```python
import torch

def _softmax(x, axis=-1):
    return torch.softmax(x, dim=axis)
def _gelu(x):
    return torch.nn.functional.gelu(x, approximate="tanh")
def _silu(x):
    return torch.nn.functional.silu(x)
def _sigmoid(x):
    return torch.sigmoid(x)
def _layernorm(x, axis=-1, eps=1e-5):
    m = x.mean(dim=axis, keepdim=True)
    v = x.var(dim=axis, keepdim=True, unbiased=False)
    return (x - m) / torch.sqrt(v + eps)
def _scatter_add(tgt, idx, src, axis=0):
    return tgt.clone().index_add_(axis, idx, src)
def _segment_sum(src, seg, n):
    out = torch.zeros((n,) + src.shape[1:], dtype=src.dtype)
    return out.index_add_(0, seg, src)
def _pad(x, pw):
    flat = tuple(v for pair in reversed(pw) for v in pair)
    return torch.nn.functional.pad(x, flat)

kernel_name = 'recurrent_scan__mha_block_cached__swiglu_ffn__prompt'

def setup_inputs():

    _w = (lambda a: (lambda t: t.to(torch.bfloat16) if t.is_floating_point() else t)(torch.as_tensor(a)))
    def _A_setup():
        B, Sq, D = 1, 2048, 640
        H, Sk, Dh = 32, 2048, 192
        return {
            "x": _w((lambda *s: torch.randn(*s, dtype=torch.bfloat16) * 0.05)(B, Sq, D)),
            "k_cache": _w((lambda *s: torch.randn(*s, dtype=torch.bfloat16) * 0.8)(B, H, Sk, Dh)),
            "v_cache": _w((lambda *s: torch.randn(*s, dtype=torch.bfloat16) * 0.2)(B, H, Sk, Dh)),
            "wq": _w((lambda *s: torch.randn(*s, dtype=torch.bfloat16) * 0.8)(D, H * Dh) * (D ** -0.5)),
            "wo": _w((lambda *s: torch.randn(*s, dtype=torch.bfloat16) * 0.2)(H * Dh, D) * ((H * Dh) ** -0.5)),
        }
    _A_in = _A_setup()

    def _B_setup():
        B, S, D, F = 1, 2048, 640, 1536
        return {
            "x": _w((lambda *s: torch.randn(*s, dtype=torch.bfloat16) * 0.05)(B, S, D)),
            "w_gate": _w((lambda *s: torch.randn(*s, dtype=torch.bfloat16) * 0.1)(D, F)),
            "w_up": _w((lambda *s: torch.randn(*s, dtype=torch.bfloat16) * 0.1)(D, F)),
            "w_down": _w((lambda *s: torch.randn(*s, dtype=torch.bfloat16) * 0.1)(F, D)),
        }
    _B_in = _B_setup()

    return {
        "A_x": _A_in["x"],
        "A_k_cache": _A_in["k_cache"],
        "A_v_cache": _A_in["v_cache"],
        "A_wq": _A_in["wq"],
        "A_wo": _A_in["wo"],
        "B_x": _B_in["x"],
        "B_w_gate": _B_in["w_gate"],
        "B_w_up": _B_in["w_up"],
        "B_w_down": _B_in["w_down"],
    }

def reference(A_x, A_k_cache, A_v_cache, A_wq, A_wo, B_x, B_w_gate, B_w_up, B_w_down):
    def _A_ref(x, k_cache, v_cache, wq, wo):
        B, Sq, D = x.shape
        H, Dh = 32, 192
        q = (lambda x, *d: x.permute(*d))((x @ wq).reshape(B, Sq, H, Dh), 0, 2, 1, 3)
        scores = torch.einsum("bhqd,bhkd->bhqk", q, k_cache) * (Dh ** -0.5)
        p = _softmax(scores, axis=-1)
        o = torch.einsum("bhqk,bhkd->bhqd", p, v_cache)
        return (lambda x, *d: x.permute(*d))(o, 0, 2, 1, 3).reshape(B, Sq, H * Dh) @ wo

    def _B_ref(x, w_gate, w_up, w_down):
        g = _silu(x @ w_gate)
        u = x @ w_up
        return (g * u) @ w_down

    x = A_x
    xn = _layernorm(x, axis=-1)
    s = _A_ref(xn, A_k_cache, A_v_cache, A_wq, A_wo)
    g = _silu(_B_ref(xn, B_w_gate, B_w_up, B_w_down))
    return x + s * g
```

```asm
; @launch grid=(256,1,1) block=(256,1,1) lds=149760
.amdgcn_target "amdgcn-amd-amdhsa--gfx950"
.text
.globl recurrent_scan__mha_block_cached__swiglu_ffn__prompt_kernel
.p2align 8
.type recurrent_scan__mha_block_cached__swiglu_ffn__prompt_kernel,@function
recurrent_scan__mha_block_cached__swiglu_ffn__prompt_kernel:
    s_cmp_ge_u32 s2, 256
    s_cbranch_scc1 K1_END
    s_getpc_b64 s[34:35]
    s_and_b32 s34, s34, 0xffffff00
    s_lshr_b32 s33, s2, 3
    s_lshl_b32 s33, s33, 12
    v_lshl_add_u32 v2, v0, 4, s33
    v_min_u32 v2, (K1_END-recurrent_scan__mha_block_cached__swiglu_ffn__prompt_kernel-16)&0xfffffff0, v2
    global_load_dwordx4 v[60:63], v2, s[34:35]
    s_bfe_u32 s33, s2, 0x10001
    s_xor_b32 s2, s2, s33
    s_memrealtime s[54:55]
    s_load_dwordx2 s[60:61], s[0:1], 0
    s_load_dwordx4 s[44:47], s[0:1], 24
    s_load_dwordx4 s[48:51], s[0:1], 48
    s_load_dwordx4 s[40:43], s[0:1], 8
    s_load_dwordx2 s[58:59], s[0:1], 64
    s_load_dwordx2 s[62:63], s[0:1], 72
    s_load_dwordx2 s[64:65], s[0:1], 80
    s_load_dwordx2 s[52:53], s[0:1], 88
    v_lshrrev_b32 v1, 6, v0
    v_and_b32 v0, 63, v0
    v_readfirstlane_b32 s28, v1
    s_and_b32 s31, s2, 6
    s_lshl_b32 s31, s31, 2
    s_bfe_u32 s33, s2, 0x30003
    s_add_u32 s31, s31, s33
    s_and_b32 s32, s2, 1
    s_lshl_b32 s32, s32, 2
    s_lshr_b32 s33, s2, 6
    s_add_u32 s32, s32, s33
    s_mul_i32 s29, s28, 3072
    v_lshrrev_b32 v36, 3, v0
    v_mul_u32_u24 v37, 1280, v36
    v_lshrrev_b32 v38, 4, v0
    v_and_b32 v39, 7, v0
    v_xor_b32 v39, v39, v38
    v_lshl_add_u32 v14, v39, 4, v37
    v_xor_b32 v39, 4, v39
    v_lshl_add_u32 v15, v39, 4, v37
    v_add_u32 v15, 10240, v15
    v_add_u32 v40, 0, v0
    v_mul_u32_u24 v44, 2731, v40
    v_lshrrev_b32 v44, 16, v44
    v_mul_u32_u24 v41, 24, v44
    v_sub_u32 v41, v40, v41
    v_and_b32 v42, 2, v44
    v_lshlrev_b32 v42, 1, v42
    v_xor_b32 v41, v41, v42
    s_lshl_b32 s33, s28, 4
    v_add_u32 v42, s33, v44
    v_mul_u32_u24 v42, 12288, v42
    v_lshl_add_u32 v42, v41, 4, v42
    v_subrev_u32 v18, 0, v42
    v_mul_u32_u24 v41, 10923, v40
    v_lshrrev_b32 v41, 16, v41
    v_mul_u32_u24 v42, 6, v41
    v_sub_u32 v42, v40, v42
    s_and_b32 s33, s31, 1
    s_lshl_b32 s33, s33, 1
    v_add_u32 v42, s33, v42
    v_subrev_u32 v43, 6, v42
    v_min_u32 v42, v42, v43
    s_and_b32 s33, s28, 1
    s_lshl_b32 s33, s33, 5
    v_add_u32 v41, s33, v41
    v_mul_u32_u24 v41, 3072, v41
    v_lshl_add_u32 v41, v42, 4, v41
    v_subrev_u32 v21, 0, v41
    v_add_u32 v40, 64, v0
    v_mul_u32_u24 v45, 2731, v40
    v_lshrrev_b32 v45, 16, v45
    v_mul_u32_u24 v41, 24, v45
    v_sub_u32 v41, v40, v41
    v_and_b32 v42, 2, v45
    v_lshlrev_b32 v42, 1, v42
    v_xor_b32 v41, v41, v42
    s_lshl_b32 s33, s28, 4
    v_add_u32 v42, s33, v45
    v_mul_u32_u24 v42, 12288, v42
    v_lshl_add_u32 v42, v41, 4, v42
    v_subrev_u32 v19, 1024, v42
    v_mul_u32_u24 v41, 10923, v40
    v_lshrrev_b32 v41, 16, v41
    v_mul_u32_u24 v42, 6, v41
    v_sub_u32 v42, v40, v42
    s_and_b32 s33, s31, 1
    s_lshl_b32 s33, s33, 1
    v_add_u32 v42, s33, v42
    v_subrev_u32 v43, 6, v42
    v_min_u32 v42, v42, v43
    s_and_b32 s33, s28, 1
    s_lshl_b32 s33, s33, 5
    v_add_u32 v41, s33, v41
    v_mul_u32_u24 v41, 3072, v41
    v_lshl_add_u32 v41, v42, 4, v41
    v_subrev_u32 v22, 1024, v41
    v_add_u32 v40, 128, v0
    v_mul_u32_u24 v46, 2731, v40
    v_lshrrev_b32 v46, 16, v46
    v_mul_u32_u24 v41, 24, v46
    v_sub_u32 v41, v40, v41
    v_and_b32 v42, 2, v46
    v_lshlrev_b32 v42, 1, v42
    v_xor_b32 v41, v41, v42
    s_lshl_b32 s33, s28, 4
    v_add_u32 v42, s33, v46
    v_mul_u32_u24 v42, 12288, v42
    v_lshl_add_u32 v42, v41, 4, v42
    v_subrev_u32 v20, 2048, v42
    v_mul_u32_u24 v41, 10923, v40
    v_lshrrev_b32 v41, 16, v41
    v_mul_u32_u24 v42, 6, v41
    v_sub_u32 v42, v40, v42
    s_and_b32 s33, s31, 1
    s_lshl_b32 s33, s33, 1
    v_add_u32 v42, s33, v42
    v_subrev_u32 v43, 6, v42
    v_min_u32 v42, v42, v43
    s_and_b32 s33, s28, 1
    s_lshl_b32 s33, s33, 5
    v_add_u32 v41, s33, v41
    v_mul_u32_u24 v41, 3072, v41
    v_lshl_add_u32 v41, v42, 4, v41
    v_subrev_u32 v23, 2048, v41
    s_add_u32 s39, s31, s32
    s_and_b32 s39, s39, 1
    s_mov_b32 s24, s39
    s_mov_b32 s25, 0
    s_mov_b32 s26, 0
    s_lshl_b32 s36, s39, 7
    s_mul_i32 s38, s39, 196608
    s_lshl_b32 s37, s38, 2
    s_mov_b32 s39, 0
    s_lshl_b32 s57, s28, 13
    s_add_u32 s57, s57, 110592
    s_lshl_b32 s33, s32, 2
    s_add_u32 s33, s33, s28
    s_mul_i32 s56, s33, 81920
    s_waitcnt lgkmcnt(0)
    s_mov_b32 s3, s54
    s_add_u32 s4, s60, s56
    s_addc_u32 s5, s61, 0
    s_mov_b32 s6, 81920
    s_mov_b32 s7, 0x00020000
    s_mul_i32 s34, s31, 384
    s_sub_u32 s35, 7864320, s34
    s_add_u32 s8, s44, s34
    s_addc_u32 s9, s45, 0
    s_mov_b32 s10, s35
    s_mov_b32 s11, 0x00020000
    s_cmp_lt_u32 s28, 2
    s_cselect_b32 s44, s48, s50
    s_cselect_b32 s45, s49, s51
    s_mul_i32 s34, s31, 96
    s_sub_u32 s35, 1966080, s34
    s_add_u32 s12, s44, s34
    s_addc_u32 s13, s45, 0
    s_mov_b32 s14, s35
    s_mov_b32 s15, 0x00020000
    s_add_u32 m0, s57, 0
    s_add_u32 s35, s36, 0
    buffer_load_dwordx4 v14, s[4:7], s35 offen lds
    s_lshl_b32 s66, s33, 7
    s_lshl_b32 s67, s31, 2
    s_add_u32 s66, s66, s67
    s_and_b32 s67, s2, 1
    s_lshl_b32 s67, s67, 5
    s_lshr_b32 s56, s2, 3
    s_add_u32 s67, s67, s56
    s_lshl_b32 s67, s67, 2
    s_add_u32 s67, s67, s28
    s_lshl_b32 s67, s67, 2
    s_bfe_u32 s56, s2, 0x20001
    s_add_u32 s67, s67, s56
    s_lshl_b32 s67, s67, 2
    s_add_u32 s67, s67, 0x1000
    s_add_u32 m0, s57, 1024
    s_add_u32 s35, s36, 0
    buffer_load_dwordx4 v15, s[4:7], s35 offen lds
    s_add_u32 s66, s66, 117440512
    s_add_u32 s67, s67, 117440512
    v_mov_b32 v1, s66
    v_mov_b32 v40, s67
    v_cmp_eq_u32 vcc, 1, v0
    v_mov_b32 v41, 0
    s_nop 0
    v_cndmask_b32 v1, v1, v40, vcc
    s_mul_i32 s66, s31, 786432
    s_add_u32 s16, s40, s66
    s_addc_u32 s17, s41, 0
    s_mov_b32 s18, 786432
    s_mov_b32 s19, 0x00020000
    s_add_u32 s20, s42, s66
    s_addc_u32 s21, s43, 0
    s_add_u32 m0, s57, 2048
    s_add_u32 s35, s36, 20480
    buffer_load_dwordx4 v14, s[4:7], s35 offen lds
    s_mov_b32 s22, 786432
    s_mov_b32 s23, 0x00020000
    s_cmp_ge_u32 s2, 192
    s_cselect_b32 s44, s58, s46
    s_cselect_b32 s45, s59, s47
    s_cselect_b32 s66, 192, 0
    s_sub_u32 s66, s2, s66
    s_mul_i32 s66, s66, 40960
    s_cmp_lt_u32 s2, 240
    s_cselect_b32 s67, 40960, 0
    s_cselect_b32 s66, s66, 0
    s_add_u32 s40, s44, s66
    s_addc_u32 s41, s45, 0
    s_mov_b32 s42, s67
    s_add_u32 m0, s57, 3072
    s_add_u32 s35, s36, 20480
    buffer_load_dwordx4 v15, s[4:7], s35 offen lds
    s_mov_b32 s43, 0x00020000
    s_lshl_b32 s66, s2, 2
    s_add_u32 s66, s66, s28
    s_mul_i32 s66, s66, 10240
    s_lshr_b32 s67, s67, 2
    s_add_u32 s48, s52, s66
    s_addc_u32 s49, s53, 0
    s_add_u32 s48, s48, 4194304
    s_addc_u32 s49, s49, 0
    s_mov_b32 s50, s67
    s_mov_b32 s51, 0x00020000
    s_and_b32 s66, s2, 1
    s_lshl_b32 s66, s66, 5
    s_lshr_b32 s67, s2, 3
    s_add_u32 m0, s57, 4096
    s_add_u32 s35, s36, 40960
    buffer_load_dwordx4 v14, s[4:7], s35 offen lds
    s_add_u32 s66, s66, s67
    s_lshl_b32 s66, s66, 2
    s_bfe_u32 s67, s2, 0x20001
    s_add_u32 s66, s66, s67
    s_lshl_b32 s66, s66, 2
    s_add_u32 s66, s66, s28
    s_mul_i32 s66, s66, 15360
    s_add_u32 s44, s52, s66
    s_addc_u32 s45, s53, 0
    s_add_u32 s44, s44, 67108864
    s_addc_u32 s45, s45, 0
    s_mov_b32 s46, 7680
    s_mov_b32 s47, 0x00020000
    v_bfe_u32 v39, v0, 2, 2
    s_add_u32 m0, s57, 5120
    s_add_u32 s35, s36, 40960
    buffer_load_dwordx4 v15, s[4:7], s35 offen lds
    v_and_b32 v40, 3, v0
    v_and_b32 v41, 15, v0
    s_lshl_b32 s66, s28, 3
    v_add_u32 v42, s66, v44
    v_bfe_u32 v43, v42, 1, 3
    v_xor_b32 v43, v43, v0
    v_lshlrev_b32 v43, 4, v43
    v_add_u32 v43, s29, v43
    v_add_u32 v8, 12288, v43
    v_and_b32 v43, 6, v42
    v_xor_b32 v43, v43, v0
    v_lshlrev_b32 v43, 4, v43
    v_add_u32 v11, s29, v43
    s_lshl_b32 s66, s28, 3
    s_add_u32 m0, s57, 6144
    s_add_u32 s35, s36, 61440
    buffer_load_dwordx4 v14, s[4:7], s35 offen lds
    v_add_u32 v42, s66, v45
    v_bfe_u32 v43, v42, 1, 3
    v_xor_b32 v43, v43, v0
    v_lshlrev_b32 v43, 4, v43
    v_add_u32 v43, s29, v43
    v_add_u32 v9, 12288, v43
    v_and_b32 v43, 6, v42
    v_xor_b32 v43, v43, v0
    v_lshlrev_b32 v43, 4, v43
    v_add_u32 v12, s29, v43
    s_lshl_b32 s66, s28, 3
    v_add_u32 v42, s66, v46
    v_bfe_u32 v43, v42, 1, 3
    v_xor_b32 v43, v43, v0
    s_add_u32 m0, s57, 7168
    s_add_u32 s35, s36, 61440
    buffer_load_dwordx4 v15, s[4:7], s35 offen lds
    v_lshlrev_b32 v43, 4, v43
    v_add_u32 v43, s29, v43
    v_add_u32 v10, 12288, v43
    v_and_b32 v43, 6, v42
    v_xor_b32 v43, v43, v0
    v_lshlrev_b32 v43, 4, v43
    v_add_u32 v13, s29, v43
    v_lshl_add_u32 v42, v38, 3, v39
    v_mul_u32_u24 v43, 384, v42
    v_lshl_add_u32 v43, v40, 4, v43
    v_lshrrev_b32 v44, 1, v39
    v_lshl_add_u32 v24, v44, 6, v43
    v_xor_b32 v45, 1, v44
    v_lshl_add_u32 v25, v45, 6, v43
    s_add_u32 s25, s25, 1
    s_xor_b32 s36, s25, s24
    s_lshl_b32 s36, s36, 7
    s_lshl_b32 s34, s29, 1
    s_add_u32 m0, s39, s34
    s_nop 0
    buffer_load_dwordx4 v18, s[8:11], s37 offen offset:0 nt lds
    s_lshr_b32 s66, s28, 1
    v_xor_b32 v45, s66, v44
    v_lshl_add_u32 v27, v45, 6, v43
    s_and_b32 s67, s28, 1
    s_lshl_b32 s66, s67, 3
    v_add_u32 v27, s66, v27
    v_mul_u32_u24 v43, 96, v42
    v_lshl_add_u32 v26, v40, 3, v43
    s_lshl_b32 s66, s28, 5
    s_cmp_eq_u32 s28, 3
    s_cselect_b32 s66, 6144, s66
    v_add_u32 v28, s66, v26
    s_lshl_b32 s66, s67, 5
    s_add_u32 s66, s66, 6176
    buffer_load_dwordx4 v19, s[8:11], s37 offen offset:1024 nt lds
    v_add_u32 v29, s66, v26
    v_bfe_u32 v44, v41, 1, 3
    v_xor_b32 v44, v44, v38
    v_xor_b32 v45, 4, v44
    v_lshlrev_b32 v43, 7, v41
    v_add_u32 v43, s57, v43
    v_lshl_add_u32 v16, v44, 4, v43
    v_lshl_add_u32 v17, v45, 4, v43
    v_mul_u32_u24 v43, 384, v41
    v_add_u32 v43, 36864, v43
    v_lshl_add_u32 v2, v44, 4, v43
    v_lshl_add_u32 v3, v45, 4, v43
    v_lshrrev_b32 v42, 2, v0
    v_mul_u32_u24 v43, 384, v42
    buffer_load_dwordx4 v20, s[8:11], s37 offen offset:2048 nt lds
    v_add_u32 v43, 86016, v43
    v_and_b32 v44, 1, v40
    v_lshl_add_u32 v43, v44, 3, v43
    v_and_b32 v44, 6, v42
    v_lshrrev_b32 v45, 1, v40
    v_xor_b32 v44, v44, v45
    v_xor_b32 v45, 0, v44
    v_lshl_add_u32 v4, v45, 4, v43
    v_xor_b32 v45, 2, v44
    v_lshl_add_u32 v5, v45, 4, v43
    v_xor_b32 v45, 4, v44
    v_lshl_add_u32 v6, v45, 4, v43
    v_xor_b32 v45, 6, v44
    v_lshl_add_u32 v7, v45, 4, v43
    s_add_u32 m0, m0, 3072
    s_add_u32 s35, s37, 98304
    buffer_load_dwordx4 v18, s[8:11], s35 offen offset:0 nt lds
    s_mul_i32 s66, s28, 320
    v_add_u32 v43, 0, v0
    v_mul_u32_u24 v44, 3277, v43
    v_lshrrev_b32 v44, 16, v44
    v_mul_u32_u24 v45, 20, v44
    v_sub_u32 v45, v43, v45
    v_mul_u32_u24 v44, 1280, v44
    v_lshl_add_u32 v44, v45, 4, v44
    v_add_u32 v30, s66, v44
    v_add_u32 v43, 64, v0
    v_mul_u32_u24 v44, 3277, v43
    v_lshrrev_b32 v44, 16, v44
    v_mul_u32_u24 v45, 20, v44
    v_sub_u32 v45, v43, v45
    buffer_load_dwordx4 v19, s[8:11], s35 offen offset:1024 nt lds
    v_mul_u32_u24 v44, 1280, v44
    v_lshl_add_u32 v44, v45, 4, v44
    v_add_u32 v31, s66, v44
    v_add_u32 v43, 128, v0
    v_mul_u32_u24 v44, 3277, v43
    v_lshrrev_b32 v44, 16, v44
    v_mul_u32_u24 v45, 20, v44
    v_sub_u32 v45, v43, v45
    v_mul_u32_u24 v44, 1280, v44
    v_lshl_add_u32 v44, v45, 4, v44
    v_add_u32 v32, s66, v44
    v_add_u32 v43, 192, v0
    v_mul_u32_u24 v44, 3277, v43
    v_lshrrev_b32 v44, 16, v44
    buffer_load_dwordx4 v20, s[8:11], s35 offen offset:2048 nt lds
    v_mul_u32_u24 v45, 20, v44
    v_sub_u32 v45, v43, v45
    v_mul_u32_u24 v44, 1280, v44
    v_lshl_add_u32 v44, v45, 4, v44
    v_add_u32 v33, s66, v44
    v_add_u32 v43, 256, v0
    v_mul_u32_u24 v44, 3277, v43
    v_lshrrev_b32 v44, 16, v44
    v_mul_u32_u24 v45, 20, v44
    v_sub_u32 v45, v43, v45
    v_mul_u32_u24 v44, 1280, v44
    v_lshl_add_u32 v44, v45, 4, v44
    v_add_u32 v34, s66, v44
    v_mul_u32_u24 v43, 320, v42
    s_add_u32 s34, s29, 24576
    s_add_u32 m0, s39, s34
    s_nop 0
    buffer_load_dwordx4 v21, s[12:15], s38 offen offset:0 lds
    v_lshl_add_u32 v43, v40, 3, v43
    s_mul_i32 s58, s28, 10240
    s_cmp_eq_u32 s28, 3
    s_cselect_b32 s58, 135168, s58
    v_add_u32 v35, s58, v43
    v_lshlrev_b32 v36, 4, v38
    v_add_u32 v36, 147456, v36
    s_lshl_b32 s66, s28, 6
    v_add_u32 v56, s66, v36
    s_and_b32 s66, s66, 64
    v_add_u32 v57, s66, v36
    v_mov_b32 v43, 0x3f803f80
    v_cmp_eq_u32 vcc, 0, v40
    v_mov_b32 v45, 148672
    buffer_load_dwordx4 v22, s[12:15], s38 offen offset:1024 lds
    s_nop 0
    v_cndmask_b32 v44, 0, v43, vcc
    v_cmp_eq_u32 vcc, 0, v41
    v_accvgpr_write_b32 a148, v44
    v_accvgpr_write_b32 a149, v44
    v_accvgpr_write_b32 a150, v44
    v_accvgpr_write_b32 a151, v44
    v_cndmask_b32 v44, 0, v43, vcc
    v_cndmask_b32 v56, v45, v56, vcc
    v_cndmask_b32 v57, v45, v57, vcc
    v_accvgpr_write_b32 a184, v44
    v_accvgpr_write_b32 a185, v44
    v_accvgpr_write_b32 a186, v44
    v_accvgpr_write_b32 a187, v44
    buffer_load_dwordx4 v23, s[12:15], s38 offen offset:2048 lds
    s_add_u32 s26, s26, 1
    s_xor_b32 s38, s26, s24
    s_mul_i32 s38, s38, 196608
    s_lshl_b32 s37, s38, 2
    s_add_u32 s39, s39, 36864
    s_cmp_eq_u32 s39, 110592
    s_cselect_b32 s39, 0, s39
    s_lshl_b32 s34, s29, 1
    s_add_u32 m0, s39, s34
    s_nop 0
    buffer_load_dwordx4 v18, s[8:11], s37 offen offset:0 nt lds
    buffer_load_dwordx4 v19, s[8:11], s37 offen offset:1024 nt lds
    buffer_load_dwordx4 v20, s[8:11], s37 offen offset:2048 nt lds
    s_add_u32 m0, m0, 3072
    s_add_u32 s35, s37, 98304
    buffer_load_dwordx4 v18, s[8:11], s35 offen offset:0 nt lds
    buffer_load_dwordx4 v19, s[8:11], s35 offen offset:1024 nt lds
    buffer_load_dwordx4 v20, s[8:11], s35 offen offset:2048 nt lds
    s_add_u32 s34, s29, 24576
    s_add_u32 m0, s39, s34
    s_nop 0
    buffer_load_dwordx4 v21, s[12:15], s38 offen offset:0 lds
    buffer_load_dwordx4 v22, s[12:15], s38 offen offset:1024 lds
    buffer_load_dwordx4 v23, s[12:15], s38 offen offset:2048 lds
    s_add_u32 s26, s26, 1
    s_xor_b32 s38, s26, s24
    s_mul_i32 s38, s38, 196608
    s_lshl_b32 s37, s38, 2
    s_add_u32 s39, s39, 36864
    s_cmp_eq_u32 s39, 110592
    s_cselect_b32 s39, 0, s39
    s_waitcnt vmcnt(18)
    ds_read_b128 a[192:195], v16 offset:0
    ds_read_b128 a[196:199], v16 offset:2048
    ds_read_b128 a[200:203], v16 offset:4096
    ds_read_b128 a[204:207], v16 offset:6144
    ds_read_b128 a[208:211], v17 offset:0
    ds_read_b128 a[212:215], v17 offset:2048
    ds_read_b128 a[216:219], v17 offset:4096
    ds_read_b128 a[220:223], v17 offset:6144
    s_waitcnt vmcnt(9) lgkmcnt(0)
    s_barrier
    ds_read_b64_tr_b16 a[152:153], v24 offset:0
    ds_read_b64_tr_b16 a[154:155], v24 offset:1536
    ds_read_b64_tr_b16 a[156:157], v24 offset:12288
    ds_read_b64_tr_b16 a[158:159], v24 offset:13824
    ds_read_b64_tr_b16 a[160:161], v24 offset:8
    ds_read_b64_tr_b16 a[162:163], v24 offset:1544
    ds_read_b64_tr_b16 a[164:165], v24 offset:12296
    ds_read_b64_tr_b16 a[166:167], v24 offset:13832
    s_mov_b32 s54, 4
    s_mov_b32 s33, 0
    s_mov_b32 s55, 36864
    s_mov_b32 s56, 4294893568
    s_waitcnt lgkmcnt(4)
    v_mfma_f32_16x16x32_bf16 v[64:67], a[152:155], a[192:195], 0
    ds_read_b64_tr_b16 a[168:169], v25 offset:0
    s_add_u32 m0, s57, 0
    v_mfma_f32_16x16x32_bf16 v[64:67], a[156:159], a[208:211], v[64:67]
    ds_read_b64_tr_b16 a[170:171], v25 offset:1536
    s_add_u32 s35, s36, 0
    v_mfma_f32_16x16x32_bf16 v[72:75], a[156:159], a[212:215], 0
    ds_read_b64_tr_b16 a[172:173], v25 offset:12288
    v_mfma_f32_16x16x32_bf16 v[72:75], a[152:155], a[196:199], v[72:75]
    ds_read_b64_tr_b16 a[174:175], v25 offset:13824
    v_mfma_f32_16x16x32_bf16 v[80:83], a[152:155], a[200:203], 0
    ds_read_b64_tr_b16 a[176:177], v27 offset:0
    v_mfma_f32_16x16x32_bf16 v[80:83], a[156:159], a[216:219], v[80:83]
    ds_read_b64_tr_b16 a[178:179], v27 offset:1536
    v_mfma_f32_16x16x32_bf16 v[88:91], a[156:159], a[220:223], 0
    ds_read_b64_tr_b16 a[180:181], v27 offset:12288
    v_mfma_f32_16x16x32_bf16 v[88:91], a[152:155], a[204:207], v[88:91]
    ds_read_b64_tr_b16 a[182:183], v27 offset:13824
    v_mfma_f32_16x16x32_bf16 a[96:99], a[148:151], a[192:195], 0
    buffer_load_dwordx4 v14, s[4:7], s35 offen lds
    s_add_u32 m0, s57, 1024
    v_mfma_f32_16x16x32_bf16 a[112:115], a[192:195], a[192:195], 0
    s_add_u32 s35, s36, 0
    s_waitcnt lgkmcnt(8)
    v_mfma_f32_16x16x32_bf16 v[92:95], a[160:163], a[204:207], 0
    ds_read_b64_tr_b16 a[152:153], v25 offset:8
    s_add_u32 s33, s33, 36864
    v_mfma_f32_16x16x32_bf16 v[92:95], a[164:167], a[220:223], v[92:95]
    ds_read_b64_tr_b16 a[154:155], v25 offset:1544
    v_mfma_f32_16x16x32_bf16 v[84:87], a[164:167], a[216:219], 0
    ds_read_b64_tr_b16 a[156:157], v25 offset:12296
    v_mfma_f32_16x16x32_bf16 v[84:87], a[160:163], a[200:203], v[84:87]
    ds_read_b64_tr_b16 a[158:159], v25 offset:13832
    v_mfma_f32_16x16x32_bf16 v[76:79], a[160:163], a[196:199], 0
    buffer_load_dwordx4 v15, s[4:7], s35 offen lds
    s_add_u32 m0, s57, 2048
    v_mfma_f32_16x16x32_bf16 v[76:79], a[164:167], a[212:215], v[76:79]
    s_add_u32 s35, s36, 20480
    v_mfma_f32_16x16x32_bf16 v[68:71], a[164:167], a[208:211], 0
    s_cmp_eq_u32 s33, 110592
    s_cselect_b32 s59, s56, s55
    v_mfma_f32_16x16x32_bf16 v[68:71], a[160:163], a[192:195], v[68:71]
    s_cmp_eq_u32 s33, 110592
    s_cselect_b32 s33, 0, s33
    v_mfma_f32_16x16x32_bf16 a[100:103], a[148:151], a[196:199], 0
    buffer_load_dwordx4 v14, s[4:7], s35 offen lds
    s_add_u32 m0, s57, 3072
    v_mfma_f32_16x16x32_bf16 a[116:119], a[196:199], a[196:199], 0
    s_add_u32 s35, s36, 20480
    s_waitcnt lgkmcnt(8)
    v_mfma_f32_16x16x32_bf16 v[96:99], a[168:171], a[192:195], 0
    ds_read_b64_tr_b16 a[160:161], v24 offset:128
    v_mfma_f32_16x16x32_bf16 v[96:99], a[172:175], a[208:211], v[96:99]
    ds_read_b64_tr_b16 a[162:163], v24 offset:1664
    v_mfma_f32_16x16x32_bf16 v[104:107], a[172:175], a[212:215], 0
    ds_read_b64_tr_b16 a[164:165], v24 offset:12416
    v_mfma_f32_16x16x32_bf16 v[104:107], a[168:171], a[196:199], v[104:107]
    ds_read_b64_tr_b16 a[166:167], v24 offset:13952
    v_mfma_f32_16x16x32_bf16 v[112:115], a[168:171], a[200:203], 0
    buffer_load_dwordx4 v15, s[4:7], s35 offen lds
    s_add_u32 m0, s57, 4096
    v_mfma_f32_16x16x32_bf16 v[112:115], a[172:175], a[216:219], v[112:115]
    s_add_u32 s35, s36, 40960
    v_mfma_f32_16x16x32_bf16 v[120:123], a[172:175], a[220:223], 0
    v_mfma_f32_16x16x32_bf16 v[120:123], a[168:171], a[204:207], v[120:123]
    s_waitcnt lgkmcnt(8)
    v_mfma_f32_16x16x32_bf16 a[128:131], a[176:179], a[184:187], 0
    buffer_load_dwordx4 v14, s[4:7], s35 offen lds
    s_add_u32 m0, s57, 5120
    v_mfma_f32_16x16x32_bf16 a[128:131], a[180:183], a[184:187], a[128:131]
    s_add_u32 s35, s36, 40960
    s_waitcnt lgkmcnt(4)
    v_mfma_f32_16x16x32_bf16 v[124:127], a[152:155], a[204:207], 0
    ds_read_b64_tr_b16 a[168:169], v24 offset:136
    v_mfma_f32_16x16x32_bf16 v[124:127], a[156:159], a[220:223], v[124:127]
    ds_read_b64_tr_b16 a[170:171], v24 offset:1672
    v_mfma_f32_16x16x32_bf16 v[116:119], a[156:159], a[216:219], 0
    ds_read_b64_tr_b16 a[172:173], v24 offset:12424
    v_mfma_f32_16x16x32_bf16 v[116:119], a[152:155], a[200:203], v[116:119]
    ds_read_b64_tr_b16 a[174:175], v24 offset:13960
    v_mfma_f32_16x16x32_bf16 v[108:111], a[152:155], a[196:199], 0
    ds_read_b64_tr_b16 a[176:177], v27 offset:128
    v_mfma_f32_16x16x32_bf16 v[108:111], a[156:159], a[212:215], v[108:111]
    ds_read_b64_tr_b16 a[178:179], v27 offset:1664
    v_mfma_f32_16x16x32_bf16 v[100:103], a[156:159], a[208:211], 0
    ds_read_b64_tr_b16 a[180:181], v27 offset:12416
    v_mfma_f32_16x16x32_bf16 v[100:103], a[152:155], a[192:195], v[100:103]
    ds_read_b64_tr_b16 a[182:183], v27 offset:13952
    v_mfma_f32_16x16x32_bf16 a[104:107], a[148:151], a[200:203], 0
    buffer_load_dwordx4 v15, s[4:7], s35 offen lds
    s_add_u32 m0, s57, 6144
    v_mfma_f32_16x16x32_bf16 a[120:123], a[200:203], a[200:203], 0
    s_add_u32 s35, s36, 61440
    s_waitcnt lgkmcnt(8)
    v_mfma_f32_16x16x32_bf16 v[128:131], a[160:163], a[192:195], 0
    ds_read_b64_tr_b16 a[152:153], v25 offset:128
    v_mfma_f32_16x16x32_bf16 v[128:131], a[164:167], a[208:211], v[128:131]
    ds_read_b64_tr_b16 a[154:155], v25 offset:1664
    v_mfma_f32_16x16x32_bf16 v[136:139], a[164:167], a[212:215], 0
    ds_read_b64_tr_b16 a[156:157], v25 offset:12416
    v_mfma_f32_16x16x32_bf16 v[136:139], a[160:163], a[196:199], v[136:139]
    ds_read_b64_tr_b16 a[158:159], v25 offset:13952
    v_mfma_f32_16x16x32_bf16 v[144:147], a[160:163], a[200:203], 0
    buffer_load_dwordx4 v14, s[4:7], s35 offen lds
    s_add_u32 m0, s57, 7168
    v_mfma_f32_16x16x32_bf16 v[144:147], a[164:167], a[216:219], v[144:147]
    s_add_u32 s35, s36, 61440
    v_mfma_f32_16x16x32_bf16 v[152:155], a[164:167], a[220:223], 0
    v_mfma_f32_16x16x32_bf16 v[152:155], a[160:163], a[204:207], v[152:155]
    v_mfma_f32_16x16x32_bf16 a[108:111], a[148:151], a[204:207], 0
    buffer_load_dwordx4 v15, s[4:7], s35 offen lds
    s_add_u32 s25, s25, 1
    v_mfma_f32_16x16x32_bf16 a[124:127], a[204:207], a[204:207], 0
    s_xor_b32 s36, s25, s24
    s_waitcnt lgkmcnt(8)
    v_mfma_f32_16x16x32_bf16 v[156:159], a[168:171], a[204:207], 0
    ds_read_b64_tr_b16 a[160:161], v25 offset:136
    s_lshl_b32 s36, s36, 7
    v_mfma_f32_16x16x32_bf16 v[156:159], a[172:175], a[220:223], v[156:159]
    ds_read_b64_tr_b16 a[162:163], v25 offset:1672
    s_lshl_b32 s34, s29, 1
    v_mfma_f32_16x16x32_bf16 v[148:151], a[172:175], a[216:219], 0
    ds_read_b64_tr_b16 a[164:165], v25 offset:12424
    s_add_u32 m0, s39, s34
    v_mfma_f32_16x16x32_bf16 v[148:151], a[168:171], a[200:203], v[148:151]
    ds_read_b64_tr_b16 a[166:167], v25 offset:13960
    v_mfma_f32_16x16x32_bf16 v[140:143], a[168:171], a[196:199], 0
    buffer_load_dwordx4 v18, s[8:11], s37 offen offset:0 nt lds
    v_mfma_f32_16x16x32_bf16 v[140:143], a[172:175], a[212:215], v[140:143]
    v_mfma_f32_16x16x32_bf16 v[132:135], a[172:175], a[208:211], 0
    v_mfma_f32_16x16x32_bf16 v[132:135], a[168:171], a[192:195], v[132:135]
    buffer_load_dwordx4 v19, s[8:11], s37 offen offset:1024 nt lds
    s_waitcnt lgkmcnt(8)
    v_mfma_f32_16x16x32_bf16 a[132:135], a[176:179], a[184:187], 0
    v_mfma_f32_16x16x32_bf16 a[132:135], a[180:183], a[184:187], a[132:135]
    s_waitcnt lgkmcnt(4)
    v_mfma_f32_16x16x32_bf16 v[160:163], a[152:155], a[192:195], 0
    ds_read_b64_tr_b16 a[168:169], v24 offset:256
    v_mfma_f32_16x16x32_bf16 v[160:163], a[156:159], a[208:211], v[160:163]
    ds_read_b64_tr_b16 a[170:171], v24 offset:1792
    v_mfma_f32_16x16x32_bf16 v[168:171], a[156:159], a[212:215], 0
    ds_read_b64_tr_b16 a[172:173], v24 offset:12544
    v_mfma_f32_16x16x32_bf16 v[168:171], a[152:155], a[196:199], v[168:171]
    ds_read_b64_tr_b16 a[174:175], v24 offset:14080
    v_mfma_f32_16x16x32_bf16 v[176:179], a[152:155], a[200:203], 0
    ds_read_b64_tr_b16 a[176:177], v27 offset:256
    v_mfma_f32_16x16x32_bf16 v[176:179], a[156:159], a[216:219], v[176:179]
    ds_read_b64_tr_b16 a[178:179], v27 offset:1792
    v_mfma_f32_16x16x32_bf16 v[184:187], a[156:159], a[220:223], 0
    ds_read_b64_tr_b16 a[180:181], v27 offset:12544
    v_mfma_f32_16x16x32_bf16 v[184:187], a[152:155], a[204:207], v[184:187]
    ds_read_b64_tr_b16 a[182:183], v27 offset:14080
    v_mfma_f32_16x16x32_bf16 a[96:99], a[148:151], a[208:211], a[96:99]
    buffer_load_dwordx4 v20, s[8:11], s37 offen offset:2048 nt lds
    s_add_u32 m0, m0, 3072
    v_mfma_f32_16x16x32_bf16 a[112:115], a[208:211], a[208:211], a[112:115]
    s_add_u32 s35, s37, 98304
    s_waitcnt lgkmcnt(8)
    v_mfma_f32_16x16x32_bf16 v[188:191], a[160:163], a[204:207], 0
    ds_read_b64_tr_b16 a[152:153], v24 offset:264
    v_add_u32 v27, s59, v27
    v_mfma_f32_16x16x32_bf16 v[188:191], a[164:167], a[220:223], v[188:191]
    ds_read_b64_tr_b16 a[154:155], v24 offset:1800
    v_mfma_f32_16x16x32_bf16 v[180:183], a[164:167], a[216:219], 0
    ds_read_b64_tr_b16 a[156:157], v24 offset:12552
    v_mfma_f32_16x16x32_bf16 v[180:183], a[160:163], a[200:203], v[180:183]
    ds_read_b64_tr_b16 a[158:159], v24 offset:14088
    v_mfma_f32_16x16x32_bf16 v[172:175], a[160:163], a[196:199], 0
    buffer_load_dwordx4 v18, s[8:11], s35 offen offset:0 nt lds
    v_mfma_f32_16x16x32_bf16 v[172:175], a[164:167], a[212:215], v[172:175]
    v_mfma_f32_16x16x32_bf16 v[164:167], a[164:167], a[208:211], 0
    v_mfma_f32_16x16x32_bf16 v[164:167], a[160:163], a[192:195], v[164:167]
    buffer_load_dwordx4 v19, s[8:11], s35 offen offset:1024 nt lds
    v_mfma_f32_16x16x32_bf16 a[100:103], a[148:151], a[212:215], a[100:103]
    v_mfma_f32_16x16x32_bf16 a[116:119], a[212:215], a[212:215], a[116:119]
    s_waitcnt lgkmcnt(8)
    v_mfma_f32_16x16x32_bf16 v[192:195], a[168:171], a[192:195], 0
    ds_read_b64_tr_b16 a[160:161], v25 offset:256
    v_mfma_f32_16x16x32_bf16 v[192:195], a[172:175], a[208:211], v[192:195]
    ds_read_b64_tr_b16 a[162:163], v25 offset:1792
    v_mfma_f32_16x16x32_bf16 v[200:203], a[172:175], a[212:215], 0
    ds_read_b64_tr_b16 a[164:165], v25 offset:12544
    v_mfma_f32_16x16x32_bf16 v[200:203], a[168:171], a[196:199], v[200:203]
    ds_read_b64_tr_b16 a[166:167], v25 offset:14080
    v_mfma_f32_16x16x32_bf16 v[208:211], a[168:171], a[200:203], 0
    buffer_load_dwordx4 v20, s[8:11], s35 offen offset:2048 nt lds
    s_add_u32 s34, s29, 24576
    v_mfma_f32_16x16x32_bf16 v[208:211], a[172:175], a[216:219], v[208:211]
    s_add_u32 m0, s39, s34
    v_mfma_f32_16x16x32_bf16 v[216:219], a[172:175], a[220:223], 0
    v_mfma_f32_16x16x32_bf16 v[216:219], a[168:171], a[204:207], v[216:219]
    buffer_load_dwordx4 v21, s[12:15], s38 offen offset:0 lds
    s_waitcnt lgkmcnt(8)
    v_mfma_f32_16x16x32_bf16 a[136:139], a[176:179], a[184:187], 0
    v_mfma_f32_16x16x32_bf16 a[136:139], a[180:183], a[184:187], a[136:139]
    s_waitcnt lgkmcnt(4)
    v_mfma_f32_16x16x32_bf16 v[220:223], a[152:155], a[204:207], 0
    ds_read_b64_tr_b16 a[168:169], v25 offset:264
    v_mfma_f32_16x16x32_bf16 v[220:223], a[156:159], a[220:223], v[220:223]
    ds_read_b64_tr_b16 a[170:171], v25 offset:1800
    v_mfma_f32_16x16x32_bf16 v[212:215], a[156:159], a[216:219], 0
    ds_read_b64_tr_b16 a[172:173], v25 offset:12552
    v_mfma_f32_16x16x32_bf16 v[212:215], a[152:155], a[200:203], v[212:215]
    ds_read_b64_tr_b16 a[174:175], v25 offset:14088
    v_mfma_f32_16x16x32_bf16 v[204:207], a[152:155], a[196:199], 0
    ds_read_b64_tr_b16 a[176:177], v28 offset:24576
    v_mfma_f32_16x16x32_bf16 v[204:207], a[156:159], a[212:215], v[204:207]
    ds_read_b64_tr_b16 a[178:179], v28 offset:24960
    v_mfma_f32_16x16x32_bf16 v[196:199], a[156:159], a[208:211], 0
    ds_read_b64_tr_b16 a[180:181], v28 offset:27648
    v_mfma_f32_16x16x32_bf16 v[196:199], a[152:155], a[192:195], v[196:199]
    ds_read_b64_tr_b16 a[182:183], v28 offset:28032
    v_mfma_f32_16x16x32_bf16 a[104:107], a[148:151], a[216:219], a[104:107]
    s_waitcnt vmcnt(13)
    ds_read_b128 a[224:227], v16 offset:0
    v_mfma_f32_16x16x32_bf16 a[120:123], a[216:219], a[216:219], a[120:123]
    ds_read_b128 a[240:243], v17 offset:0
    s_waitcnt lgkmcnt(10)
    v_mfma_f32_16x16x32_bf16 v[224:227], a[160:163], a[192:195], 0
    ds_read_b64_tr_b16 a[152:153], v26 offset:24576
    v_add_u32 v24, s59, v24
    v_mfma_f32_16x16x32_bf16 v[224:227], a[164:167], a[208:211], v[224:227]
    ds_read_b64_tr_b16 a[154:155], v26 offset:24960
    v_add_u32 v25, s59, v25
    v_mfma_f32_16x16x32_bf16 v[232:235], a[164:167], a[212:215], 0
    ds_read_b64_tr_b16 a[156:157], v26 offset:27648
    v_add_u32 v28, s59, v28
    v_mfma_f32_16x16x32_bf16 v[232:235], a[160:163], a[196:199], v[232:235]
    ds_read_b64_tr_b16 a[158:159], v26 offset:28032
    v_mfma_f32_16x16x32_bf16 v[240:243], a[160:163], a[200:203], 0
    s_waitcnt vmcnt(11)
    ds_read_b128 a[228:231], v16 offset:2048
    v_mfma_f32_16x16x32_bf16 v[240:243], a[164:167], a[216:219], v[240:243]
    ds_read_b128 a[244:247], v17 offset:2048
    v_mfma_f32_16x16x32_bf16 v[248:251], a[164:167], a[220:223], 0
    buffer_load_dwordx4 v22, s[12:15], s38 offen offset:1024 lds
    v_mfma_f32_16x16x32_bf16 v[248:251], a[160:163], a[204:207], v[248:251]
    v_mfma_f32_16x16x32_bf16 a[108:111], a[148:151], a[220:223], a[108:111]
    v_mfma_f32_16x16x32_bf16 a[124:127], a[220:223], a[220:223], a[124:127]
    buffer_load_dwordx4 v23, s[12:15], s38 offen offset:2048 lds
    s_waitcnt lgkmcnt(12)
    v_mfma_f32_16x16x32_bf16 v[252:255], a[168:171], a[204:207], 0
    ds_read_b64_tr_b16 a[160:161], v26 offset:24608
    s_add_u32 s26, s26, 1
    v_mfma_f32_16x16x32_bf16 v[252:255], a[172:175], a[220:223], v[252:255]
    ds_read_b64_tr_b16 a[162:163], v26 offset:24992
    s_xor_b32 s38, s26, s24
    v_mfma_f32_16x16x32_bf16 v[244:247], a[172:175], a[216:219], 0
    ds_read_b64_tr_b16 a[164:165], v26 offset:27680
    s_mul_i32 s38, s38, 196608
    v_mfma_f32_16x16x32_bf16 v[244:247], a[168:171], a[200:203], v[244:247]
    ds_read_b64_tr_b16 a[166:167], v26 offset:28064
    s_lshl_b32 s37, s38, 2
    v_mfma_f32_16x16x32_bf16 v[236:239], a[168:171], a[196:199], 0
    s_waitcnt vmcnt(11)
    ds_read_b128 a[232:235], v16 offset:4096
    s_add_u32 s39, s39, 36864
    v_mfma_f32_16x16x32_bf16 v[236:239], a[172:175], a[212:215], v[236:239]
    ds_read_b128 a[248:251], v17 offset:4096
    v_mfma_f32_16x16x32_bf16 v[228:231], a[172:175], a[208:211], 0
    s_cmp_eq_u32 s39, 110592
    s_cselect_b32 s39, 0, s39
    v_mfma_f32_16x16x32_bf16 v[228:231], a[168:171], a[192:195], v[228:231]
    s_waitcnt lgkmcnt(14)
    v_mfma_f32_16x16x32_bf16 a[140:143], a[176:179], a[184:187], 0
    v_mfma_f32_16x16x32_bf16 a[140:143], a[180:183], a[184:187], a[140:143]
    s_waitcnt lgkmcnt(8)
    v_mfma_f32_16x16x32_bf16 a[0:3], a[152:155], a[192:195], 0
    ds_read_b64_tr_b16 a[168:169], v26 offset:24640
    s_add_u32 m0, s57, 0
    v_mfma_f32_16x16x32_bf16 a[0:3], a[156:159], a[208:211], a[0:3]
    ds_read_b64_tr_b16 a[170:171], v26 offset:25024
    s_add_u32 s35, s36, 0
    v_mfma_f32_16x16x32_bf16 a[4:7], a[156:159], a[212:215], 0
    ds_read_b64_tr_b16 a[172:173], v26 offset:27712
    v_mfma_f32_16x16x32_bf16 a[4:7], a[152:155], a[196:199], a[4:7]
    ds_read_b64_tr_b16 a[174:175], v26 offset:28096
    v_mfma_f32_16x16x32_bf16 a[8:11], a[152:155], a[200:203], 0
    ds_read_b64_tr_b16 a[176:177], v29 offset:24576
    v_mfma_f32_16x16x32_bf16 a[8:11], a[156:159], a[216:219], a[8:11]
    ds_read_b64_tr_b16 a[178:179], v29 offset:24960
    v_mfma_f32_16x16x32_bf16 a[12:15], a[156:159], a[220:223], 0
    ds_read_b64_tr_b16 a[180:181], v29 offset:27648
    v_mfma_f32_16x16x32_bf16 a[12:15], a[152:155], a[204:207], a[12:15]
    ds_read_b64_tr_b16 a[182:183], v29 offset:28032
    s_waitcnt lgkmcnt(10)
    v_mfma_f32_16x16x32_bf16 a[28:31], a[160:163], a[204:207], 0
    ds_read_b64_tr_b16 a[152:153], v26 offset:30720
    v_add_u32 v29, s59, v29
    v_mfma_f32_16x16x32_bf16 a[28:31], a[164:167], a[220:223], a[28:31]
    ds_read_b64_tr_b16 a[154:155], v26 offset:31104
    v_mfma_f32_16x16x32_bf16 a[24:27], a[164:167], a[216:219], 0
    ds_read_b64_tr_b16 a[156:157], v26 offset:33792
    v_mfma_f32_16x16x32_bf16 a[24:27], a[160:163], a[200:203], a[24:27]
    ds_read_b64_tr_b16 a[158:159], v26 offset:34176
    v_mfma_f32_16x16x32_bf16 a[20:23], a[160:163], a[196:199], 0
    s_waitcnt vmcnt(9)
    ds_read_b128 a[236:239], v16 offset:6144
    v_mfma_f32_16x16x32_bf16 a[20:23], a[164:167], a[212:215], a[20:23]
    ds_read_b128 a[252:255], v17 offset:6144
    v_mfma_f32_16x16x32_bf16 a[16:19], a[164:167], a[208:211], 0
    buffer_load_dwordx4 v14, s[4:7], s35 offen lds
    s_add_u32 m0, s57, 1024
    v_mfma_f32_16x16x32_bf16 a[16:19], a[160:163], a[192:195], a[16:19]
    s_add_u32 s35, s36, 0
    s_waitcnt lgkmcnt(10)
    v_mfma_f32_16x16x32_bf16 a[32:35], a[168:171], a[192:195], 0
    ds_read_b64_tr_b16 a[160:161], v26 offset:30752
    v_mfma_f32_16x16x32_bf16 a[32:35], a[172:175], a[208:211], a[32:35]
    ds_read_b64_tr_b16 a[162:163], v26 offset:31136
    v_mfma_f32_16x16x32_bf16 a[36:39], a[172:175], a[212:215], 0
    ds_read_b64_tr_b16 a[164:165], v26 offset:33824
    v_mfma_f32_16x16x32_bf16 a[36:39], a[168:171], a[196:199], a[36:39]
    ds_read_b64_tr_b16 a[166:167], v26 offset:34208
    v_mfma_f32_16x16x32_bf16 a[40:43], a[168:171], a[200:203], 0
    buffer_load_dwordx4 v15, s[4:7], s35 offen lds
    s_add_u32 m0, s57, 2048
    v_mfma_f32_16x16x32_bf16 a[40:43], a[172:175], a[216:219], a[40:43]
    s_add_u32 s35, s36, 20480
    v_mfma_f32_16x16x32_bf16 a[44:47], a[172:175], a[220:223], 0
    v_mfma_f32_16x16x32_bf16 a[44:47], a[168:171], a[204:207], a[44:47]
    buffer_load_dwordx4 v14, s[4:7], s35 offen lds
    s_add_u32 m0, s57, 3072
    s_waitcnt lgkmcnt(10)
    v_mfma_f32_16x16x32_bf16 a[144:147], a[176:179], a[184:187], 0
    s_add_u32 s35, s36, 20480
    v_mfma_f32_16x16x32_bf16 a[144:147], a[180:183], a[184:187], a[144:147]
    s_waitcnt lgkmcnt(6)
    v_mfma_f32_16x16x32_bf16 a[60:63], a[152:155], a[204:207], 0
    ds_read_b64_tr_b16 a[168:169], v26 offset:30784
    v_mfma_f32_16x16x32_bf16 a[60:63], a[156:159], a[220:223], a[60:63]
    ds_read_b64_tr_b16 a[170:171], v26 offset:31168
    v_mfma_f32_16x16x32_bf16 a[56:59], a[156:159], a[216:219], 0
    ds_read_b64_tr_b16 a[172:173], v26 offset:33856
    v_mfma_f32_16x16x32_bf16 a[56:59], a[152:155], a[200:203], a[56:59]
    ds_read_b64_tr_b16 a[174:175], v26 offset:34240
    v_mfma_f32_16x16x32_bf16 a[52:55], a[152:155], a[196:199], 0
    buffer_load_dwordx4 v15, s[4:7], s35 offen lds
    s_add_u32 m0, s57, 4096
    v_mfma_f32_16x16x32_bf16 a[52:55], a[156:159], a[212:215], a[52:55]
    s_add_u32 s35, s36, 40960
    v_mfma_f32_16x16x32_bf16 a[48:51], a[156:159], a[208:211], 0
    v_mfma_f32_16x16x32_bf16 a[48:51], a[152:155], a[192:195], a[48:51]
    buffer_load_dwordx4 v14, s[4:7], s35 offen lds
    s_waitcnt lgkmcnt(0)
    s_barrier
    v_mfma_f32_16x16x32_bf16 a[64:67], a[160:163], a[192:195], 0
    ds_read_b64_tr_b16 a[152:153], v24 offset:0
    s_add_u32 m0, s57, 5120
    v_mfma_f32_16x16x32_bf16 a[64:67], a[164:167], a[208:211], a[64:67]
    ds_read_b64_tr_b16 a[154:155], v24 offset:1536
    s_add_u32 s35, s36, 40960
    v_mfma_f32_16x16x32_bf16 a[68:71], a[164:167], a[212:215], 0
    ds_read_b64_tr_b16 a[156:157], v24 offset:12288
    v_add_u32 v26, s59, v26
    v_mfma_f32_16x16x32_bf16 a[68:71], a[160:163], a[196:199], a[68:71]
    ds_read_b64_tr_b16 a[158:159], v24 offset:13824
    v_mfma_f32_16x16x32_bf16 a[72:75], a[160:163], a[200:203], 0
    buffer_load_dwordx4 v15, s[4:7], s35 offen lds
    s_add_u32 m0, s57, 6144
    v_mfma_f32_16x16x32_bf16 a[72:75], a[164:167], a[216:219], a[72:75]
    s_add_u32 s35, s36, 61440
    v_mfma_f32_16x16x32_bf16 a[76:79], a[164:167], a[220:223], 0
    v_mfma_f32_16x16x32_bf16 a[76:79], a[160:163], a[204:207], a[76:79]
    buffer_load_dwordx4 v14, s[4:7], s35 offen lds
    v_mfma_f32_16x16x32_bf16 a[92:95], a[168:171], a[204:207], 0
    ds_read_b64_tr_b16 a[160:161], v24 offset:8
    s_add_u32 m0, s57, 7168
    v_mfma_f32_16x16x32_bf16 a[92:95], a[172:175], a[220:223], a[92:95]
    ds_read_b64_tr_b16 a[162:163], v24 offset:1544
    s_add_u32 s35, s36, 61440
    v_mfma_f32_16x16x32_bf16 a[88:91], a[172:175], a[216:219], 0
    ds_read_b64_tr_b16 a[164:165], v24 offset:12296
    v_mfma_f32_16x16x32_bf16 a[88:91], a[168:171], a[200:203], a[88:91]
    ds_read_b64_tr_b16 a[166:167], v24 offset:13832
    v_mfma_f32_16x16x32_bf16 a[84:87], a[168:171], a[196:199], 0
    buffer_load_dwordx4 v15, s[4:7], s35 offen lds
    s_add_u32 s25, s25, 1
    v_mfma_f32_16x16x32_bf16 a[84:87], a[172:175], a[212:215], a[84:87]
    s_xor_b32 s36, s25, s24
    s_lshl_b32 s36, s36, 7
    v_mfma_f32_16x16x32_bf16 a[80:83], a[172:175], a[208:211], 0
    v_mfma_f32_16x16x32_bf16 a[80:83], a[168:171], a[192:195], a[80:83]
    s_branch K1_GEMM1
.p2align 5
K1_GEMM:
    s_waitcnt lgkmcnt(4)
    v_mfma_f32_16x16x32_bf16 v[64:67], a[152:155], a[192:195], v[64:67]
    ds_read_b64_tr_b16 a[168:169], v25 offset:0
    s_lshl_b32 s34, s29, 1
    v_mfma_f32_16x16x32_bf16 v[64:67], a[156:159], a[208:211], v[64:67]
    ds_read_b64_tr_b16 a[170:171], v25 offset:1536
    s_add_u32 m0, s39, s34
    v_mfma_f32_16x16x32_bf16 v[72:75], a[156:159], a[212:215], v[72:75]
    ds_read_b64_tr_b16 a[172:173], v25 offset:12288
    v_mfma_f32_16x16x32_bf16 v[72:75], a[152:155], a[196:199], v[72:75]
    ds_read_b64_tr_b16 a[174:175], v25 offset:13824
    v_mfma_f32_16x16x32_bf16 v[80:83], a[152:155], a[200:203], v[80:83]
    ds_read_b64_tr_b16 a[176:177], v27 offset:0
    v_mfma_f32_16x16x32_bf16 v[80:83], a[156:159], a[216:219], v[80:83]
    ds_read_b64_tr_b16 a[178:179], v27 offset:1536
    v_mfma_f32_16x16x32_bf16 v[88:91], a[156:159], a[220:223], v[88:91]
    ds_read_b64_tr_b16 a[180:181], v27 offset:12288
    v_mfma_f32_16x16x32_bf16 v[88:91], a[152:155], a[204:207], v[88:91]
    ds_read_b64_tr_b16 a[182:183], v27 offset:13824
    v_mfma_f32_16x16x32_bf16 a[96:99], a[148:151], a[192:195], a[96:99]
    buffer_load_dwordx4 v18, s[8:11], s37 offen offset:0 nt lds
    v_mfma_f32_16x16x32_bf16 a[112:115], a[192:195], a[192:195], a[112:115]
    s_waitcnt lgkmcnt(8)
    v_mfma_f32_16x16x32_bf16 v[92:95], a[160:163], a[204:207], v[92:95]
    ds_read_b64_tr_b16 a[152:153], v25 offset:8
    s_add_u32 s33, s33, 36864
    v_mfma_f32_16x16x32_bf16 v[92:95], a[164:167], a[220:223], v[92:95]
    ds_read_b64_tr_b16 a[154:155], v25 offset:1544
    v_mfma_f32_16x16x32_bf16 v[84:87], a[164:167], a[216:219], v[84:87]
    ds_read_b64_tr_b16 a[156:157], v25 offset:12296
    v_mfma_f32_16x16x32_bf16 v[84:87], a[160:163], a[200:203], v[84:87]
    ds_read_b64_tr_b16 a[158:159], v25 offset:13832
    v_mfma_f32_16x16x32_bf16 v[76:79], a[160:163], a[196:199], v[76:79]
    s_cmp_eq_u32 s33, 110592
    s_cselect_b32 s59, s56, s55
    v_mfma_f32_16x16x32_bf16 v[76:79], a[164:167], a[212:215], v[76:79]
    buffer_load_dwordx4 v19, s[8:11], s37 offen offset:1024 nt lds
    v_mfma_f32_16x16x32_bf16 v[68:71], a[164:167], a[208:211], v[68:71]
    s_cmp_eq_u32 s33, 110592
    s_cselect_b32 s33, 0, s33
    v_mfma_f32_16x16x32_bf16 v[68:71], a[160:163], a[192:195], v[68:71]
    v_mfma_f32_16x16x32_bf16 a[100:103], a[148:151], a[196:199], a[100:103]
    v_mfma_f32_16x16x32_bf16 a[116:119], a[196:199], a[196:199], a[116:119]
    s_waitcnt lgkmcnt(8)
    v_mfma_f32_16x16x32_bf16 v[96:99], a[168:171], a[192:195], v[96:99]
    ds_read_b64_tr_b16 a[160:161], v24 offset:128
    v_mfma_f32_16x16x32_bf16 v[96:99], a[172:175], a[208:211], v[96:99]
    ds_read_b64_tr_b16 a[162:163], v24 offset:1664
    v_mfma_f32_16x16x32_bf16 v[104:107], a[172:175], a[212:215], v[104:107]
    ds_read_b64_tr_b16 a[164:165], v24 offset:12416
    v_mfma_f32_16x16x32_bf16 v[104:107], a[168:171], a[196:199], v[104:107]
    ds_read_b64_tr_b16 a[166:167], v24 offset:13952
    v_mfma_f32_16x16x32_bf16 v[112:115], a[168:171], a[200:203], v[112:115]
    buffer_load_dwordx4 v20, s[8:11], s37 offen offset:2048 nt lds
    s_add_u32 m0, m0, 3072
    v_mfma_f32_16x16x32_bf16 v[112:115], a[172:175], a[216:219], v[112:115]
    s_add_u32 s35, s37, 98304
    v_mfma_f32_16x16x32_bf16 v[120:123], a[172:175], a[220:223], v[120:123]
    v_mfma_f32_16x16x32_bf16 v[120:123], a[168:171], a[204:207], v[120:123]
    s_waitcnt lgkmcnt(8)
    v_mfma_f32_16x16x32_bf16 a[128:131], a[176:179], a[184:187], a[128:131]
    v_mfma_f32_16x16x32_bf16 a[128:131], a[180:183], a[184:187], a[128:131]
    s_waitcnt lgkmcnt(4)
    v_mfma_f32_16x16x32_bf16 v[124:127], a[152:155], a[204:207], v[124:127]
    ds_read_b64_tr_b16 a[168:169], v24 offset:136
    v_mfma_f32_16x16x32_bf16 v[124:127], a[156:159], a[220:223], v[124:127]
    ds_read_b64_tr_b16 a[170:171], v24 offset:1672
    v_mfma_f32_16x16x32_bf16 v[116:119], a[156:159], a[216:219], v[116:119]
    ds_read_b64_tr_b16 a[172:173], v24 offset:12424
    v_mfma_f32_16x16x32_bf16 v[116:119], a[152:155], a[200:203], v[116:119]
    ds_read_b64_tr_b16 a[174:175], v24 offset:13960
    v_mfma_f32_16x16x32_bf16 v[108:111], a[152:155], a[196:199], v[108:111]
    ds_read_b64_tr_b16 a[176:177], v27 offset:128
    v_mfma_f32_16x16x32_bf16 v[108:111], a[156:159], a[212:215], v[108:111]
    ds_read_b64_tr_b16 a[178:179], v27 offset:1664
    v_mfma_f32_16x16x32_bf16 v[100:103], a[156:159], a[208:211], v[100:103]
    ds_read_b64_tr_b16 a[180:181], v27 offset:12416
    v_mfma_f32_16x16x32_bf16 v[100:103], a[152:155], a[192:195], v[100:103]
    ds_read_b64_tr_b16 a[182:183], v27 offset:13952
    v_mfma_f32_16x16x32_bf16 a[104:107], a[148:151], a[200:203], a[104:107]
    buffer_load_dwordx4 v18, s[8:11], s35 offen offset:0 nt lds
    v_mfma_f32_16x16x32_bf16 a[120:123], a[200:203], a[200:203], a[120:123]
    s_waitcnt lgkmcnt(8)
    v_mfma_f32_16x16x32_bf16 v[128:131], a[160:163], a[192:195], v[128:131]
    ds_read_b64_tr_b16 a[152:153], v25 offset:128
    v_mfma_f32_16x16x32_bf16 v[128:131], a[164:167], a[208:211], v[128:131]
    ds_read_b64_tr_b16 a[154:155], v25 offset:1664
    v_mfma_f32_16x16x32_bf16 v[136:139], a[164:167], a[212:215], v[136:139]
    ds_read_b64_tr_b16 a[156:157], v25 offset:12416
    v_mfma_f32_16x16x32_bf16 v[136:139], a[160:163], a[196:199], v[136:139]
    ds_read_b64_tr_b16 a[158:159], v25 offset:13952
    v_mfma_f32_16x16x32_bf16 v[144:147], a[160:163], a[200:203], v[144:147]
    v_mfma_f32_16x16x32_bf16 v[144:147], a[164:167], a[216:219], v[144:147]
    buffer_load_dwordx4 v19, s[8:11], s35 offen offset:1024 nt lds
    v_mfma_f32_16x16x32_bf16 v[152:155], a[164:167], a[220:223], v[152:155]
    v_mfma_f32_16x16x32_bf16 v[152:155], a[160:163], a[204:207], v[152:155]
    v_mfma_f32_16x16x32_bf16 a[108:111], a[148:151], a[204:207], a[108:111]
    v_mfma_f32_16x16x32_bf16 a[124:127], a[204:207], a[204:207], a[124:127]
    s_waitcnt lgkmcnt(8)
    v_mfma_f32_16x16x32_bf16 v[156:159], a[168:171], a[204:207], v[156:159]
    ds_read_b64_tr_b16 a[160:161], v25 offset:136
    v_mfma_f32_16x16x32_bf16 v[156:159], a[172:175], a[220:223], v[156:159]
    ds_read_b64_tr_b16 a[162:163], v25 offset:1672
    v_mfma_f32_16x16x32_bf16 v[148:151], a[172:175], a[216:219], v[148:151]
    ds_read_b64_tr_b16 a[164:165], v25 offset:12424
    v_mfma_f32_16x16x32_bf16 v[148:151], a[168:171], a[200:203], v[148:151]
    ds_read_b64_tr_b16 a[166:167], v25 offset:13960
    v_mfma_f32_16x16x32_bf16 v[140:143], a[168:171], a[196:199], v[140:143]
    s_waitcnt vmcnt(11)
    ds_read_b128 a[224:227], v16 offset:0
    v_mfma_f32_16x16x32_bf16 v[140:143], a[172:175], a[212:215], v[140:143]
    ds_read_b128 a[240:243], v17 offset:0
    v_mfma_f32_16x16x32_bf16 v[132:135], a[172:175], a[208:211], v[132:135]
    buffer_load_dwordx4 v20, s[8:11], s35 offen offset:2048 nt lds
    s_add_u32 s34, s29, 24576
    v_mfma_f32_16x16x32_bf16 v[132:135], a[168:171], a[192:195], v[132:135]
    s_add_u32 m0, s39, s34
    s_waitcnt lgkmcnt(10)
    v_mfma_f32_16x16x32_bf16 a[132:135], a[176:179], a[184:187], a[132:135]
    v_mfma_f32_16x16x32_bf16 a[132:135], a[180:183], a[184:187], a[132:135]
    s_waitcnt lgkmcnt(6)
    v_mfma_f32_16x16x32_bf16 v[160:163], a[152:155], a[192:195], v[160:163]
    ds_read_b64_tr_b16 a[168:169], v24 offset:256
    v_mfma_f32_16x16x32_bf16 v[160:163], a[156:159], a[208:211], v[160:163]
    ds_read_b64_tr_b16 a[170:171], v24 offset:1792
    v_mfma_f32_16x16x32_bf16 v[168:171], a[156:159], a[212:215], v[168:171]
    ds_read_b64_tr_b16 a[172:173], v24 offset:12544
    v_mfma_f32_16x16x32_bf16 v[168:171], a[152:155], a[196:199], v[168:171]
    ds_read_b64_tr_b16 a[174:175], v24 offset:14080
    v_mfma_f32_16x16x32_bf16 v[176:179], a[152:155], a[200:203], v[176:179]
    ds_read_b64_tr_b16 a[176:177], v27 offset:256
    v_mfma_f32_16x16x32_bf16 v[176:179], a[156:159], a[216:219], v[176:179]
    ds_read_b64_tr_b16 a[178:179], v27 offset:1792
    v_mfma_f32_16x16x32_bf16 v[184:187], a[156:159], a[220:223], v[184:187]
    ds_read_b64_tr_b16 a[180:181], v27 offset:12544
    v_mfma_f32_16x16x32_bf16 v[184:187], a[152:155], a[204:207], v[184:187]
    ds_read_b64_tr_b16 a[182:183], v27 offset:14080
    v_mfma_f32_16x16x32_bf16 a[96:99], a[148:151], a[208:211], a[96:99]
    buffer_load_dwordx4 v21, s[12:15], s38 offen offset:0 lds
    v_mfma_f32_16x16x32_bf16 a[112:115], a[208:211], a[208:211], a[112:115]
    s_waitcnt lgkmcnt(10)
    v_mfma_f32_16x16x32_bf16 v[188:191], a[160:163], a[204:207], v[188:191]
    ds_read_b64_tr_b16 a[152:153], v24 offset:264
    v_add_u32 v27, s59, v27
    v_mfma_f32_16x16x32_bf16 v[188:191], a[164:167], a[220:223], v[188:191]
    ds_read_b64_tr_b16 a[154:155], v24 offset:1800
    v_mfma_f32_16x16x32_bf16 v[180:183], a[164:167], a[216:219], v[180:183]
    ds_read_b64_tr_b16 a[156:157], v24 offset:12552
    v_mfma_f32_16x16x32_bf16 v[180:183], a[160:163], a[200:203], v[180:183]
    ds_read_b64_tr_b16 a[158:159], v24 offset:14088
    v_mfma_f32_16x16x32_bf16 v[172:175], a[160:163], a[196:199], v[172:175]
    s_waitcnt vmcnt(11)
    ds_read_b128 a[228:231], v16 offset:2048
    v_mfma_f32_16x16x32_bf16 v[172:175], a[164:167], a[212:215], v[172:175]
    ds_read_b128 a[244:247], v17 offset:2048
    v_mfma_f32_16x16x32_bf16 v[164:167], a[164:167], a[208:211], v[164:167]
    buffer_load_dwordx4 v22, s[12:15], s38 offen offset:1024 lds
    v_mfma_f32_16x16x32_bf16 v[164:167], a[160:163], a[192:195], v[164:167]
    v_mfma_f32_16x16x32_bf16 a[100:103], a[148:151], a[212:215], a[100:103]
    v_mfma_f32_16x16x32_bf16 a[116:119], a[212:215], a[212:215], a[116:119]
    s_waitcnt lgkmcnt(10)
    v_mfma_f32_16x16x32_bf16 v[192:195], a[168:171], a[192:195], v[192:195]
    ds_read_b64_tr_b16 a[160:161], v25 offset:256
    v_mfma_f32_16x16x32_bf16 v[192:195], a[172:175], a[208:211], v[192:195]
    ds_read_b64_tr_b16 a[162:163], v25 offset:1792
    v_mfma_f32_16x16x32_bf16 v[200:203], a[172:175], a[212:215], v[200:203]
    ds_read_b64_tr_b16 a[164:165], v25 offset:12544
    v_mfma_f32_16x16x32_bf16 v[200:203], a[168:171], a[196:199], v[200:203]
    ds_read_b64_tr_b16 a[166:167], v25 offset:14080
    v_mfma_f32_16x16x32_bf16 v[208:211], a[168:171], a[200:203], v[208:211]
    buffer_load_dwordx4 v23, s[12:15], s38 offen offset:2048 lds
    s_add_u32 s26, s26, 1
    v_mfma_f32_16x16x32_bf16 v[208:211], a[172:175], a[216:219], v[208:211]
    s_xor_b32 s38, s26, s24
    s_mul_i32 s38, s38, 196608
    v_mfma_f32_16x16x32_bf16 v[216:219], a[172:175], a[220:223], v[216:219]
    s_lshl_b32 s37, s38, 2
    s_add_u32 s39, s39, 36864
    v_mfma_f32_16x16x32_bf16 v[216:219], a[168:171], a[204:207], v[216:219]
    s_cmp_eq_u32 s39, 110592
    s_cselect_b32 s39, 0, s39
    s_waitcnt lgkmcnt(10)
    v_mfma_f32_16x16x32_bf16 a[136:139], a[176:179], a[184:187], a[136:139]
    s_add_u32 m0, s57, 0
    s_add_u32 s35, s36, 0
    v_mfma_f32_16x16x32_bf16 a[136:139], a[180:183], a[184:187], a[136:139]
    buffer_load_dwordx4 v14, s[4:7], s35 offen lds
    s_waitcnt lgkmcnt(6)
    v_mfma_f32_16x16x32_bf16 v[220:223], a[152:155], a[204:207], v[220:223]
    ds_read_b64_tr_b16 a[168:169], v25 offset:264
    s_add_u32 m0, s57, 1024
    v_mfma_f32_16x16x32_bf16 v[220:223], a[156:159], a[220:223], v[220:223]
    ds_read_b64_tr_b16 a[170:171], v25 offset:1800
    s_add_u32 s35, s36, 0
    v_mfma_f32_16x16x32_bf16 v[212:215], a[156:159], a[216:219], v[212:215]
    ds_read_b64_tr_b16 a[172:173], v25 offset:12552
    v_mfma_f32_16x16x32_bf16 v[212:215], a[152:155], a[200:203], v[212:215]
    ds_read_b64_tr_b16 a[174:175], v25 offset:14088
    v_mfma_f32_16x16x32_bf16 v[204:207], a[152:155], a[196:199], v[204:207]
    ds_read_b64_tr_b16 a[176:177], v28 offset:24576
    v_mfma_f32_16x16x32_bf16 v[204:207], a[156:159], a[212:215], v[204:207]
    ds_read_b64_tr_b16 a[178:179], v28 offset:24960
    v_mfma_f32_16x16x32_bf16 v[196:199], a[156:159], a[208:211], v[196:199]
    ds_read_b64_tr_b16 a[180:181], v28 offset:27648
    v_mfma_f32_16x16x32_bf16 v[196:199], a[152:155], a[192:195], v[196:199]
    ds_read_b64_tr_b16 a[182:183], v28 offset:28032
    v_mfma_f32_16x16x32_bf16 a[104:107], a[148:151], a[216:219], a[104:107]
    s_waitcnt vmcnt(12)
    ds_read_b128 a[232:235], v16 offset:4096
    v_mfma_f32_16x16x32_bf16 a[120:123], a[216:219], a[216:219], a[120:123]
    ds_read_b128 a[248:251], v17 offset:4096
    s_waitcnt lgkmcnt(10)
    v_mfma_f32_16x16x32_bf16 v[224:227], a[160:163], a[192:195], v[224:227]
    ds_read_b64_tr_b16 a[152:153], v26 offset:24576
    v_add_u32 v24, s59, v24
    v_mfma_f32_16x16x32_bf16 v[224:227], a[164:167], a[208:211], v[224:227]
    ds_read_b64_tr_b16 a[154:155], v26 offset:24960
    v_add_u32 v25, s59, v25
    v_mfma_f32_16x16x32_bf16 v[232:235], a[164:167], a[212:215], v[232:235]
    ds_read_b64_tr_b16 a[156:157], v26 offset:27648
    v_add_u32 v28, s59, v28
    v_mfma_f32_16x16x32_bf16 v[232:235], a[160:163], a[196:199], v[232:235]
    ds_read_b64_tr_b16 a[158:159], v26 offset:28032
    v_mfma_f32_16x16x32_bf16 v[240:243], a[160:163], a[200:203], v[240:243]
    buffer_load_dwordx4 v15, s[4:7], s35 offen lds
    s_add_u32 m0, s57, 2048
    v_mfma_f32_16x16x32_bf16 v[240:243], a[164:167], a[216:219], v[240:243]
    s_add_u32 s35, s36, 20480
    v_mfma_f32_16x16x32_bf16 v[248:251], a[164:167], a[220:223], v[248:251]
    v_mfma_f32_16x16x32_bf16 v[248:251], a[160:163], a[204:207], v[248:251]
    v_mfma_f32_16x16x32_bf16 a[108:111], a[148:151], a[220:223], a[108:111]
    v_mfma_f32_16x16x32_bf16 a[124:127], a[220:223], a[220:223], a[124:127]
    buffer_load_dwordx4 v14, s[4:7], s35 offen lds
    s_waitcnt lgkmcnt(10)
    v_mfma_f32_16x16x32_bf16 v[252:255], a[168:171], a[204:207], v[252:255]
    ds_read_b64_tr_b16 a[160:161], v26 offset:24608
    s_add_u32 m0, s57, 3072
    v_mfma_f32_16x16x32_bf16 v[252:255], a[172:175], a[220:223], v[252:255]
    ds_read_b64_tr_b16 a[162:163], v26 offset:24992
    s_add_u32 s35, s36, 20480
    v_mfma_f32_16x16x32_bf16 v[244:247], a[172:175], a[216:219], v[244:247]
    ds_read_b64_tr_b16 a[164:165], v26 offset:27680
    v_mfma_f32_16x16x32_bf16 v[244:247], a[168:171], a[200:203], v[244:247]
    ds_read_b64_tr_b16 a[166:167], v26 offset:28064
    v_mfma_f32_16x16x32_bf16 v[236:239], a[168:171], a[196:199], v[236:239]
    s_waitcnt vmcnt(12)
    ds_read_b128 a[236:239], v16 offset:6144
    v_mfma_f32_16x16x32_bf16 v[236:239], a[172:175], a[212:215], v[236:239]
    ds_read_b128 a[252:255], v17 offset:6144
    v_mfma_f32_16x16x32_bf16 v[228:231], a[172:175], a[208:211], v[228:231]
    buffer_load_dwordx4 v15, s[4:7], s35 offen lds
    v_mfma_f32_16x16x32_bf16 v[228:231], a[168:171], a[192:195], v[228:231]
    s_waitcnt lgkmcnt(12)
    v_mfma_f32_16x16x32_bf16 a[140:143], a[176:179], a[184:187], a[140:143]
    v_mfma_f32_16x16x32_bf16 a[140:143], a[180:183], a[184:187], a[140:143]
    s_waitcnt lgkmcnt(6)
    v_mfma_f32_16x16x32_bf16 a[0:3], a[152:155], a[192:195], a[0:3]
    ds_read_b64_tr_b16 a[168:169], v26 offset:24640
    s_add_u32 m0, s57, 4096
    v_mfma_f32_16x16x32_bf16 a[0:3], a[156:159], a[208:211], a[0:3]
    ds_read_b64_tr_b16 a[170:171], v26 offset:25024
    s_add_u32 s35, s36, 40960
    v_mfma_f32_16x16x32_bf16 a[4:7], a[156:159], a[212:215], a[4:7]
    ds_read_b64_tr_b16 a[172:173], v26 offset:27712
    v_mfma_f32_16x16x32_bf16 a[4:7], a[152:155], a[196:199], a[4:7]
    ds_read_b64_tr_b16 a[174:175], v26 offset:28096
    v_mfma_f32_16x16x32_bf16 a[8:11], a[152:155], a[200:203], a[8:11]
    ds_read_b64_tr_b16 a[176:177], v29 offset:24576
    v_mfma_f32_16x16x32_bf16 a[8:11], a[156:159], a[216:219], a[8:11]
    ds_read_b64_tr_b16 a[178:179], v29 offset:24960
    v_mfma_f32_16x16x32_bf16 a[12:15], a[156:159], a[220:223], a[12:15]
    ds_read_b64_tr_b16 a[180:181], v29 offset:27648
    v_mfma_f32_16x16x32_bf16 a[12:15], a[152:155], a[204:207], a[12:15]
    ds_read_b64_tr_b16 a[182:183], v29 offset:28032
    s_waitcnt lgkmcnt(10)
    v_mfma_f32_16x16x32_bf16 a[28:31], a[160:163], a[204:207], a[28:31]
    ds_read_b64_tr_b16 a[152:153], v26 offset:30720
    v_add_u32 v29, s59, v29
    v_mfma_f32_16x16x32_bf16 a[28:31], a[164:167], a[220:223], a[28:31]
    ds_read_b64_tr_b16 a[154:155], v26 offset:31104
    v_mfma_f32_16x16x32_bf16 a[24:27], a[164:167], a[216:219], a[24:27]
    ds_read_b64_tr_b16 a[156:157], v26 offset:33792
    v_mfma_f32_16x16x32_bf16 a[24:27], a[160:163], a[200:203], a[24:27]
    ds_read_b64_tr_b16 a[158:159], v26 offset:34176
    v_mfma_f32_16x16x32_bf16 a[20:23], a[160:163], a[196:199], a[20:23]
    buffer_load_dwordx4 v14, s[4:7], s35 offen lds
    s_add_u32 m0, s57, 5120
    v_mfma_f32_16x16x32_bf16 a[20:23], a[164:167], a[212:215], a[20:23]
    s_add_u32 s35, s36, 40960
    v_mfma_f32_16x16x32_bf16 a[16:19], a[164:167], a[208:211], a[16:19]
    v_mfma_f32_16x16x32_bf16 a[16:19], a[160:163], a[192:195], a[16:19]
    s_waitcnt lgkmcnt(8)
    v_mfma_f32_16x16x32_bf16 a[32:35], a[168:171], a[192:195], a[32:35]
    ds_read_b64_tr_b16 a[160:161], v26 offset:30752
    v_mfma_f32_16x16x32_bf16 a[32:35], a[172:175], a[208:211], a[32:35]
    ds_read_b64_tr_b16 a[162:163], v26 offset:31136
    v_mfma_f32_16x16x32_bf16 a[36:39], a[172:175], a[212:215], a[36:39]
    ds_read_b64_tr_b16 a[164:165], v26 offset:33824
    v_mfma_f32_16x16x32_bf16 a[36:39], a[168:171], a[196:199], a[36:39]
    ds_read_b64_tr_b16 a[166:167], v26 offset:34208
    v_mfma_f32_16x16x32_bf16 a[40:43], a[168:171], a[200:203], a[40:43]
    buffer_load_dwordx4 v15, s[4:7], s35 offen lds
    s_add_u32 m0, s57, 6144
    v_mfma_f32_16x16x32_bf16 a[40:43], a[172:175], a[216:219], a[40:43]
    s_add_u32 s35, s36, 61440
    v_mfma_f32_16x16x32_bf16 a[44:47], a[172:175], a[220:223], a[44:47]
    v_mfma_f32_16x16x32_bf16 a[44:47], a[168:171], a[204:207], a[44:47]
    s_waitcnt lgkmcnt(8)
    v_mfma_f32_16x16x32_bf16 a[144:147], a[176:179], a[184:187], a[144:147]
    v_mfma_f32_16x16x32_bf16 a[144:147], a[180:183], a[184:187], a[144:147]
    buffer_load_dwordx4 v14, s[4:7], s35 offen lds
    s_waitcnt lgkmcnt(4)
    v_mfma_f32_16x16x32_bf16 a[60:63], a[152:155], a[204:207], a[60:63]
    ds_read_b64_tr_b16 a[168:169], v26 offset:30784
    s_add_u32 m0, s57, 7168
    v_mfma_f32_16x16x32_bf16 a[60:63], a[156:159], a[220:223], a[60:63]
    ds_read_b64_tr_b16 a[170:171], v26 offset:31168
    s_add_u32 s35, s36, 61440
    v_mfma_f32_16x16x32_bf16 a[56:59], a[156:159], a[216:219], a[56:59]
    ds_read_b64_tr_b16 a[172:173], v26 offset:33856
    v_mfma_f32_16x16x32_bf16 a[56:59], a[152:155], a[200:203], a[56:59]
    ds_read_b64_tr_b16 a[174:175], v26 offset:34240
    v_mfma_f32_16x16x32_bf16 a[52:55], a[152:155], a[196:199], a[52:55]
    buffer_load_dwordx4 v15, s[4:7], s35 offen lds
    s_add_u32 s25, s25, 1
    v_mfma_f32_16x16x32_bf16 a[52:55], a[156:159], a[212:215], a[52:55]
    s_xor_b32 s36, s25, s24
    s_lshl_b32 s36, s36, 7
    v_mfma_f32_16x16x32_bf16 a[48:51], a[156:159], a[208:211], a[48:51]
    v_mfma_f32_16x16x32_bf16 a[48:51], a[152:155], a[192:195], a[48:51]
    s_waitcnt lgkmcnt(0)
    s_barrier
    v_mfma_f32_16x16x32_bf16 a[64:67], a[160:163], a[192:195], a[64:67]
    ds_read_b64_tr_b16 a[152:153], v24 offset:0
    v_add_u32 v26, s59, v26
    v_mfma_f32_16x16x32_bf16 a[64:67], a[164:167], a[208:211], a[64:67]
    ds_read_b64_tr_b16 a[154:155], v24 offset:1536
    v_mfma_f32_16x16x32_bf16 a[68:71], a[164:167], a[212:215], a[68:71]
    ds_read_b64_tr_b16 a[156:157], v24 offset:12288
    v_mfma_f32_16x16x32_bf16 a[68:71], a[160:163], a[196:199], a[68:71]
    ds_read_b64_tr_b16 a[158:159], v24 offset:13824
    v_mfma_f32_16x16x32_bf16 a[72:75], a[160:163], a[200:203], a[72:75]
    v_mfma_f32_16x16x32_bf16 a[72:75], a[164:167], a[216:219], a[72:75]
    v_mfma_f32_16x16x32_bf16 a[76:79], a[164:167], a[220:223], a[76:79]
    v_mfma_f32_16x16x32_bf16 a[76:79], a[160:163], a[204:207], a[76:79]
    v_mfma_f32_16x16x32_bf16 a[92:95], a[168:171], a[204:207], a[92:95]
    ds_read_b64_tr_b16 a[160:161], v24 offset:8
    v_mfma_f32_16x16x32_bf16 a[92:95], a[172:175], a[220:223], a[92:95]
    ds_read_b64_tr_b16 a[162:163], v24 offset:1544
    v_mfma_f32_16x16x32_bf16 a[88:91], a[172:175], a[216:219], a[88:91]
    ds_read_b64_tr_b16 a[164:165], v24 offset:12296
    v_mfma_f32_16x16x32_bf16 a[88:91], a[168:171], a[200:203], a[88:91]
    ds_read_b64_tr_b16 a[166:167], v24 offset:13832
    v_mfma_f32_16x16x32_bf16 a[84:87], a[168:171], a[196:199], a[84:87]
    v_mfma_f32_16x16x32_bf16 a[84:87], a[172:175], a[212:215], a[84:87]
    v_mfma_f32_16x16x32_bf16 a[80:83], a[172:175], a[208:211], a[80:83]
    v_mfma_f32_16x16x32_bf16 a[80:83], a[168:171], a[192:195], a[80:83]
K1_GEMM1:
    s_waitcnt lgkmcnt(4)
    v_mfma_f32_16x16x32_bf16 v[64:67], a[152:155], a[224:227], v[64:67]
    ds_read_b64_tr_b16 a[168:169], v25 offset:0
    s_lshl_b32 s34, s29, 1
    v_mfma_f32_16x16x32_bf16 v[64:67], a[156:159], a[240:243], v[64:67]
    ds_read_b64_tr_b16 a[170:171], v25 offset:1536
    s_add_u32 m0, s39, s34
    v_mfma_f32_16x16x32_bf16 v[72:75], a[156:159], a[244:247], v[72:75]
    ds_read_b64_tr_b16 a[172:173], v25 offset:12288
    v_mfma_f32_16x16x32_bf16 v[72:75], a[152:155], a[228:231], v[72:75]
    ds_read_b64_tr_b16 a[174:175], v25 offset:13824
    v_mfma_f32_16x16x32_bf16 v[80:83], a[152:155], a[232:235], v[80:83]
    ds_read_b64_tr_b16 a[176:177], v27 offset:0
    v_mfma_f32_16x16x32_bf16 v[80:83], a[156:159], a[248:251], v[80:83]
    ds_read_b64_tr_b16 a[178:179], v27 offset:1536
    v_mfma_f32_16x16x32_bf16 v[88:91], a[156:159], a[252:255], v[88:91]
    ds_read_b64_tr_b16 a[180:181], v27 offset:12288
    v_mfma_f32_16x16x32_bf16 v[88:91], a[152:155], a[236:239], v[88:91]
    ds_read_b64_tr_b16 a[182:183], v27 offset:13824
    v_mfma_f32_16x16x32_bf16 a[96:99], a[148:151], a[224:227], a[96:99]
    buffer_load_dwordx4 v18, s[8:11], s37 offen offset:0 nt lds
    v_mfma_f32_16x16x32_bf16 a[112:115], a[224:227], a[224:227], a[112:115]
    s_waitcnt lgkmcnt(8)
    v_mfma_f32_16x16x32_bf16 v[92:95], a[160:163], a[236:239], v[92:95]
    ds_read_b64_tr_b16 a[152:153], v25 offset:8
    s_add_u32 s33, s33, 36864
    v_mfma_f32_16x16x32_bf16 v[92:95], a[164:167], a[252:255], v[92:95]
    ds_read_b64_tr_b16 a[154:155], v25 offset:1544
    v_mfma_f32_16x16x32_bf16 v[84:87], a[164:167], a[248:251], v[84:87]
    ds_read_b64_tr_b16 a[156:157], v25 offset:12296
    v_mfma_f32_16x16x32_bf16 v[84:87], a[160:163], a[232:235], v[84:87]
    ds_read_b64_tr_b16 a[158:159], v25 offset:13832
    v_mfma_f32_16x16x32_bf16 v[76:79], a[160:163], a[228:231], v[76:79]
    s_cmp_eq_u32 s33, 110592
    s_cselect_b32 s59, s56, s55
    v_mfma_f32_16x16x32_bf16 v[76:79], a[164:167], a[244:247], v[76:79]
    buffer_load_dwordx4 v19, s[8:11], s37 offen offset:1024 nt lds
    v_mfma_f32_16x16x32_bf16 v[68:71], a[164:167], a[240:243], v[68:71]
    s_cmp_eq_u32 s33, 110592
    s_cselect_b32 s33, 0, s33
    v_mfma_f32_16x16x32_bf16 v[68:71], a[160:163], a[224:227], v[68:71]
    v_mfma_f32_16x16x32_bf16 a[100:103], a[148:151], a[228:231], a[100:103]
    v_mfma_f32_16x16x32_bf16 a[116:119], a[228:231], a[228:231], a[116:119]
    s_waitcnt lgkmcnt(8)
    v_mfma_f32_16x16x32_bf16 v[96:99], a[168:171], a[224:227], v[96:99]
    ds_read_b64_tr_b16 a[160:161], v24 offset:128
    v_mfma_f32_16x16x32_bf16 v[96:99], a[172:175], a[240:243], v[96:99]
    ds_read_b64_tr_b16 a[162:163], v24 offset:1664
    v_mfma_f32_16x16x32_bf16 v[104:107], a[172:175], a[244:247], v[104:107]
    ds_read_b64_tr_b16 a[164:165], v24 offset:12416
    v_mfma_f32_16x16x32_bf16 v[104:107], a[168:171], a[228:231], v[104:107]
    ds_read_b64_tr_b16 a[166:167], v24 offset:13952
    v_mfma_f32_16x16x32_bf16 v[112:115], a[168:171], a[232:235], v[112:115]
    buffer_load_dwordx4 v20, s[8:11], s37 offen offset:2048 nt lds
    s_add_u32 m0, m0, 3072
    v_mfma_f32_16x16x32_bf16 v[112:115], a[172:175], a[248:251], v[112:115]
    s_add_u32 s35, s37, 98304
    v_mfma_f32_16x16x32_bf16 v[120:123], a[172:175], a[252:255], v[120:123]
    v_mfma_f32_16x16x32_bf16 v[120:123], a[168:171], a[236:239], v[120:123]
    s_waitcnt lgkmcnt(8)
    v_mfma_f32_16x16x32_bf16 a[128:131], a[176:179], a[184:187], a[128:131]
    v_mfma_f32_16x16x32_bf16 a[128:131], a[180:183], a[184:187], a[128:131]
    s_waitcnt lgkmcnt(4)
    v_mfma_f32_16x16x32_bf16 v[124:127], a[152:155], a[236:239], v[124:127]
    ds_read_b64_tr_b16 a[168:169], v24 offset:136
    v_mfma_f32_16x16x32_bf16 v[124:127], a[156:159], a[252:255], v[124:127]
    ds_read_b64_tr_b16 a[170:171], v24 offset:1672
    v_mfma_f32_16x16x32_bf16 v[116:119], a[156:159], a[248:251], v[116:119]
    ds_read_b64_tr_b16 a[172:173], v24 offset:12424
    v_mfma_f32_16x16x32_bf16 v[116:119], a[152:155], a[232:235], v[116:119]
    ds_read_b64_tr_b16 a[174:175], v24 offset:13960
    v_mfma_f32_16x16x32_bf16 v[108:111], a[152:155], a[228:231], v[108:111]
    ds_read_b64_tr_b16 a[176:177], v27 offset:128
    v_mfma_f32_16x16x32_bf16 v[108:111], a[156:159], a[244:247], v[108:111]
    ds_read_b64_tr_b16 a[178:179], v27 offset:1664
    v_mfma_f32_16x16x32_bf16 v[100:103], a[156:159], a[240:243], v[100:103]
    ds_read_b64_tr_b16 a[180:181], v27 offset:12416
    v_mfma_f32_16x16x32_bf16 v[100:103], a[152:155], a[224:227], v[100:103]
    ds_read_b64_tr_b16 a[182:183], v27 offset:13952
    v_mfma_f32_16x16x32_bf16 a[104:107], a[148:151], a[232:235], a[104:107]
    buffer_load_dwordx4 v18, s[8:11], s35 offen offset:0 nt lds
    v_mfma_f32_16x16x32_bf16 a[120:123], a[232:235], a[232:235], a[120:123]
    s_waitcnt lgkmcnt(8)
    v_mfma_f32_16x16x32_bf16 v[128:131], a[160:163], a[224:227], v[128:131]
    ds_read_b64_tr_b16 a[152:153], v25 offset:128
    v_mfma_f32_16x16x32_bf16 v[128:131], a[164:167], a[240:243], v[128:131]
    ds_read_b64_tr_b16 a[154:155], v25 offset:1664
    v_mfma_f32_16x16x32_bf16 v[136:139], a[164:167], a[244:247], v[136:139]
    ds_read_b64_tr_b16 a[156:157], v25 offset:12416
    v_mfma_f32_16x16x32_bf16 v[136:139], a[160:163], a[228:231], v[136:139]
    ds_read_b64_tr_b16 a[158:159], v25 offset:13952
    v_mfma_f32_16x16x32_bf16 v[144:147], a[160:163], a[232:235], v[144:147]
    v_mfma_f32_16x16x32_bf16 v[144:147], a[164:167], a[248:251], v[144:147]
    buffer_load_dwordx4 v19, s[8:11], s35 offen offset:1024 nt lds
    v_mfma_f32_16x16x32_bf16 v[152:155], a[164:167], a[252:255], v[152:155]
    v_mfma_f32_16x16x32_bf16 v[152:155], a[160:163], a[236:239], v[152:155]
    v_mfma_f32_16x16x32_bf16 a[108:111], a[148:151], a[236:239], a[108:111]
    v_mfma_f32_16x16x32_bf16 a[124:127], a[236:239], a[236:239], a[124:127]
    s_waitcnt lgkmcnt(8)
    v_mfma_f32_16x16x32_bf16 v[156:159], a[168:171], a[236:239], v[156:159]
    ds_read_b64_tr_b16 a[160:161], v25 offset:136
    v_mfma_f32_16x16x32_bf16 v[156:159], a[172:175], a[252:255], v[156:159]
    ds_read_b64_tr_b16 a[162:163], v25 offset:1672
    v_mfma_f32_16x16x32_bf16 v[148:151], a[172:175], a[248:251], v[148:151]
    ds_read_b64_tr_b16 a[164:165], v25 offset:12424
    v_mfma_f32_16x16x32_bf16 v[148:151], a[168:171], a[232:235], v[148:151]
    ds_read_b64_tr_b16 a[166:167], v25 offset:13960
    v_mfma_f32_16x16x32_bf16 v[140:143], a[168:171], a[228:231], v[140:143]
    s_waitcnt vmcnt(11)
    ds_read_b128 a[192:195], v16 offset:0
    v_mfma_f32_16x16x32_bf16 v[140:143], a[172:175], a[244:247], v[140:143]
    ds_read_b128 a[208:211], v17 offset:0
    v_mfma_f32_16x16x32_bf16 v[132:135], a[172:175], a[240:243], v[132:135]
    buffer_load_dwordx4 v20, s[8:11], s35 offen offset:2048 nt lds
    s_add_u32 s34, s29, 24576
    v_mfma_f32_16x16x32_bf16 v[132:135], a[168:171], a[224:227], v[132:135]
    s_add_u32 m0, s39, s34
    s_waitcnt lgkmcnt(10)
    v_mfma_f32_16x16x32_bf16 a[132:135], a[176:179], a[184:187], a[132:135]
    v_mfma_f32_16x16x32_bf16 a[132:135], a[180:183], a[184:187], a[132:135]
    s_waitcnt lgkmcnt(6)
    v_mfma_f32_16x16x32_bf16 v[160:163], a[152:155], a[224:227], v[160:163]
    ds_read_b64_tr_b16 a[168:169], v24 offset:256
    v_mfma_f32_16x16x32_bf16 v[160:163], a[156:159], a[240:243], v[160:163]
    ds_read_b64_tr_b16 a[170:171], v24 offset:1792
    v_mfma_f32_16x16x32_bf16 v[168:171], a[156:159], a[244:247], v[168:171]
    ds_read_b64_tr_b16 a[172:173], v24 offset:12544
    v_mfma_f32_16x16x32_bf16 v[168:171], a[152:155], a[228:231], v[168:171]
    ds_read_b64_tr_b16 a[174:175], v24 offset:14080
    v_mfma_f32_16x16x32_bf16 v[176:179], a[152:155], a[232:235], v[176:179]
    ds_read_b64_tr_b16 a[176:177], v27 offset:256
    v_mfma_f32_16x16x32_bf16 v[176:179], a[156:159], a[248:251], v[176:179]
    ds_read_b64_tr_b16 a[178:179], v27 offset:1792
    v_mfma_f32_16x16x32_bf16 v[184:187], a[156:159], a[252:255], v[184:187]
    ds_read_b64_tr_b16 a[180:181], v27 offset:12544
    v_mfma_f32_16x16x32_bf16 v[184:187], a[152:155], a[236:239], v[184:187]
    ds_read_b64_tr_b16 a[182:183], v27 offset:14080
    v_mfma_f32_16x16x32_bf16 a[96:99], a[148:151], a[240:243], a[96:99]
    buffer_load_dwordx4 v21, s[12:15], s38 offen offset:0 lds
    v_mfma_f32_16x16x32_bf16 a[112:115], a[240:243], a[240:243], a[112:115]
    s_waitcnt lgkmcnt(10)
    v_mfma_f32_16x16x32_bf16 v[188:191], a[160:163], a[236:239], v[188:191]
    ds_read_b64_tr_b16 a[152:153], v24 offset:264
    v_add_u32 v27, s59, v27
    v_mfma_f32_16x16x32_bf16 v[188:191], a[164:167], a[252:255], v[188:191]
    ds_read_b64_tr_b16 a[154:155], v24 offset:1800
    v_mfma_f32_16x16x32_bf16 v[180:183], a[164:167], a[248:251], v[180:183]
    ds_read_b64_tr_b16 a[156:157], v24 offset:12552
    v_mfma_f32_16x16x32_bf16 v[180:183], a[160:163], a[232:235], v[180:183]
    ds_read_b64_tr_b16 a[158:159], v24 offset:14088
    v_mfma_f32_16x16x32_bf16 v[172:175], a[160:163], a[228:231], v[172:175]
    s_waitcnt vmcnt(11)
    ds_read_b128 a[196:199], v16 offset:2048
    v_mfma_f32_16x16x32_bf16 v[172:175], a[164:167], a[244:247], v[172:175]
    ds_read_b128 a[212:215], v17 offset:2048
    v_mfma_f32_16x16x32_bf16 v[164:167], a[164:167], a[240:243], v[164:167]
    buffer_load_dwordx4 v22, s[12:15], s38 offen offset:1024 lds
    v_mfma_f32_16x16x32_bf16 v[164:167], a[160:163], a[224:227], v[164:167]
    v_mfma_f32_16x16x32_bf16 a[100:103], a[148:151], a[244:247], a[100:103]
    v_mfma_f32_16x16x32_bf16 a[116:119], a[244:247], a[244:247], a[116:119]
    s_waitcnt lgkmcnt(10)
    v_mfma_f32_16x16x32_bf16 v[192:195], a[168:171], a[224:227], v[192:195]
    ds_read_b64_tr_b16 a[160:161], v25 offset:256
    v_mfma_f32_16x16x32_bf16 v[192:195], a[172:175], a[240:243], v[192:195]
    ds_read_b64_tr_b16 a[162:163], v25 offset:1792
    v_mfma_f32_16x16x32_bf16 v[200:203], a[172:175], a[244:247], v[200:203]
    ds_read_b64_tr_b16 a[164:165], v25 offset:12544
    v_mfma_f32_16x16x32_bf16 v[200:203], a[168:171], a[228:231], v[200:203]
    ds_read_b64_tr_b16 a[166:167], v25 offset:14080
    v_mfma_f32_16x16x32_bf16 v[208:211], a[168:171], a[232:235], v[208:211]
    buffer_load_dwordx4 v23, s[12:15], s38 offen offset:2048 lds
    s_add_u32 s26, s26, 1
    v_mfma_f32_16x16x32_bf16 v[208:211], a[172:175], a[248:251], v[208:211]
    s_xor_b32 s38, s26, s24
    s_mul_i32 s38, s38, 196608
    v_mfma_f32_16x16x32_bf16 v[216:219], a[172:175], a[252:255], v[216:219]
    s_lshl_b32 s37, s38, 2
    s_add_u32 s39, s39, 36864
    v_mfma_f32_16x16x32_bf16 v[216:219], a[168:171], a[236:239], v[216:219]
    s_cmp_eq_u32 s39, 110592
    s_cselect_b32 s39, 0, s39
    s_waitcnt lgkmcnt(10)
    v_mfma_f32_16x16x32_bf16 a[136:139], a[176:179], a[184:187], a[136:139]
    s_add_u32 m0, s57, 0
    s_add_u32 s35, s36, 0
    v_mfma_f32_16x16x32_bf16 a[136:139], a[180:183], a[184:187], a[136:139]
    buffer_load_dwordx4 v14, s[4:7], s35 offen lds
    s_waitcnt lgkmcnt(6)
    v_mfma_f32_16x16x32_bf16 v[220:223], a[152:155], a[236:239], v[220:223]
    ds_read_b64_tr_b16 a[168:169], v25 offset:264
    s_add_u32 m0, s57, 1024
    v_mfma_f32_16x16x32_bf16 v[220:223], a[156:159], a[252:255], v[220:223]
    ds_read_b64_tr_b16 a[170:171], v25 offset:1800
    s_add_u32 s35, s36, 0
    v_mfma_f32_16x16x32_bf16 v[212:215], a[156:159], a[248:251], v[212:215]
    ds_read_b64_tr_b16 a[172:173], v25 offset:12552
    v_mfma_f32_16x16x32_bf16 v[212:215], a[152:155], a[232:235], v[212:215]
    ds_read_b64_tr_b16 a[174:175], v25 offset:14088
    v_mfma_f32_16x16x32_bf16 v[204:207], a[152:155], a[228:231], v[204:207]
    ds_read_b64_tr_b16 a[176:177], v28 offset:24576
    v_mfma_f32_16x16x32_bf16 v[204:207], a[156:159], a[244:247], v[204:207]
    ds_read_b64_tr_b16 a[178:179], v28 offset:24960
    v_mfma_f32_16x16x32_bf16 v[196:199], a[156:159], a[240:243], v[196:199]
    ds_read_b64_tr_b16 a[180:181], v28 offset:27648
    v_mfma_f32_16x16x32_bf16 v[196:199], a[152:155], a[224:227], v[196:199]
    ds_read_b64_tr_b16 a[182:183], v28 offset:28032
    v_mfma_f32_16x16x32_bf16 a[104:107], a[148:151], a[248:251], a[104:107]
    s_waitcnt vmcnt(12)
    ds_read_b128 a[200:203], v16 offset:4096
    v_mfma_f32_16x16x32_bf16 a[120:123], a[248:251], a[248:251], a[120:123]
    ds_read_b128 a[216:219], v17 offset:4096
    s_waitcnt lgkmcnt(10)
    v_mfma_f32_16x16x32_bf16 v[224:227], a[160:163], a[224:227], v[224:227]
    ds_read_b64_tr_b16 a[152:153], v26 offset:24576
    v_add_u32 v24, s59, v24
    v_mfma_f32_16x16x32_bf16 v[224:227], a[164:167], a[240:243], v[224:227]
    ds_read_b64_tr_b16 a[154:155], v26 offset:24960
    v_add_u32 v25, s59, v25
    v_mfma_f32_16x16x32_bf16 v[232:235], a[164:167], a[244:247], v[232:235]
    ds_read_b64_tr_b16 a[156:157], v26 offset:27648
    v_add_u32 v28, s59, v28
    v_mfma_f32_16x16x32_bf16 v[232:235], a[160:163], a[228:231], v[232:235]
    ds_read_b64_tr_b16 a[158:159], v26 offset:28032
    v_mfma_f32_16x16x32_bf16 v[240:243], a[160:163], a[232:235], v[240:243]
    buffer_load_dwordx4 v15, s[4:7], s35 offen lds
    s_add_u32 m0, s57, 2048
    v_mfma_f32_16x16x32_bf16 v[240:243], a[164:167], a[248:251], v[240:243]
    s_add_u32 s35, s36, 20480
    v_mfma_f32_16x16x32_bf16 v[248:251], a[164:167], a[252:255], v[248:251]
    v_mfma_f32_16x16x32_bf16 v[248:251], a[160:163], a[236:239], v[248:251]
    v_mfma_f32_16x16x32_bf16 a[108:111], a[148:151], a[252:255], a[108:111]
    v_mfma_f32_16x16x32_bf16 a[124:127], a[252:255], a[252:255], a[124:127]
    buffer_load_dwordx4 v14, s[4:7], s35 offen lds
    s_waitcnt lgkmcnt(10)
    v_mfma_f32_16x16x32_bf16 v[252:255], a[168:171], a[236:239], v[252:255]
    ds_read_b64_tr_b16 a[160:161], v26 offset:24608
    s_add_u32 m0, s57, 3072
    v_mfma_f32_16x16x32_bf16 v[252:255], a[172:175], a[252:255], v[252:255]
    ds_read_b64_tr_b16 a[162:163], v26 offset:24992
    s_add_u32 s35, s36, 20480
    v_mfma_f32_16x16x32_bf16 v[244:247], a[172:175], a[248:251], v[244:247]
    ds_read_b64_tr_b16 a[164:165], v26 offset:27680
    v_mfma_f32_16x16x32_bf16 v[244:247], a[168:171], a[232:235], v[244:247]
    ds_read_b64_tr_b16 a[166:167], v26 offset:28064
    v_mfma_f32_16x16x32_bf16 v[236:239], a[168:171], a[228:231], v[236:239]
    s_waitcnt vmcnt(12)
    ds_read_b128 a[204:207], v16 offset:6144
    v_mfma_f32_16x16x32_bf16 v[236:239], a[172:175], a[244:247], v[236:239]
    ds_read_b128 a[220:223], v17 offset:6144
    v_mfma_f32_16x16x32_bf16 v[228:231], a[172:175], a[240:243], v[228:231]
    buffer_load_dwordx4 v15, s[4:7], s35 offen lds
    v_mfma_f32_16x16x32_bf16 v[228:231], a[168:171], a[224:227], v[228:231]
    s_waitcnt lgkmcnt(12)
    v_mfma_f32_16x16x32_bf16 a[140:143], a[176:179], a[184:187], a[140:143]
    v_mfma_f32_16x16x32_bf16 a[140:143], a[180:183], a[184:187], a[140:143]
    s_waitcnt lgkmcnt(6)
    v_mfma_f32_16x16x32_bf16 a[0:3], a[152:155], a[224:227], a[0:3]
    ds_read_b64_tr_b16 a[168:169], v26 offset:24640
    s_add_u32 m0, s57, 4096
    v_mfma_f32_16x16x32_bf16 a[0:3], a[156:159], a[240:243], a[0:3]
    ds_read_b64_tr_b16 a[170:171], v26 offset:25024
    s_add_u32 s35, s36, 40960
    v_mfma_f32_16x16x32_bf16 a[4:7], a[156:159], a[244:247], a[4:7]
    ds_read_b64_tr_b16 a[172:173], v26 offset:27712
    v_mfma_f32_16x16x32_bf16 a[4:7], a[152:155], a[228:231], a[4:7]
    ds_read_b64_tr_b16 a[174:175], v26 offset:28096
    v_mfma_f32_16x16x32_bf16 a[8:11], a[152:155], a[232:235], a[8:11]
    ds_read_b64_tr_b16 a[176:177], v29 offset:24576
    v_mfma_f32_16x16x32_bf16 a[8:11], a[156:159], a[248:251], a[8:11]
    ds_read_b64_tr_b16 a[178:179], v29 offset:24960
    v_mfma_f32_16x16x32_bf16 a[12:15], a[156:159], a[252:255], a[12:15]
    ds_read_b64_tr_b16 a[180:181], v29 offset:27648
    v_mfma_f32_16x16x32_bf16 a[12:15], a[152:155], a[236:239], a[12:15]
    ds_read_b64_tr_b16 a[182:183], v29 offset:28032
    s_waitcnt lgkmcnt(10)
    v_mfma_f32_16x16x32_bf16 a[28:31], a[160:163], a[236:239], a[28:31]
    ds_read_b64_tr_b16 a[152:153], v26 offset:30720
    v_add_u32 v29, s59, v29
    v_mfma_f32_16x16x32_bf16 a[28:31], a[164:167], a[252:255], a[28:31]
    ds_read_b64_tr_b16 a[154:155], v26 offset:31104
    v_mfma_f32_16x16x32_bf16 a[24:27], a[164:167], a[248:251], a[24:27]
    ds_read_b64_tr_b16 a[156:157], v26 offset:33792
    v_mfma_f32_16x16x32_bf16 a[24:27], a[160:163], a[232:235], a[24:27]
    ds_read_b64_tr_b16 a[158:159], v26 offset:34176
    v_mfma_f32_16x16x32_bf16 a[20:23], a[160:163], a[228:231], a[20:23]
    buffer_load_dwordx4 v14, s[4:7], s35 offen lds
    s_add_u32 m0, s57, 5120
    v_mfma_f32_16x16x32_bf16 a[20:23], a[164:167], a[244:247], a[20:23]
    s_add_u32 s35, s36, 40960
    v_mfma_f32_16x16x32_bf16 a[16:19], a[164:167], a[240:243], a[16:19]
    v_mfma_f32_16x16x32_bf16 a[16:19], a[160:163], a[224:227], a[16:19]
    s_waitcnt lgkmcnt(8)
    v_mfma_f32_16x16x32_bf16 a[32:35], a[168:171], a[224:227], a[32:35]
    ds_read_b64_tr_b16 a[160:161], v26 offset:30752
    v_mfma_f32_16x16x32_bf16 a[32:35], a[172:175], a[240:243], a[32:35]
    ds_read_b64_tr_b16 a[162:163], v26 offset:31136
    v_mfma_f32_16x16x32_bf16 a[36:39], a[172:175], a[244:247], a[36:39]
    ds_read_b64_tr_b16 a[164:165], v26 offset:33824
    v_mfma_f32_16x16x32_bf16 a[36:39], a[168:171], a[228:231], a[36:39]
    ds_read_b64_tr_b16 a[166:167], v26 offset:34208
    v_mfma_f32_16x16x32_bf16 a[40:43], a[168:171], a[232:235], a[40:43]
    buffer_load_dwordx4 v15, s[4:7], s35 offen lds
    s_add_u32 m0, s57, 6144
    v_mfma_f32_16x16x32_bf16 a[40:43], a[172:175], a[248:251], a[40:43]
    s_add_u32 s35, s36, 61440
    v_mfma_f32_16x16x32_bf16 a[44:47], a[172:175], a[252:255], a[44:47]
    v_mfma_f32_16x16x32_bf16 a[44:47], a[168:171], a[236:239], a[44:47]
    s_waitcnt lgkmcnt(8)
    v_mfma_f32_16x16x32_bf16 a[144:147], a[176:179], a[184:187], a[144:147]
    v_mfma_f32_16x16x32_bf16 a[144:147], a[180:183], a[184:187], a[144:147]
    buffer_load_dwordx4 v14, s[4:7], s35 offen lds
    s_waitcnt lgkmcnt(4)
    v_mfma_f32_16x16x32_bf16 a[60:63], a[152:155], a[236:239], a[60:63]
    ds_read_b64_tr_b16 a[168:169], v26 offset:30784
    s_add_u32 m0, s57, 7168
    v_mfma_f32_16x16x32_bf16 a[60:63], a[156:159], a[252:255], a[60:63]
    ds_read_b64_tr_b16 a[170:171], v26 offset:31168
    s_add_u32 s35, s36, 61440
    v_mfma_f32_16x16x32_bf16 a[56:59], a[156:159], a[248:251], a[56:59]
    ds_read_b64_tr_b16 a[172:173], v26 offset:33856
    v_mfma_f32_16x16x32_bf16 a[56:59], a[152:155], a[232:235], a[56:59]
    ds_read_b64_tr_b16 a[174:175], v26 offset:34240
    v_mfma_f32_16x16x32_bf16 a[52:55], a[152:155], a[228:231], a[52:55]
    buffer_load_dwordx4 v15, s[4:7], s35 offen lds
    s_add_u32 s25, s25, 1
    v_mfma_f32_16x16x32_bf16 a[52:55], a[156:159], a[244:247], a[52:55]
    s_xor_b32 s36, s25, s24
    s_lshl_b32 s36, s36, 7
    v_mfma_f32_16x16x32_bf16 a[48:51], a[156:159], a[240:243], a[48:51]
    v_mfma_f32_16x16x32_bf16 a[48:51], a[152:155], a[224:227], a[48:51]
    s_waitcnt lgkmcnt(0)
    s_barrier
    v_mfma_f32_16x16x32_bf16 a[64:67], a[160:163], a[224:227], a[64:67]
    ds_read_b64_tr_b16 a[152:153], v24 offset:0
    v_add_u32 v26, s59, v26
    v_mfma_f32_16x16x32_bf16 a[64:67], a[164:167], a[240:243], a[64:67]
    ds_read_b64_tr_b16 a[154:155], v24 offset:1536
    v_mfma_f32_16x16x32_bf16 a[68:71], a[164:167], a[244:247], a[68:71]
    ds_read_b64_tr_b16 a[156:157], v24 offset:12288
    v_mfma_f32_16x16x32_bf16 a[68:71], a[160:163], a[228:231], a[68:71]
    ds_read_b64_tr_b16 a[158:159], v24 offset:13824
    v_mfma_f32_16x16x32_bf16 a[72:75], a[160:163], a[232:235], a[72:75]
    v_mfma_f32_16x16x32_bf16 a[72:75], a[164:167], a[248:251], a[72:75]
    v_mfma_f32_16x16x32_bf16 a[76:79], a[164:167], a[252:255], a[76:79]
    v_mfma_f32_16x16x32_bf16 a[76:79], a[160:163], a[236:239], a[76:79]
    v_mfma_f32_16x16x32_bf16 a[92:95], a[168:171], a[236:239], a[92:95]
    ds_read_b64_tr_b16 a[160:161], v24 offset:8
    v_mfma_f32_16x16x32_bf16 a[92:95], a[172:175], a[252:255], a[92:95]
    ds_read_b64_tr_b16 a[162:163], v24 offset:1544
    v_mfma_f32_16x16x32_bf16 a[88:91], a[172:175], a[248:251], a[88:91]
    ds_read_b64_tr_b16 a[164:165], v24 offset:12296
    v_mfma_f32_16x16x32_bf16 a[88:91], a[168:171], a[232:235], a[88:91]
    ds_read_b64_tr_b16 a[166:167], v24 offset:13832
    v_mfma_f32_16x16x32_bf16 a[84:87], a[168:171], a[228:231], a[84:87]
    v_mfma_f32_16x16x32_bf16 a[84:87], a[172:175], a[244:247], a[84:87]
    v_mfma_f32_16x16x32_bf16 a[80:83], a[172:175], a[240:243], a[80:83]
    v_mfma_f32_16x16x32_bf16 a[80:83], a[168:171], a[224:227], a[80:83]
    s_sub_u32 s54, s54, 1
    s_cmp_lg_u32 s54, 0
    s_cbranch_scc1 K1_GEMM
K1_GEMM_END:
    s_waitcnt lgkmcnt(4)
    v_mfma_f32_16x16x32_bf16 v[64:67], a[152:155], a[192:195], v[64:67]
    ds_read_b64_tr_b16 a[168:169], v25 offset:0
    s_add_u32 m0, s29, 36864
    v_mfma_f32_16x16x32_bf16 v[64:67], a[156:159], a[208:211], v[64:67]
    ds_read_b64_tr_b16 a[170:171], v25 offset:1536
    v_subrev_u32 v60, 12288, v8
    v_mfma_f32_16x16x32_bf16 v[72:75], a[156:159], a[212:215], v[72:75]
    ds_read_b64_tr_b16 a[172:173], v25 offset:12288
    v_subrev_u32 v61, 12288, v9
    v_mfma_f32_16x16x32_bf16 v[72:75], a[152:155], a[196:199], v[72:75]
    ds_read_b64_tr_b16 a[174:175], v25 offset:13824
    v_subrev_u32 v62, 12288, v10
    v_mfma_f32_16x16x32_bf16 v[80:83], a[152:155], a[200:203], v[80:83]
    ds_read_b64_tr_b16 a[176:177], v27 offset:0
    v_mfma_f32_16x16x32_bf16 v[80:83], a[156:159], a[216:219], v[80:83]
    ds_read_b64_tr_b16 a[178:179], v27 offset:1536
    v_mfma_f32_16x16x32_bf16 v[88:91], a[156:159], a[220:223], v[88:91]
    ds_read_b64_tr_b16 a[180:181], v27 offset:12288
    v_mfma_f32_16x16x32_bf16 v[88:91], a[152:155], a[204:207], v[88:91]
    ds_read_b64_tr_b16 a[182:183], v27 offset:13824
    v_mfma_f32_16x16x32_bf16 a[96:99], a[148:151], a[192:195], a[96:99]
    buffer_load_dwordx4 v60, s[16:19], 0 offen offset:0 lds
    v_mfma_f32_16x16x32_bf16 a[112:115], a[192:195], a[192:195], a[112:115]
    s_waitcnt lgkmcnt(8)
    v_mfma_f32_16x16x32_bf16 v[92:95], a[160:163], a[204:207], v[92:95]
    ds_read_b64_tr_b16 a[152:153], v25 offset:8
    s_add_u32 s33, s33, 36864
    v_mfma_f32_16x16x32_bf16 v[92:95], a[164:167], a[220:223], v[92:95]
    ds_read_b64_tr_b16 a[154:155], v25 offset:1544
    v_mfma_f32_16x16x32_bf16 v[84:87], a[164:167], a[216:219], v[84:87]
    ds_read_b64_tr_b16 a[156:157], v25 offset:12296
    v_mfma_f32_16x16x32_bf16 v[84:87], a[160:163], a[200:203], v[84:87]
    ds_read_b64_tr_b16 a[158:159], v25 offset:13832
    v_mfma_f32_16x16x32_bf16 v[76:79], a[160:163], a[196:199], v[76:79]
    s_cmp_eq_u32 s33, 110592
    s_cselect_b32 s59, s56, s55
    v_mfma_f32_16x16x32_bf16 v[76:79], a[164:167], a[212:215], v[76:79]
    buffer_load_dwordx4 v61, s[16:19], 0 offen offset:1024 lds
    v_mfma_f32_16x16x32_bf16 v[68:71], a[164:167], a[208:211], v[68:71]
    s_cmp_eq_u32 s33, 110592
    s_cselect_b32 s33, 0, s33
    v_mfma_f32_16x16x32_bf16 v[68:71], a[160:163], a[192:195], v[68:71]
    v_mfma_f32_16x16x32_bf16 a[100:103], a[148:151], a[196:199], a[100:103]
    v_mfma_f32_16x16x32_bf16 a[116:119], a[196:199], a[196:199], a[116:119]
    s_waitcnt lgkmcnt(8)
    v_mfma_f32_16x16x32_bf16 v[96:99], a[168:171], a[192:195], v[96:99]
    ds_read_b64_tr_b16 a[160:161], v24 offset:128
    s_lshl_b32 s66, s32, 2
    v_mfma_f32_16x16x32_bf16 v[96:99], a[172:175], a[208:211], v[96:99]
    ds_read_b64_tr_b16 a[162:163], v24 offset:1664
    s_add_u32 s66, s66, s28
    v_mfma_f32_16x16x32_bf16 v[104:107], a[172:175], a[212:215], v[104:107]
    ds_read_b64_tr_b16 a[164:165], v24 offset:12416
    s_mul_i32 s67, s66, 983040
    v_mfma_f32_16x16x32_bf16 v[104:107], a[168:171], a[196:199], v[104:107]
    ds_read_b64_tr_b16 a[166:167], v24 offset:13952
    s_add_u32 s24, s52, s67
    s_addc_u32 s25, s53, 0
    v_mfma_f32_16x16x32_bf16 v[112:115], a[168:171], a[200:203], v[112:115]
    buffer_load_dwordx4 v62, s[16:19], 0 offen offset:2048 lds
    s_add_u32 m0, s29, 49152
    v_mfma_f32_16x16x32_bf16 v[112:115], a[172:175], a[216:219], v[112:115]
    s_mov_b32 s30, 0
    s_add_u32 s24, s24, 16777216
    s_addc_u32 s25, s25, 0
    v_mfma_f32_16x16x32_bf16 v[120:123], a[172:175], a[220:223], v[120:123]
    s_mov_b32 s26, 983040
    v_mfma_f32_16x16x32_bf16 v[120:123], a[168:171], a[204:207], v[120:123]
    s_mov_b32 s27, 0x00020000
    s_waitcnt lgkmcnt(8)
    v_mfma_f32_16x16x32_bf16 a[128:131], a[176:179], a[184:187], a[128:131]
    s_bfe_u32 s66, s2, 0x20003
    v_mfma_f32_16x16x32_bf16 a[128:131], a[180:183], a[184:187], a[128:131]
    s_mul_i32 s66, s66, 10240
    s_waitcnt lgkmcnt(4)
    v_mfma_f32_16x16x32_bf16 v[124:127], a[152:155], a[204:207], v[124:127]
    ds_read_b64_tr_b16 a[168:169], v24 offset:136
    s_sub_u32 s67, 9830400, s66
    v_mfma_f32_16x16x32_bf16 v[124:127], a[156:159], a[220:223], v[124:127]
    ds_read_b64_tr_b16 a[170:171], v24 offset:1672
    s_add_u32 s8, s52, s66
    s_addc_u32 s9, s53, 0
    v_mfma_f32_16x16x32_bf16 v[116:119], a[156:159], a[216:219], v[116:119]
    ds_read_b64_tr_b16 a[172:173], v24 offset:12424
    s_add_u32 s8, s8, 4194304
    s_addc_u32 s9, s9, 0
    v_mfma_f32_16x16x32_bf16 v[116:119], a[152:155], a[200:203], v[116:119]
    ds_read_b64_tr_b16 a[174:175], v24 offset:13960
    s_mov_b32 s10, s67
    v_mfma_f32_16x16x32_bf16 v[108:111], a[152:155], a[196:199], v[108:111]
    ds_read_b64_tr_b16 a[176:177], v27 offset:128
    s_mov_b32 s11, 0x00020000
    v_mfma_f32_16x16x32_bf16 v[108:111], a[156:159], a[212:215], v[108:111]
    ds_read_b64_tr_b16 a[178:179], v27 offset:1664
    s_and_b32 s66, s2, 1
    v_mfma_f32_16x16x32_bf16 v[100:103], a[156:159], a[208:211], v[100:103]
    ds_read_b64_tr_b16 a[180:181], v27 offset:12416
    s_lshl_b32 s66, s66, 5
    v_mfma_f32_16x16x32_bf16 v[100:103], a[152:155], a[192:195], v[100:103]
    ds_read_b64_tr_b16 a[182:183], v27 offset:13952
    s_lshr_b32 s67, s2, 3
    v_mfma_f32_16x16x32_bf16 a[104:107], a[148:151], a[200:203], a[104:107]
    buffer_load_dwordx4 v8, s[16:19], s30 offen offset:0 lds
    s_add_u32 s66, s66, s67
    v_mfma_f32_16x16x32_bf16 a[120:123], a[200:203], a[200:203], a[120:123]
    s_mul_i32 s67, s66, 245760
    s_waitcnt lgkmcnt(8)
    v_mfma_f32_16x16x32_bf16 v[128:131], a[160:163], a[192:195], v[128:131]
    ds_read_b64_tr_b16 a[152:153], v25 offset:128
    s_add_u32 s4, s52, s67
    s_addc_u32 s5, s53, 0
    v_mfma_f32_16x16x32_bf16 v[128:131], a[164:167], a[208:211], v[128:131]
    ds_read_b64_tr_b16 a[154:155], v25 offset:1664
    s_add_u32 s4, s4, 67108864
    s_addc_u32 s5, s5, 0
    v_mfma_f32_16x16x32_bf16 v[136:139], a[164:167], a[212:215], v[136:139]
    ds_read_b64_tr_b16 a[156:157], v25 offset:12416
    s_mov_b32 s6, 245760
    v_mfma_f32_16x16x32_bf16 v[136:139], a[160:163], a[196:199], v[136:139]
    ds_read_b64_tr_b16 a[158:159], v25 offset:13952
    s_mov_b32 s7, 0x00020000
    v_mfma_f32_16x16x32_bf16 v[144:147], a[160:163], a[200:203], v[144:147]
    s_lshr_b32 s66, s66, 2
    v_mfma_f32_16x16x32_bf16 v[144:147], a[164:167], a[216:219], v[144:147]
    buffer_load_dwordx4 v9, s[16:19], s30 offen offset:1024 lds
    s_mul_i32 s66, s66, 1966080
    v_mfma_f32_16x16x32_bf16 v[152:155], a[164:167], a[220:223], v[152:155]
    s_add_u32 s12, s52, s66
    s_addc_u32 s13, s53, 0
    v_mfma_f32_16x16x32_bf16 v[152:155], a[160:163], a[204:207], v[152:155]
    s_add_u32 s12, s12, 16777216
    s_addc_u32 s13, s13, 0
    v_mfma_f32_16x16x32_bf16 a[108:111], a[148:151], a[204:207], a[108:111]
    s_mov_b32 s14, 1966080
    v_mfma_f32_16x16x32_bf16 a[124:127], a[204:207], a[204:207], a[124:127]
    s_mov_b32 s15, 0x00020000
    s_waitcnt lgkmcnt(8)
    v_mfma_f32_16x16x32_bf16 v[156:159], a[168:171], a[204:207], v[156:159]
    ds_read_b64_tr_b16 a[160:161], v25 offset:136
    s_mul_i32 s35, s31, 3
    v_mfma_f32_16x16x32_bf16 v[156:159], a[172:175], a[220:223], v[156:159]
    ds_read_b64_tr_b16 a[162:163], v25 offset:1672
    s_add_u32 s36, s35, 1
    v_mfma_f32_16x16x32_bf16 v[148:151], a[172:175], a[216:219], v[148:151]
    ds_read_b64_tr_b16 a[164:165], v25 offset:12424
    s_lshr_b32 s36, s36, 1
    v_mfma_f32_16x16x32_bf16 v[148:151], a[168:171], a[200:203], v[148:151]
    ds_read_b64_tr_b16 a[166:167], v25 offset:13960
    s_add_u32 s36, s36, 192
    v_mfma_f32_16x16x32_bf16 v[140:143], a[168:171], a[196:199], v[140:143]
    s_waitcnt vmcnt(11)
    ds_read_b128 a[224:227], v16 offset:0
    s_lshl_b32 s37, s36, 10
    v_mfma_f32_16x16x32_bf16 v[140:143], a[172:175], a[212:215], v[140:143]
    ds_read_b128 a[240:243], v17 offset:0
    s_lshr_b32 s35, s35, 1
    v_mfma_f32_16x16x32_bf16 v[132:135], a[172:175], a[208:211], v[132:135]
    buffer_load_dwordx4 v10, s[16:19], s30 offen offset:2048 lds
    s_add_u32 m0, s29, 61440
    v_mfma_f32_16x16x32_bf16 v[132:135], a[168:171], a[192:195], v[132:135]
    s_mov_b32 s30, 12288
    s_add_u32 s35, s35, 193
    s_waitcnt lgkmcnt(10)
    v_mfma_f32_16x16x32_bf16 a[132:135], a[176:179], a[184:187], a[132:135]
    s_and_b32 s36, s31, 1
    v_mfma_f32_16x16x32_bf16 a[132:135], a[180:183], a[184:187], a[132:135]
    s_sub_u32 s35, s35, s36
    s_waitcnt lgkmcnt(6)
    v_mfma_f32_16x16x32_bf16 v[160:163], a[152:155], a[192:195], v[160:163]
    ds_read_b64_tr_b16 a[168:169], v24 offset:256
    s_lshl_b32 s35, s35, 10
    v_mfma_f32_16x16x32_bf16 v[160:163], a[156:159], a[208:211], v[160:163]
    ds_read_b64_tr_b16 a[170:171], v24 offset:1792
    s_lshl_b32 s36, s36, 9
    v_mfma_f32_16x16x32_bf16 v[168:171], a[156:159], a[212:215], v[168:171]
    ds_read_b64_tr_b16 a[172:173], v24 offset:12544
    s_add_u32 s38, s35, s36
    v_mfma_f32_16x16x32_bf16 v[168:171], a[152:155], a[196:199], v[168:171]
    ds_read_b64_tr_b16 a[174:175], v24 offset:14080
    s_mov_b32 s39, 20480
    v_mfma_f32_16x16x32_bf16 v[176:179], a[152:155], a[200:203], v[176:179]
    ds_read_b64_tr_b16 a[176:177], v27 offset:256
    v_lshlrev_b32 v39, 4, v0
    v_mfma_f32_16x16x32_bf16 v[176:179], a[156:159], a[216:219], v[176:179]
    ds_read_b64_tr_b16 a[178:179], v27 offset:1792
    v_lshlrev_b32 v37, 3, v0
    v_mfma_f32_16x16x32_bf16 v[184:187], a[156:159], a[220:223], v[184:187]
    ds_read_b64_tr_b16 a[180:181], v27 offset:12544
    v_mfma_f32_16x16x32_bf16 v[184:187], a[152:155], a[204:207], v[184:187]
    ds_read_b64_tr_b16 a[182:183], v27 offset:14080
    v_mfma_f32_16x16x32_bf16 a[96:99], a[148:151], a[208:211], a[96:99]
    buffer_load_dwordx4 v8, s[16:19], s30 offen offset:0 lds
    v_mfma_f32_16x16x32_bf16 a[112:115], a[208:211], a[208:211], a[112:115]
    s_waitcnt lgkmcnt(10)
    v_mfma_f32_16x16x32_bf16 v[188:191], a[160:163], a[204:207], v[188:191]
    ds_read_b64_tr_b16 a[152:153], v24 offset:264
    v_add_u32 v27, s59, v27
    v_mfma_f32_16x16x32_bf16 v[188:191], a[164:167], a[220:223], v[188:191]
    ds_read_b64_tr_b16 a[154:155], v24 offset:1800
    v_mfma_f32_16x16x32_bf16 v[180:183], a[164:167], a[216:219], v[180:183]
    ds_read_b64_tr_b16 a[156:157], v24 offset:12552
    v_mfma_f32_16x16x32_bf16 v[180:183], a[160:163], a[200:203], v[180:183]
    ds_read_b64_tr_b16 a[158:159], v24 offset:14088
    v_mfma_f32_16x16x32_bf16 v[172:175], a[160:163], a[196:199], v[172:175]
    s_waitcnt vmcnt(11)
    ds_read_b128 a[228:231], v16 offset:2048
    v_mfma_f32_16x16x32_bf16 v[172:175], a[164:167], a[212:215], v[172:175]
    ds_read_b128 a[244:247], v17 offset:2048
    v_mfma_f32_16x16x32_bf16 v[164:167], a[164:167], a[208:211], v[164:167]
    buffer_load_dwordx4 v9, s[16:19], s30 offen offset:1024 lds
    v_mfma_f32_16x16x32_bf16 v[164:167], a[160:163], a[192:195], v[164:167]
    v_mfma_f32_16x16x32_bf16 a[100:103], a[148:151], a[212:215], a[100:103]
    v_mfma_f32_16x16x32_bf16 a[116:119], a[212:215], a[212:215], a[116:119]
    s_waitcnt lgkmcnt(10)
    v_mfma_f32_16x16x32_bf16 v[192:195], a[168:171], a[192:195], v[192:195]
    ds_read_b64_tr_b16 a[160:161], v25 offset:256
    v_mfma_f32_16x16x32_bf16 v[192:195], a[172:175], a[208:211], v[192:195]
    ds_read_b64_tr_b16 a[162:163], v25 offset:1792
    v_mfma_f32_16x16x32_bf16 v[200:203], a[172:175], a[212:215], v[200:203]
    ds_read_b64_tr_b16 a[164:165], v25 offset:12544
    v_mfma_f32_16x16x32_bf16 v[200:203], a[168:171], a[196:199], v[200:203]
    ds_read_b64_tr_b16 a[166:167], v25 offset:14080
    v_mfma_f32_16x16x32_bf16 v[208:211], a[168:171], a[200:203], v[208:211]
    buffer_load_dwordx4 v10, s[16:19], s30 offen offset:2048 lds
    v_mfma_f32_16x16x32_bf16 v[208:211], a[172:175], a[216:219], v[208:211]
    v_mfma_f32_16x16x32_bf16 v[216:219], a[172:175], a[220:223], v[216:219]
    v_mfma_f32_16x16x32_bf16 v[216:219], a[168:171], a[204:207], v[216:219]
    s_waitcnt lgkmcnt(10)
    v_mfma_f32_16x16x32_bf16 a[136:139], a[176:179], a[184:187], a[136:139]
    v_mfma_f32_16x16x32_bf16 a[136:139], a[180:183], a[184:187], a[136:139]
    s_waitcnt lgkmcnt(6)
    v_mfma_f32_16x16x32_bf16 v[220:223], a[152:155], a[204:207], v[220:223]
    ds_read_b64_tr_b16 a[168:169], v25 offset:264
    v_mfma_f32_16x16x32_bf16 v[220:223], a[156:159], a[220:223], v[220:223]
    ds_read_b64_tr_b16 a[170:171], v25 offset:1800
    v_mfma_f32_16x16x32_bf16 v[212:215], a[156:159], a[216:219], v[212:215]
    ds_read_b64_tr_b16 a[172:173], v25 offset:12552
    v_mfma_f32_16x16x32_bf16 v[212:215], a[152:155], a[200:203], v[212:215]
    ds_read_b64_tr_b16 a[174:175], v25 offset:14088
    v_mfma_f32_16x16x32_bf16 v[204:207], a[152:155], a[196:199], v[204:207]
    ds_read_b64_tr_b16 a[176:177], v28 offset:24576
    v_mfma_f32_16x16x32_bf16 v[204:207], a[156:159], a[212:215], v[204:207]
    ds_read_b64_tr_b16 a[178:179], v28 offset:24960
    v_mfma_f32_16x16x32_bf16 v[196:199], a[156:159], a[208:211], v[196:199]
    ds_read_b64_tr_b16 a[180:181], v28 offset:27648
    v_mfma_f32_16x16x32_bf16 v[196:199], a[152:155], a[192:195], v[196:199]
    ds_read_b64_tr_b16 a[182:183], v28 offset:28032
    v_mfma_f32_16x16x32_bf16 a[104:107], a[148:151], a[216:219], a[104:107]
    s_waitcnt vmcnt(11)
    ds_read_b128 a[232:235], v16 offset:4096
    v_mfma_f32_16x16x32_bf16 a[120:123], a[216:219], a[216:219], a[120:123]
    ds_read_b128 a[248:251], v17 offset:4096
    s_waitcnt lgkmcnt(10)
    v_mfma_f32_16x16x32_bf16 v[224:227], a[160:163], a[192:195], v[224:227]
    ds_read_b64_tr_b16 a[152:153], v26 offset:24576
    v_add_u32 v24, s59, v24
    v_mfma_f32_16x16x32_bf16 v[224:227], a[164:167], a[208:211], v[224:227]
    ds_read_b64_tr_b16 a[154:155], v26 offset:24960
    v_add_u32 v25, s59, v25
    v_mfma_f32_16x16x32_bf16 v[232:235], a[164:167], a[212:215], v[232:235]
    ds_read_b64_tr_b16 a[156:157], v26 offset:27648
    v_add_u32 v28, s59, v28
    v_mfma_f32_16x16x32_bf16 v[232:235], a[160:163], a[196:199], v[232:235]
    ds_read_b64_tr_b16 a[158:159], v26 offset:28032
    v_mfma_f32_16x16x32_bf16 v[240:243], a[160:163], a[200:203], v[240:243]
    v_mfma_f32_16x16x32_bf16 v[240:243], a[164:167], a[216:219], v[240:243]
    v_mfma_f32_16x16x32_bf16 v[248:251], a[164:167], a[220:223], v[248:251]
    v_mfma_f32_16x16x32_bf16 v[248:251], a[160:163], a[204:207], v[248:251]
    v_mfma_f32_16x16x32_bf16 a[108:111], a[148:151], a[220:223], a[108:111]
    v_mfma_f32_16x16x32_bf16 a[124:127], a[220:223], a[220:223], a[124:127]
    s_waitcnt lgkmcnt(10)
    v_mfma_f32_16x16x32_bf16 v[252:255], a[168:171], a[204:207], v[252:255]
    ds_read_b64_tr_b16 a[160:161], v26 offset:24608
    v_mfma_f32_16x16x32_bf16 v[252:255], a[172:175], a[220:223], v[252:255]
    ds_read_b64_tr_b16 a[162:163], v26 offset:24992
    v_mfma_f32_16x16x32_bf16 v[244:247], a[172:175], a[216:219], v[244:247]
    ds_read_b64_tr_b16 a[164:165], v26 offset:27680
    v_mfma_f32_16x16x32_bf16 v[244:247], a[168:171], a[200:203], v[244:247]
    ds_read_b64_tr_b16 a[166:167], v26 offset:28064
    v_mfma_f32_16x16x32_bf16 v[236:239], a[168:171], a[196:199], v[236:239]
    s_waitcnt vmcnt(9)
    ds_read_b128 a[236:239], v16 offset:6144
    v_mfma_f32_16x16x32_bf16 v[236:239], a[172:175], a[212:215], v[236:239]
    ds_read_b128 a[252:255], v17 offset:6144
    v_mfma_f32_16x16x32_bf16 v[228:231], a[172:175], a[208:211], v[228:231]
    v_mfma_f32_16x16x32_bf16 v[228:231], a[168:171], a[192:195], v[228:231]
    s_waitcnt lgkmcnt(12)
    v_mfma_f32_16x16x32_bf16 a[140:143], a[176:179], a[184:187], a[140:143]
    v_mfma_f32_16x16x32_bf16 a[140:143], a[180:183], a[184:187], a[140:143]
    s_waitcnt lgkmcnt(6)
    v_mfma_f32_16x16x32_bf16 a[0:3], a[152:155], a[192:195], a[0:3]
    ds_read_b64_tr_b16 a[168:169], v26 offset:24640
    v_mfma_f32_16x16x32_bf16 a[0:3], a[156:159], a[208:211], a[0:3]
    ds_read_b64_tr_b16 a[170:171], v26 offset:25024
    v_mfma_f32_16x16x32_bf16 a[4:7], a[156:159], a[212:215], a[4:7]
    ds_read_b64_tr_b16 a[172:173], v26 offset:27712
    v_mfma_f32_16x16x32_bf16 a[4:7], a[152:155], a[196:199], a[4:7]
    ds_read_b64_tr_b16 a[174:175], v26 offset:28096
    v_mfma_f32_16x16x32_bf16 a[8:11], a[152:155], a[200:203], a[8:11]
    ds_read_b64_tr_b16 a[176:177], v29 offset:24576
    v_mfma_f32_16x16x32_bf16 a[8:11], a[156:159], a[216:219], a[8:11]
    ds_read_b64_tr_b16 a[178:179], v29 offset:24960
    v_mfma_f32_16x16x32_bf16 a[12:15], a[156:159], a[220:223], a[12:15]
    ds_read_b64_tr_b16 a[180:181], v29 offset:27648
    v_mfma_f32_16x16x32_bf16 a[12:15], a[152:155], a[204:207], a[12:15]
    ds_read_b64_tr_b16 a[182:183], v29 offset:28032
    s_waitcnt lgkmcnt(10)
    v_mfma_f32_16x16x32_bf16 a[28:31], a[160:163], a[204:207], a[28:31]
    ds_read_b64_tr_b16 a[152:153], v26 offset:30720
    v_add_u32 v29, s59, v29
    v_mfma_f32_16x16x32_bf16 a[28:31], a[164:167], a[220:223], a[28:31]
    ds_read_b64_tr_b16 a[154:155], v26 offset:31104
    v_mfma_f32_16x16x32_bf16 a[24:27], a[164:167], a[216:219], a[24:27]
    ds_read_b64_tr_b16 a[156:157], v26 offset:33792
    v_mfma_f32_16x16x32_bf16 a[24:27], a[160:163], a[200:203], a[24:27]
    ds_read_b64_tr_b16 a[158:159], v26 offset:34176
    v_mfma_f32_16x16x32_bf16 a[20:23], a[160:163], a[196:199], a[20:23]
    v_mfma_f32_16x16x32_bf16 a[20:23], a[164:167], a[212:215], a[20:23]
    v_mfma_f32_16x16x32_bf16 a[16:19], a[164:167], a[208:211], a[16:19]
    v_mfma_f32_16x16x32_bf16 a[16:19], a[160:163], a[192:195], a[16:19]
    s_waitcnt lgkmcnt(8)
    v_mfma_f32_16x16x32_bf16 a[32:35], a[168:171], a[192:195], a[32:35]
    ds_read_b64_tr_b16 a[160:161], v26 offset:30752
    v_mfma_f32_16x16x32_bf16 a[32:35], a[172:175], a[208:211], a[32:35]
    ds_read_b64_tr_b16 a[162:163], v26 offset:31136
    v_mfma_f32_16x16x32_bf16 a[36:39], a[172:175], a[212:215], a[36:39]
    ds_read_b64_tr_b16 a[164:165], v26 offset:33824
    v_mfma_f32_16x16x32_bf16 a[36:39], a[168:171], a[196:199], a[36:39]
    ds_read_b64_tr_b16 a[166:167], v26 offset:34208
    v_mfma_f32_16x16x32_bf16 a[40:43], a[168:171], a[200:203], a[40:43]
    v_mfma_f32_16x16x32_bf16 a[40:43], a[172:175], a[216:219], a[40:43]
    v_mfma_f32_16x16x32_bf16 a[44:47], a[172:175], a[220:223], a[44:47]
    v_mfma_f32_16x16x32_bf16 a[44:47], a[168:171], a[204:207], a[44:47]
    s_waitcnt lgkmcnt(8)
    v_mfma_f32_16x16x32_bf16 a[144:147], a[176:179], a[184:187], a[144:147]
    v_mfma_f32_16x16x32_bf16 a[144:147], a[180:183], a[184:187], a[144:147]
    s_waitcnt lgkmcnt(4)
    v_mfma_f32_16x16x32_bf16 a[60:63], a[152:155], a[204:207], a[60:63]
    ds_read_b64_tr_b16 a[168:169], v26 offset:30784
    v_mfma_f32_16x16x32_bf16 a[60:63], a[156:159], a[220:223], a[60:63]
    ds_read_b64_tr_b16 a[170:171], v26 offset:31168
    v_mfma_f32_16x16x32_bf16 a[56:59], a[156:159], a[216:219], a[56:59]
    ds_read_b64_tr_b16 a[172:173], v26 offset:33856
    v_mfma_f32_16x16x32_bf16 a[56:59], a[152:155], a[200:203], a[56:59]
    ds_read_b64_tr_b16 a[174:175], v26 offset:34240
    v_mfma_f32_16x16x32_bf16 a[52:55], a[152:155], a[196:199], a[52:55]
    v_mfma_f32_16x16x32_bf16 a[52:55], a[156:159], a[212:215], a[52:55]
    v_mfma_f32_16x16x32_bf16 a[48:51], a[156:159], a[208:211], a[48:51]
    v_mfma_f32_16x16x32_bf16 a[48:51], a[152:155], a[192:195], a[48:51]
    s_waitcnt lgkmcnt(0)
    s_barrier
    v_mfma_f32_16x16x32_bf16 a[64:67], a[160:163], a[192:195], a[64:67]
    ds_read_b64_tr_b16 a[152:153], v24 offset:0
    v_add_u32 v26, s59, v26
    v_mfma_f32_16x16x32_bf16 a[64:67], a[164:167], a[208:211], a[64:67]
    ds_read_b64_tr_b16 a[154:155], v24 offset:1536
    v_mfma_f32_16x16x32_bf16 a[68:71], a[164:167], a[212:215], a[68:71]
    ds_read_b64_tr_b16 a[156:157], v24 offset:12288
    v_mfma_f32_16x16x32_bf16 a[68:71], a[160:163], a[196:199], a[68:71]
    ds_read_b64_tr_b16 a[158:159], v24 offset:13824
    v_mfma_f32_16x16x32_bf16 a[72:75], a[160:163], a[200:203], a[72:75]
    v_mfma_f32_16x16x32_bf16 a[72:75], a[164:167], a[216:219], a[72:75]
    v_mfma_f32_16x16x32_bf16 a[76:79], a[164:167], a[220:223], a[76:79]
    v_mfma_f32_16x16x32_bf16 a[76:79], a[160:163], a[204:207], a[76:79]
    v_mfma_f32_16x16x32_bf16 a[92:95], a[168:171], a[204:207], a[92:95]
    ds_read_b64_tr_b16 a[160:161], v24 offset:8
    v_mfma_f32_16x16x32_bf16 a[92:95], a[172:175], a[220:223], a[92:95]
    ds_read_b64_tr_b16 a[162:163], v24 offset:1544
    v_mfma_f32_16x16x32_bf16 a[88:91], a[172:175], a[216:219], a[88:91]
    ds_read_b64_tr_b16 a[164:165], v24 offset:12296
    v_mfma_f32_16x16x32_bf16 a[88:91], a[168:171], a[200:203], a[88:91]
    ds_read_b64_tr_b16 a[166:167], v24 offset:13832
    v_mfma_f32_16x16x32_bf16 a[84:87], a[168:171], a[196:199], a[84:87]
    v_mfma_f32_16x16x32_bf16 a[84:87], a[172:175], a[212:215], a[84:87]
    v_mfma_f32_16x16x32_bf16 a[80:83], a[172:175], a[208:211], a[80:83]
    v_mfma_f32_16x16x32_bf16 a[80:83], a[168:171], a[192:195], a[80:83]
    s_waitcnt lgkmcnt(4)
    v_mfma_f32_16x16x32_bf16 v[64:67], a[152:155], a[224:227], v[64:67]
    ds_read_b64_tr_b16 a[168:169], v25 offset:0
    s_add_u32 m0, s29, 86016
    v_mfma_f32_16x16x32_bf16 v[64:67], a[156:159], a[240:243], v[64:67]
    ds_read_b64_tr_b16 a[170:171], v25 offset:1536
    s_mov_b32 s30, 0
    v_mfma_f32_16x16x32_bf16 v[72:75], a[156:159], a[244:247], v[72:75]
    ds_read_b64_tr_b16 a[172:173], v25 offset:12288
    v_mfma_f32_16x16x32_bf16 v[72:75], a[152:155], a[228:231], v[72:75]
    ds_read_b64_tr_b16 a[174:175], v25 offset:13824
    v_mfma_f32_16x16x32_bf16 v[80:83], a[152:155], a[232:235], v[80:83]
    ds_read_b64_tr_b16 a[176:177], v27 offset:0
    v_mfma_f32_16x16x32_bf16 v[80:83], a[156:159], a[248:251], v[80:83]
    ds_read_b64_tr_b16 a[178:179], v27 offset:1536
    v_mfma_f32_16x16x32_bf16 v[88:91], a[156:159], a[252:255], v[88:91]
    ds_read_b64_tr_b16 a[180:181], v27 offset:12288
    v_mfma_f32_16x16x32_bf16 v[88:91], a[152:155], a[236:239], v[88:91]
    ds_read_b64_tr_b16 a[182:183], v27 offset:13824
    v_mfma_f32_16x16x32_bf16 a[96:99], a[148:151], a[224:227], a[96:99]
    buffer_load_dwordx4 v11, s[20:23], s30 offen offset:0 lds
    v_mfma_f32_16x16x32_bf16 a[112:115], a[224:227], a[224:227], a[112:115]
    v_mfma_f32_16x16x32_bf16 a[100:103], a[148:151], a[228:231], a[100:103]
    v_mfma_f32_16x16x32_bf16 a[116:119], a[228:231], a[228:231], a[116:119]
    s_waitcnt lgkmcnt(8)
    v_mfma_f32_16x16x32_bf16 v[92:95], a[160:163], a[236:239], v[92:95]
    ds_read_b64_tr_b16 a[152:153], v25 offset:8
    v_mfma_f32_16x16x32_bf16 v[92:95], a[164:167], a[252:255], v[92:95]
    ds_read_b64_tr_b16 a[154:155], v25 offset:1544
    v_mfma_f32_16x16x32_bf16 v[84:87], a[164:167], a[248:251], v[84:87]
    ds_read_b64_tr_b16 a[156:157], v25 offset:12296
    v_mfma_f32_16x16x32_bf16 v[84:87], a[160:163], a[232:235], v[84:87]
    ds_read_b64_tr_b16 a[158:159], v25 offset:13832
    v_mfma_f32_16x16x32_bf16 v[76:79], a[160:163], a[228:231], v[76:79]
    buffer_load_dwordx4 v12, s[20:23], s30 offen offset:1024 lds
    v_mfma_f32_16x16x32_bf16 v[76:79], a[164:167], a[244:247], v[76:79]
    v_mfma_f32_16x16x32_bf16 v[68:71], a[164:167], a[240:243], v[68:71]
    v_mfma_f32_16x16x32_bf16 v[68:71], a[160:163], a[224:227], v[68:71]
    v_mfma_f32_16x16x32_bf16 a[104:107], a[148:151], a[232:235], a[104:107]
    v_mfma_f32_16x16x32_bf16 a[120:123], a[232:235], a[232:235], a[120:123]
    v_mfma_f32_16x16x32_bf16 a[108:111], a[148:151], a[236:239], a[108:111]
    v_mfma_f32_16x16x32_bf16 a[124:127], a[236:239], a[236:239], a[124:127]
    buffer_load_dwordx4 v13, s[20:23], s30 offen offset:2048 lds
    s_waitcnt lgkmcnt(8)
    v_mfma_f32_16x16x32_bf16 v[96:99], a[168:171], a[224:227], v[96:99]
    ds_read_b64_tr_b16 a[160:161], v24 offset:128
    s_add_u32 m0, s29, 73728
    v_mfma_f32_16x16x32_bf16 v[96:99], a[172:175], a[240:243], v[96:99]
    ds_read_b64_tr_b16 a[162:163], v24 offset:1664
    s_mov_b32 s30, 24576
    v_mfma_f32_16x16x32_bf16 v[104:107], a[172:175], a[244:247], v[104:107]
    ds_read_b64_tr_b16 a[164:165], v24 offset:12416
    v_mfma_f32_16x16x32_bf16 v[104:107], a[168:171], a[228:231], v[104:107]
    ds_read_b64_tr_b16 a[166:167], v24 offset:13952
    v_mfma_f32_16x16x32_bf16 v[112:115], a[168:171], a[232:235], v[112:115]
    v_mfma_f32_16x16x32_bf16 v[112:115], a[172:175], a[248:251], v[112:115]
    v_mfma_f32_16x16x32_bf16 v[120:123], a[172:175], a[252:255], v[120:123]
    buffer_load_dwordx4 v8, s[16:19], s30 offen offset:0 lds
    v_mfma_f32_16x16x32_bf16 v[120:123], a[168:171], a[236:239], v[120:123]
    s_waitcnt lgkmcnt(8)
    v_mfma_f32_16x16x32_bf16 a[128:131], a[176:179], a[184:187], a[128:131]
    v_mfma_f32_16x16x32_bf16 a[128:131], a[180:183], a[184:187], a[128:131]
    s_waitcnt lgkmcnt(4)
    v_mfma_f32_16x16x32_bf16 v[124:127], a[152:155], a[236:239], v[124:127]
    ds_read_b64_tr_b16 a[168:169], v24 offset:136
    v_mfma_f32_16x16x32_bf16 v[124:127], a[156:159], a[252:255], v[124:127]
    ds_read_b64_tr_b16 a[170:171], v24 offset:1672
    v_mfma_f32_16x16x32_bf16 v[116:119], a[156:159], a[248:251], v[116:119]
    ds_read_b64_tr_b16 a[172:173], v24 offset:12424
    v_mfma_f32_16x16x32_bf16 v[116:119], a[152:155], a[232:235], v[116:119]
    ds_read_b64_tr_b16 a[174:175], v24 offset:13960
    v_mfma_f32_16x16x32_bf16 v[108:111], a[152:155], a[228:231], v[108:111]
    ds_read_b64_tr_b16 a[176:177], v27 offset:128
    v_mfma_f32_16x16x32_bf16 v[108:111], a[156:159], a[244:247], v[108:111]
    ds_read_b64_tr_b16 a[178:179], v27 offset:1664
    v_mfma_f32_16x16x32_bf16 v[100:103], a[156:159], a[240:243], v[100:103]
    ds_read_b64_tr_b16 a[180:181], v27 offset:12416
    v_mfma_f32_16x16x32_bf16 v[100:103], a[152:155], a[224:227], v[100:103]
    ds_read_b64_tr_b16 a[182:183], v27 offset:13952
    v_mfma_f32_16x16x32_bf16 a[96:99], a[148:151], a[240:243], a[96:99]
    buffer_load_dwordx4 v9, s[16:19], s30 offen offset:1024 lds
    v_mfma_f32_16x16x32_bf16 a[112:115], a[240:243], a[240:243], a[112:115]
    v_mfma_f32_16x16x32_bf16 a[100:103], a[148:151], a[244:247], a[100:103]
    v_mfma_f32_16x16x32_bf16 a[116:119], a[244:247], a[244:247], a[116:119]
    s_waitcnt lgkmcnt(8)
    v_mfma_f32_16x16x32_bf16 v[128:131], a[160:163], a[224:227], v[128:131]
    ds_read_b64_tr_b16 a[152:153], v25 offset:128
    v_mfma_f32_16x16x32_bf16 v[128:131], a[164:167], a[240:243], v[128:131]
    ds_read_b64_tr_b16 a[154:155], v25 offset:1664
    v_mfma_f32_16x16x32_bf16 v[136:139], a[164:167], a[244:247], v[136:139]
    ds_read_b64_tr_b16 a[156:157], v25 offset:12416
    v_mfma_f32_16x16x32_bf16 v[136:139], a[160:163], a[228:231], v[136:139]
    ds_read_b64_tr_b16 a[158:159], v25 offset:13952
    v_mfma_f32_16x16x32_bf16 v[144:147], a[160:163], a[232:235], v[144:147]
    buffer_load_dwordx4 v10, s[16:19], s30 offen offset:2048 lds
    s_add_u32 m0, s29, 98304
    v_mfma_f32_16x16x32_bf16 v[144:147], a[164:167], a[248:251], v[144:147]
    s_mov_b32 s30, 12288
    v_mfma_f32_16x16x32_bf16 v[152:155], a[164:167], a[252:255], v[152:155]
    v_mfma_f32_16x16x32_bf16 v[152:155], a[160:163], a[236:239], v[152:155]
    v_mfma_f32_16x16x32_bf16 a[104:107], a[148:151], a[248:251], a[104:107]
    v_mfma_f32_16x16x32_bf16 a[120:123], a[248:251], a[248:251], a[120:123]
    v_mfma_f32_16x16x32_bf16 a[108:111], a[148:151], a[252:255], a[108:111]
    v_mfma_f32_16x16x32_bf16 a[124:127], a[252:255], a[252:255], a[124:127]
    buffer_load_dwordx4 v11, s[20:23], s30 offen offset:0 lds
    s_waitcnt lgkmcnt(8)
    v_mfma_f32_16x16x32_bf16 v[156:159], a[168:171], a[236:239], v[156:159]
    ds_read_b64_tr_b16 a[160:161], v25 offset:136
    v_mfma_f32_16x16x32_bf16 v[156:159], a[172:175], a[252:255], v[156:159]
    ds_read_b64_tr_b16 a[162:163], v25 offset:1672
    v_mfma_f32_16x16x32_bf16 v[148:151], a[172:175], a[248:251], v[148:151]
    ds_read_b64_tr_b16 a[164:165], v25 offset:12424
    v_mfma_f32_16x16x32_bf16 v[148:151], a[168:171], a[232:235], v[148:151]
    ds_read_b64_tr_b16 a[166:167], v25 offset:13960
    v_mfma_f32_16x16x32_bf16 v[140:143], a[168:171], a[228:231], v[140:143]
    v_mfma_f32_16x16x32_bf16 v[140:143], a[172:175], a[244:247], v[140:143]
    v_mfma_f32_16x16x32_bf16 v[132:135], a[172:175], a[240:243], v[132:135]
    buffer_load_dwordx4 v12, s[20:23], s30 offen offset:1024 lds
    v_mfma_f32_16x16x32_bf16 v[132:135], a[168:171], a[224:227], v[132:135]
    s_waitcnt lgkmcnt(8)
    v_mfma_f32_16x16x32_bf16 a[132:135], a[176:179], a[184:187], a[132:135]
    v_mfma_f32_16x16x32_bf16 a[132:135], a[180:183], a[184:187], a[132:135]
    s_waitcnt lgkmcnt(4)
    v_mfma_f32_16x16x32_bf16 v[160:163], a[152:155], a[224:227], v[160:163]
    ds_read_b64_tr_b16 a[168:169], v24 offset:256
    v_accvgpr_read_b32 v48, a112
    v_mfma_f32_16x16x32_bf16 v[160:163], a[156:159], a[240:243], v[160:163]
    ds_read_b64_tr_b16 a[170:171], v24 offset:1792
    v_accvgpr_read_b32 v49, a116
    v_mfma_f32_16x16x32_bf16 v[168:171], a[156:159], a[244:247], v[168:171]
    ds_read_b64_tr_b16 a[172:173], v24 offset:12544
    v_accvgpr_read_b32 v50, a120
    v_mfma_f32_16x16x32_bf16 v[168:171], a[152:155], a[228:231], v[168:171]
    ds_read_b64_tr_b16 a[174:175], v24 offset:14080
    v_accvgpr_read_b32 v51, a124
    v_mfma_f32_16x16x32_bf16 v[176:179], a[152:155], a[232:235], v[176:179]
    ds_read_b64_tr_b16 a[176:177], v27 offset:256
    v_and_b32 v58, 3, v0
    v_mfma_f32_16x16x32_bf16 v[176:179], a[156:159], a[248:251], v[176:179]
    ds_read_b64_tr_b16 a[178:179], v27 offset:1792
    v_cmp_eq_u32 vcc, 1, v58
    v_mfma_f32_16x16x32_bf16 v[184:187], a[156:159], a[252:255], v[184:187]
    ds_read_b64_tr_b16 a[180:181], v27 offset:12544
    v_accvgpr_read_b32 v52, a113
    v_mfma_f32_16x16x32_bf16 v[184:187], a[152:155], a[236:239], v[184:187]
    ds_read_b64_tr_b16 a[182:183], v27 offset:14080
    s_waitcnt lgkmcnt(8)
    v_mfma_f32_16x16x32_bf16 v[188:191], a[160:163], a[236:239], v[188:191]
    ds_read_b64_tr_b16 a[152:153], v24 offset:264
    v_accvgpr_read_b32 v53, a117
    v_mfma_f32_16x16x32_bf16 v[188:191], a[164:167], a[252:255], v[188:191]
    ds_read_b64_tr_b16 a[154:155], v24 offset:1800
    v_accvgpr_read_b32 v54, a121
    v_mfma_f32_16x16x32_bf16 v[180:183], a[164:167], a[248:251], v[180:183]
    ds_read_b64_tr_b16 a[156:157], v24 offset:12552
    v_accvgpr_read_b32 v55, a125
    v_mfma_f32_16x16x32_bf16 v[180:183], a[160:163], a[232:235], v[180:183]
    ds_read_b64_tr_b16 a[158:159], v24 offset:14088
    v_cndmask_b32 v48, v48, v52, vcc
    v_mfma_f32_16x16x32_bf16 v[172:175], a[160:163], a[228:231], v[172:175]
    buffer_load_dwordx4 v13, s[20:23], s30 offen offset:2048 lds
    v_cndmask_b32 v49, v49, v53, vcc
    v_mfma_f32_16x16x32_bf16 v[172:175], a[164:167], a[244:247], v[172:175]
    v_cndmask_b32 v50, v50, v54, vcc
    v_cndmask_b32 v51, v51, v55, vcc
    v_mfma_f32_16x16x32_bf16 v[164:167], a[164:167], a[240:243], v[164:167]
    v_cmp_eq_u32 vcc, 2, v58
    v_accvgpr_read_b32 v52, a114
    v_mfma_f32_16x16x32_bf16 v[164:167], a[160:163], a[224:227], v[164:167]
    v_accvgpr_read_b32 v53, a118
    s_waitcnt lgkmcnt(8)
    v_mfma_f32_16x16x32_bf16 v[192:195], a[168:171], a[224:227], v[192:195]
    ds_read_b64_tr_b16 a[160:161], v25 offset:256
    v_accvgpr_read_b32 v54, a122
    v_mfma_f32_16x16x32_bf16 v[192:195], a[172:175], a[240:243], v[192:195]
    ds_read_b64_tr_b16 a[162:163], v25 offset:1792
    v_accvgpr_read_b32 v55, a126
    v_mfma_f32_16x16x32_bf16 v[200:203], a[172:175], a[244:247], v[200:203]
    ds_read_b64_tr_b16 a[164:165], v25 offset:12544
    v_cndmask_b32 v48, v48, v52, vcc
    v_mfma_f32_16x16x32_bf16 v[200:203], a[168:171], a[228:231], v[200:203]
    ds_read_b64_tr_b16 a[166:167], v25 offset:14080
    v_cndmask_b32 v49, v49, v53, vcc
    v_mfma_f32_16x16x32_bf16 v[208:211], a[168:171], a[232:235], v[208:211]
    v_cndmask_b32 v50, v50, v54, vcc
    v_cndmask_b32 v51, v51, v55, vcc
    v_mfma_f32_16x16x32_bf16 v[208:211], a[172:175], a[248:251], v[208:211]
    v_cmp_eq_u32 vcc, 3, v58
    v_accvgpr_read_b32 v52, a115
    v_mfma_f32_16x16x32_bf16 v[216:219], a[172:175], a[252:255], v[216:219]
    v_accvgpr_read_b32 v53, a119
    v_accvgpr_read_b32 v54, a123
    v_mfma_f32_16x16x32_bf16 v[216:219], a[168:171], a[236:239], v[216:219]
    v_accvgpr_read_b32 v55, a127
    v_cndmask_b32 v48, v48, v52, vcc
    s_waitcnt lgkmcnt(8)
    v_mfma_f32_16x16x32_bf16 a[136:139], a[176:179], a[184:187], a[136:139]
    v_cndmask_b32 v49, v49, v53, vcc
    v_cndmask_b32 v50, v50, v54, vcc
    v_mfma_f32_16x16x32_bf16 a[136:139], a[180:183], a[184:187], a[136:139]
    v_cndmask_b32 v51, v51, v55, vcc
    s_waitcnt lgkmcnt(4)
    v_mfma_f32_16x16x32_bf16 v[220:223], a[152:155], a[236:239], v[220:223]
    ds_read_b64_tr_b16 a[168:169], v25 offset:264
    v_bfe_u32 v58, v0, 2, 2
    v_mfma_f32_16x16x32_bf16 v[220:223], a[156:159], a[252:255], v[220:223]
    ds_read_b64_tr_b16 a[170:171], v25 offset:1800
    v_lshrrev_b32 v59, 4, v0
    v_mfma_f32_16x16x32_bf16 v[212:215], a[156:159], a[248:251], v[212:215]
    ds_read_b64_tr_b16 a[172:173], v25 offset:12552
    v_cmp_eq_u32 vcc, v58, v59
    v_mfma_f32_16x16x32_bf16 v[212:215], a[152:155], a[232:235], v[212:215]
    ds_read_b64_tr_b16 a[174:175], v25 offset:14088
    s_mov_b32 s34, 0x3acccccd
    v_mfma_f32_16x16x32_bf16 v[204:207], a[152:155], a[228:231], v[204:207]
    ds_read_b64_tr_b16 a[176:177], v28 offset:24576
    s_nop 0
    v_mfma_f32_16x16x32_bf16 v[204:207], a[156:159], a[244:247], v[204:207]
    ds_read_b64_tr_b16 a[178:179], v28 offset:24960
    v_cndmask_b32 v48, 0, v48, vcc
    v_mfma_f32_16x16x32_bf16 v[196:199], a[156:159], a[240:243], v[196:199]
    ds_read_b64_tr_b16 a[180:181], v28 offset:27648
    v_cndmask_b32 v49, 0, v49, vcc
    v_mfma_f32_16x16x32_bf16 v[196:199], a[152:155], a[224:227], v[196:199]
    ds_read_b64_tr_b16 a[182:183], v28 offset:28032
    s_waitcnt lgkmcnt(8)
    v_mfma_f32_16x16x32_bf16 v[224:227], a[160:163], a[224:227], v[224:227]
    ds_read_b64_tr_b16 a[152:153], v26 offset:24576
    v_cndmask_b32 v50, 0, v50, vcc
    v_mfma_f32_16x16x32_bf16 v[224:227], a[164:167], a[240:243], v[224:227]
    ds_read_b64_tr_b16 a[154:155], v26 offset:24960
    v_cndmask_b32 v51, 0, v51, vcc
    v_mfma_f32_16x16x32_bf16 v[232:235], a[164:167], a[244:247], v[232:235]
    ds_read_b64_tr_b16 a[156:157], v26 offset:27648
    v_mov_b32 v52, v48
    v_mfma_f32_16x16x32_bf16 v[232:235], a[160:163], a[228:231], v[232:235]
    ds_read_b64_tr_b16 a[158:159], v26 offset:28032
    v_mov_b32 v53, v49
    v_mfma_f32_16x16x32_bf16 v[240:243], a[160:163], a[232:235], v[240:243]
    v_mov_b32 v54, v50
    v_mov_b32 v55, v51
    v_mfma_f32_16x16x32_bf16 v[240:243], a[164:167], a[248:251], v[240:243]
    s_nop 1
    v_permlane32_swap_b32 v52, v48
    v_mfma_f32_16x16x32_bf16 v[248:251], a[164:167], a[252:255], v[248:251]
    v_permlane32_swap_b32 v53, v49
    v_permlane32_swap_b32 v54, v50
    v_mfma_f32_16x16x32_bf16 v[248:251], a[160:163], a[236:239], v[248:251]
    v_permlane32_swap_b32 v55, v51
    s_waitcnt lgkmcnt(8)
    v_mfma_f32_16x16x32_bf16 v[252:255], a[168:171], a[236:239], v[252:255]
    ds_read_b64_tr_b16 a[160:161], v26 offset:24608
    s_nop 1
    v_mfma_f32_16x16x32_bf16 v[252:255], a[172:175], a[252:255], v[252:255]
    ds_read_b64_tr_b16 a[162:163], v26 offset:24992
    v_add_f32 v48, v48, v52
    v_mfma_f32_16x16x32_bf16 v[244:247], a[172:175], a[248:251], v[244:247]
    ds_read_b64_tr_b16 a[164:165], v26 offset:27680
    v_add_f32 v49, v49, v53
    v_mfma_f32_16x16x32_bf16 v[244:247], a[168:171], a[232:235], v[244:247]
    ds_read_b64_tr_b16 a[166:167], v26 offset:28064
    v_add_f32 v50, v50, v54
    v_mfma_f32_16x16x32_bf16 v[236:239], a[168:171], a[228:231], v[236:239]
    v_add_f32 v51, v51, v55
    v_mov_b32 v52, v48
    v_mfma_f32_16x16x32_bf16 v[236:239], a[172:175], a[244:247], v[236:239]
    v_mov_b32 v53, v49
    v_mov_b32 v54, v50
    v_mfma_f32_16x16x32_bf16 v[228:231], a[172:175], a[240:243], v[228:231]
    v_mov_b32 v55, v51
    s_nop 1
    v_mfma_f32_16x16x32_bf16 v[228:231], a[168:171], a[224:227], v[228:231]
    v_permlane16_swap_b32 v52, v48
    v_permlane16_swap_b32 v53, v49
    s_waitcnt lgkmcnt(8)
    v_mfma_f32_16x16x32_bf16 a[140:143], a[176:179], a[184:187], a[140:143]
    v_permlane16_swap_b32 v54, v50
    v_permlane16_swap_b32 v55, v51
    v_mfma_f32_16x16x32_bf16 a[140:143], a[180:183], a[184:187], a[140:143]
    s_nop 1
    s_waitcnt lgkmcnt(4)
    v_mfma_f32_16x16x32_bf16 a[0:3], a[152:155], a[224:227], a[0:3]
    ds_read_b64_tr_b16 a[168:169], v26 offset:24640
    v_add_f32 v48, v48, v52
    v_mfma_f32_16x16x32_bf16 a[0:3], a[156:159], a[240:243], a[0:3]
    ds_read_b64_tr_b16 a[170:171], v26 offset:25024
    v_add_f32 v49, v49, v53
    v_mfma_f32_16x16x32_bf16 a[4:7], a[156:159], a[244:247], a[4:7]
    ds_read_b64_tr_b16 a[172:173], v26 offset:27712
    v_add_f32 v50, v50, v54
    v_mfma_f32_16x16x32_bf16 a[4:7], a[152:155], a[228:231], a[4:7]
    ds_read_b64_tr_b16 a[174:175], v26 offset:28096
    v_add_f32 v51, v51, v55
    v_mfma_f32_16x16x32_bf16 a[8:11], a[152:155], a[232:235], a[8:11]
    ds_read_b64_tr_b16 a[176:177], v29 offset:24576
    v_accvgpr_read_b32 v52, a96
    v_mfma_f32_16x16x32_bf16 a[8:11], a[156:159], a[248:251], a[8:11]
    ds_read_b64_tr_b16 a[178:179], v29 offset:24960
    v_accvgpr_read_b32 v53, a100
    v_mfma_f32_16x16x32_bf16 a[12:15], a[156:159], a[252:255], a[12:15]
    ds_read_b64_tr_b16 a[180:181], v29 offset:27648
    v_accvgpr_read_b32 v54, a104
    v_mfma_f32_16x16x32_bf16 a[12:15], a[152:155], a[236:239], a[12:15]
    ds_read_b64_tr_b16 a[182:183], v29 offset:28032
    s_waitcnt lgkmcnt(8)
    v_mfma_f32_16x16x32_bf16 a[28:31], a[160:163], a[236:239], a[28:31]
    ds_read_b64_tr_b16 a[152:153], v26 offset:30720
    v_accvgpr_read_b32 v55, a108
    v_mfma_f32_16x16x32_bf16 a[28:31], a[164:167], a[252:255], a[28:31]
    ds_read_b64_tr_b16 a[154:155], v26 offset:31104
    v_mul_f32 v52, s34, v52
    v_mfma_f32_16x16x32_bf16 a[24:27], a[164:167], a[248:251], a[24:27]
    ds_read_b64_tr_b16 a[156:157], v26 offset:33792
    v_mul_f32 v48, s34, v48
    v_mfma_f32_16x16x32_bf16 a[24:27], a[160:163], a[232:235], a[24:27]
    ds_read_b64_tr_b16 a[158:159], v26 offset:34176
    v_mul_f32 v53, s34, v53
    v_mfma_f32_16x16x32_bf16 a[20:23], a[160:163], a[228:231], a[20:23]
    v_mul_f32 v49, s34, v49
    v_mul_f32 v54, s34, v54
    v_mfma_f32_16x16x32_bf16 a[20:23], a[164:167], a[244:247], a[20:23]
    v_mul_f32 v50, s34, v50
    v_mul_f32 v55, s34, v55
    v_mfma_f32_16x16x32_bf16 a[16:19], a[164:167], a[240:243], a[16:19]
    v_mul_f32 v51, s34, v51
    v_fma_f32 v48, -v52, v52, v48
    v_mfma_f32_16x16x32_bf16 a[16:19], a[160:163], a[224:227], a[16:19]
    v_fma_f32 v49, -v53, v53, v49
    s_waitcnt lgkmcnt(8)
    v_mfma_f32_16x16x32_bf16 a[32:35], a[168:171], a[224:227], a[32:35]
    ds_read_b64_tr_b16 a[160:161], v26 offset:30752
    v_fma_f32 v50, -v54, v54, v50
    v_mfma_f32_16x16x32_bf16 a[32:35], a[172:175], a[240:243], a[32:35]
    ds_read_b64_tr_b16 a[162:163], v26 offset:31136
    v_fma_f32 v51, -v55, v55, v51
    v_mfma_f32_16x16x32_bf16 a[36:39], a[172:175], a[244:247], a[36:39]
    ds_read_b64_tr_b16 a[164:165], v26 offset:33824
    v_max_f32 v48, 0, v48
    v_mfma_f32_16x16x32_bf16 a[36:39], a[168:171], a[228:231], a[36:39]
    ds_read_b64_tr_b16 a[166:167], v26 offset:34208
    v_max_f32 v49, 0, v49
    v_mfma_f32_16x16x32_bf16 a[40:43], a[168:171], a[232:235], a[40:43]
    v_max_f32 v50, 0, v50
    v_max_f32 v51, 0, v51
    v_mfma_f32_16x16x32_bf16 a[40:43], a[172:175], a[248:251], a[40:43]
    v_cvt_pk_bf16_f32 v48, v52, v48
    v_cvt_pk_bf16_f32 v49, v53, v49
    v_mfma_f32_16x16x32_bf16 a[44:47], a[172:175], a[252:255], a[44:47]
    v_cvt_pk_bf16_f32 v50, v54, v50
    v_cvt_pk_bf16_f32 v51, v55, v51
    v_mfma_f32_16x16x32_bf16 a[44:47], a[168:171], a[236:239], a[44:47]
    v_lshlrev_b32 v52, 16, v48
    v_and_b32 v48, 0xffff0000, v48
    s_waitcnt lgkmcnt(8)
    v_mfma_f32_16x16x32_bf16 a[144:147], a[176:179], a[184:187], a[144:147]
    v_lshlrev_b32 v53, 16, v49
    v_and_b32 v49, 0xffff0000, v49
    v_mfma_f32_16x16x32_bf16 a[144:147], a[180:183], a[184:187], a[144:147]
    v_lshlrev_b32 v54, 16, v50
    s_waitcnt lgkmcnt(4)
    v_mfma_f32_16x16x32_bf16 a[60:63], a[152:155], a[236:239], a[60:63]
    ds_read_b64_tr_b16 a[168:169], v26 offset:30784
    v_and_b32 v50, 0xffff0000, v50
    v_mfma_f32_16x16x32_bf16 a[60:63], a[156:159], a[252:255], a[60:63]
    ds_read_b64_tr_b16 a[170:171], v26 offset:31168
    v_lshlrev_b32 v55, 16, v51
    v_mfma_f32_16x16x32_bf16 a[56:59], a[156:159], a[248:251], a[56:59]
    ds_read_b64_tr_b16 a[172:173], v26 offset:33856
    v_and_b32 v51, 0xffff0000, v51
    v_mfma_f32_16x16x32_bf16 a[56:59], a[152:155], a[232:235], a[56:59]
    ds_read_b64_tr_b16 a[174:175], v26 offset:34240
    v_sub_f32 v14, 0, v52
    v_mfma_f32_16x16x32_bf16 a[52:55], a[152:155], a[228:231], a[52:55]
    v_add_f32 v48, 0x3727c5ac, v48
    v_sub_f32 v16, 0, v53
    v_mfma_f32_16x16x32_bf16 a[52:55], a[156:159], a[244:247], a[52:55]
    v_add_f32 v49, 0x3727c5ac, v49
    v_sub_f32 v18, 0, v54
    v_mfma_f32_16x16x32_bf16 a[48:51], a[156:159], a[240:243], a[48:51]
    v_add_f32 v50, 0x3727c5ac, v50
    v_sub_f32 v20, 0, v55
    v_mfma_f32_16x16x32_bf16 a[48:51], a[152:155], a[224:227], a[48:51]
    v_add_f32 v51, 0x3727c5ac, v51
    s_waitcnt lgkmcnt(4)
    v_mfma_f32_16x16x32_bf16 a[64:67], a[160:163], a[224:227], a[64:67]
    ds_write_b128 v56, a[128:131] offset:0
    v_cvt_pk_bf16_f32 v48, v48, v48
    v_mfma_f32_16x16x32_bf16 a[64:67], a[164:167], a[240:243], a[64:67]
    ds_write_b128 v56, a[132:135] offset:256
    v_cvt_pk_bf16_f32 v49, v49, v49
    v_mfma_f32_16x16x32_bf16 a[68:71], a[164:167], a[244:247], a[68:71]
    ds_write_b128 v56, a[136:139] offset:512
    v_cvt_pk_bf16_f32 v50, v50, v50
    v_mfma_f32_16x16x32_bf16 a[68:71], a[160:163], a[228:231], a[68:71]
    ds_write_b128 v56, a[140:143] offset:768
    v_cvt_pk_bf16_f32 v51, v51, v51
    v_mfma_f32_16x16x32_bf16 a[72:75], a[160:163], a[232:235], a[72:75]
    ds_write_b128 v57, a[144:147] offset:1024
    v_lshlrev_b32 v48, 16, v48
    v_mfma_f32_16x16x32_bf16 a[72:75], a[164:167], a[248:251], a[72:75]
    v_lshlrev_b32 v49, 16, v49
    v_lshlrev_b32 v50, 16, v50
    v_mfma_f32_16x16x32_bf16 a[76:79], a[164:167], a[252:255], a[76:79]
    v_lshlrev_b32 v51, 16, v51
    v_mfma_f32_16x16x32_bf16 a[76:79], a[160:163], a[236:239], a[76:79]
    s_waitcnt lgkmcnt(5)
    v_mfma_f32_16x16x32_bf16 a[92:95], a[168:171], a[236:239], a[92:95]
    v_sqrt_f32 v48, v48
    v_mfma_f32_16x16x32_bf16 a[92:95], a[172:175], a[252:255], a[92:95]
    v_sqrt_f32 v49, v49
    v_mfma_f32_16x16x32_bf16 a[88:91], a[172:175], a[248:251], a[88:91]
    v_sqrt_f32 v50, v50
    v_mfma_f32_16x16x32_bf16 a[88:91], a[168:171], a[232:235], a[88:91]
    v_sqrt_f32 v51, v51
    v_mfma_f32_16x16x32_bf16 a[84:87], a[168:171], a[228:231], a[84:87]
    v_cvt_pk_bf16_f32 v48, v48, v48
    v_cvt_pk_bf16_f32 v49, v49, v49
    v_mfma_f32_16x16x32_bf16 a[84:87], a[172:175], a[244:247], a[84:87]
    v_cvt_pk_bf16_f32 v50, v50, v50
    v_cvt_pk_bf16_f32 v51, v51, v51
    v_mfma_f32_16x16x32_bf16 a[80:83], a[172:175], a[240:243], a[80:83]
    v_lshlrev_b32 v48, 16, v48
    v_lshlrev_b32 v49, 16, v49
    v_mfma_f32_16x16x32_bf16 a[80:83], a[168:171], a[224:227], a[80:83]
    v_lshlrev_b32 v50, 16, v50
    v_lshlrev_b32 v51, 16, v51
    v_rcp_f32 v52, v48
    v_rcp_f32 v53, v49
    v_rcp_f32 v54, v50
    v_rcp_f32 v55, v51
    v_mul_f32 v41, v48, v48
    v_mul_f32 v43, v49, v49
    v_mul_f32 v45, v50, v50
    v_mul_f32 v47, v51, v51
    v_mul_f32 v15, 0x3dd53b95, v52
    v_mul_f32 v40, 0xbfb8aa3b, v52
    v_mul_f32 v17, 0x3dd53b95, v53
    v_mul_f32 v42, 0xbfb8aa3b, v53
    v_mul_f32 v19, 0x3dd53b95, v54
    v_mul_f32 v44, 0xbfb8aa3b, v54
    v_mul_f32 v21, 0x3dd53b95, v55
    v_mul_f32 v46, 0xbfb8aa3b, v55
    s_waitcnt vmcnt(9) lgkmcnt(0)
    s_barrier
    ds_read_b128 v[48:51], v36 offset:640
    ds_read_b128 v[52:55], v36 offset:704
    ds_read_b128 v[56:59], v36 offset:512
    ds_read_b128 v[60:63], v36 offset:576
    s_waitcnt lgkmcnt(2)
    v_pk_fma_f32 v[248:249], v[20:21], v[48:49], v[248:249] op_sel_hi:[0,1,1]
    v_pk_fma_f32 v[250:251], v[20:21], v[50:51], v[250:251] op_sel_hi:[0,1,1]
    v_pk_fma_f32 v[252:253], v[20:21], v[52:53], v[252:253] op_sel_hi:[0,1,1]
    v_pk_fma_f32 v[254:255], v[20:21], v[54:55], v[254:255] op_sel_hi:[0,1,1]
    v_pk_mul_f32 v[248:249], v[20:21], v[248:249] op_sel:[1,0]
    v_pk_mul_f32 v[250:251], v[20:21], v[250:251] op_sel:[1,0]
    v_pk_mul_f32 v[252:253], v[20:21], v[252:253] op_sel:[1,0]
    v_pk_mul_f32 v[254:255], v[20:21], v[254:255] op_sel:[1,0]
    v_cvt_pk_bf16_f32 v255, v254, v255
    v_cvt_pk_bf16_f32 v254, v252, v253
    v_cvt_pk_bf16_f32 v253, v250, v251
    v_cvt_pk_bf16_f32 v252, v248, v249
    v_pk_fma_f32 v[240:241], v[18:19], v[48:49], v[240:241] op_sel_hi:[0,1,1]
    v_pk_fma_f32 v[242:243], v[18:19], v[50:51], v[242:243] op_sel_hi:[0,1,1]
    v_pk_fma_f32 v[244:245], v[18:19], v[52:53], v[244:245] op_sel_hi:[0,1,1]
    v_pk_fma_f32 v[246:247], v[18:19], v[54:55], v[246:247] op_sel_hi:[0,1,1]
    v_pk_mul_f32 v[240:241], v[18:19], v[240:241] op_sel:[1,0]
    v_pk_mul_f32 v[242:243], v[18:19], v[242:243] op_sel:[1,0]
    v_pk_mul_f32 v[244:245], v[18:19], v[244:245] op_sel:[1,0]
    v_pk_mul_f32 v[246:247], v[18:19], v[246:247] op_sel:[1,0]
    v_cvt_pk_bf16_f32 v251, v246, v247
    v_cvt_pk_bf16_f32 v250, v244, v245
    v_cvt_pk_bf16_f32 v249, v242, v243
    v_cvt_pk_bf16_f32 v248, v240, v241
    v_pk_fma_f32 v[232:233], v[16:17], v[48:49], v[232:233] op_sel_hi:[0,1,1]
    v_pk_fma_f32 v[234:235], v[16:17], v[50:51], v[234:235] op_sel_hi:[0,1,1]
    v_pk_fma_f32 v[236:237], v[16:17], v[52:53], v[236:237] op_sel_hi:[0,1,1]
    v_pk_fma_f32 v[238:239], v[16:17], v[54:55], v[238:239] op_sel_hi:[0,1,1]
    v_pk_mul_f32 v[232:233], v[16:17], v[232:233] op_sel:[1,0]
    v_pk_mul_f32 v[234:235], v[16:17], v[234:235] op_sel:[1,0]
    v_pk_mul_f32 v[236:237], v[16:17], v[236:237] op_sel:[1,0]
    v_pk_mul_f32 v[238:239], v[16:17], v[238:239] op_sel:[1,0]
    v_cvt_pk_bf16_f32 v247, v238, v239
    v_cvt_pk_bf16_f32 v246, v236, v237
    v_cvt_pk_bf16_f32 v245, v234, v235
    v_cvt_pk_bf16_f32 v244, v232, v233
    v_pk_fma_f32 v[224:225], v[14:15], v[48:49], v[224:225] op_sel_hi:[0,1,1]
    v_pk_fma_f32 v[226:227], v[14:15], v[50:51], v[226:227] op_sel_hi:[0,1,1]
    v_pk_fma_f32 v[228:229], v[14:15], v[52:53], v[228:229] op_sel_hi:[0,1,1]
    v_pk_fma_f32 v[230:231], v[14:15], v[54:55], v[230:231] op_sel_hi:[0,1,1]
    v_pk_mul_f32 v[224:225], v[14:15], v[224:225] op_sel:[1,0]
    v_pk_mul_f32 v[226:227], v[14:15], v[226:227] op_sel:[1,0]
    v_pk_mul_f32 v[228:229], v[14:15], v[228:229] op_sel:[1,0]
    v_pk_mul_f32 v[230:231], v[14:15], v[230:231] op_sel:[1,0]
    v_cvt_pk_bf16_f32 v243, v230, v231
    v_cvt_pk_bf16_f32 v242, v228, v229
    v_cvt_pk_bf16_f32 v241, v226, v227
    v_cvt_pk_bf16_f32 v240, v224, v225
    ds_read_b128 v[48:51], v36 offset:384
    ds_read_b128 v[52:55], v36 offset:448
    s_waitcnt lgkmcnt(2)
    v_pk_fma_f32 v[216:217], v[20:21], v[56:57], v[216:217] op_sel_hi:[0,1,1]
    v_pk_fma_f32 v[218:219], v[20:21], v[58:59], v[218:219] op_sel_hi:[0,1,1]
    v_pk_fma_f32 v[220:221], v[20:21], v[60:61], v[220:221] op_sel_hi:[0,1,1]
    v_pk_fma_f32 v[222:223], v[20:21], v[62:63], v[222:223] op_sel_hi:[0,1,1]
    v_pk_mul_f32 v[216:217], v[20:21], v[216:217] op_sel:[1,0]
    v_pk_mul_f32 v[218:219], v[20:21], v[218:219] op_sel:[1,0]
    v_pk_mul_f32 v[220:221], v[20:21], v[220:221] op_sel:[1,0]
    v_pk_mul_f32 v[222:223], v[20:21], v[222:223] op_sel:[1,0]
    v_cvt_pk_bf16_f32 v239, v222, v223
    v_cvt_pk_bf16_f32 v238, v220, v221
    v_cvt_pk_bf16_f32 v237, v218, v219
    v_cvt_pk_bf16_f32 v236, v216, v217
    v_pk_fma_f32 v[208:209], v[18:19], v[56:57], v[208:209] op_sel_hi:[0,1,1]
    v_pk_fma_f32 v[210:211], v[18:19], v[58:59], v[210:211] op_sel_hi:[0,1,1]
    v_pk_fma_f32 v[212:213], v[18:19], v[60:61], v[212:213] op_sel_hi:[0,1,1]
    v_pk_fma_f32 v[214:215], v[18:19], v[62:63], v[214:215] op_sel_hi:[0,1,1]
    v_pk_mul_f32 v[208:209], v[18:19], v[208:209] op_sel:[1,0]
    v_pk_mul_f32 v[210:211], v[18:19], v[210:211] op_sel:[1,0]
    v_pk_mul_f32 v[212:213], v[18:19], v[212:213] op_sel:[1,0]
    v_pk_mul_f32 v[214:215], v[18:19], v[214:215] op_sel:[1,0]
    v_cvt_pk_bf16_f32 v235, v214, v215
    v_cvt_pk_bf16_f32 v234, v212, v213
    v_cvt_pk_bf16_f32 v233, v210, v211
    v_cvt_pk_bf16_f32 v232, v208, v209
    v_pk_fma_f32 v[200:201], v[16:17], v[56:57], v[200:201] op_sel_hi:[0,1,1]
    v_pk_fma_f32 v[202:203], v[16:17], v[58:59], v[202:203] op_sel_hi:[0,1,1]
    v_pk_fma_f32 v[204:205], v[16:17], v[60:61], v[204:205] op_sel_hi:[0,1,1]
    v_pk_fma_f32 v[206:207], v[16:17], v[62:63], v[206:207] op_sel_hi:[0,1,1]
    v_pk_mul_f32 v[200:201], v[16:17], v[200:201] op_sel:[1,0]
    v_pk_mul_f32 v[202:203], v[16:17], v[202:203] op_sel:[1,0]
    v_pk_mul_f32 v[204:205], v[16:17], v[204:205] op_sel:[1,0]
    v_pk_mul_f32 v[206:207], v[16:17], v[206:207] op_sel:[1,0]
    v_cvt_pk_bf16_f32 v231, v206, v207
    v_cvt_pk_bf16_f32 v230, v204, v205
    v_cvt_pk_bf16_f32 v229, v202, v203
    v_cvt_pk_bf16_f32 v228, v200, v201
    v_pk_fma_f32 v[192:193], v[14:15], v[56:57], v[192:193] op_sel_hi:[0,1,1]
    v_pk_fma_f32 v[194:195], v[14:15], v[58:59], v[194:195] op_sel_hi:[0,1,1]
    v_pk_fma_f32 v[196:197], v[14:15], v[60:61], v[196:197] op_sel_hi:[0,1,1]
    v_pk_fma_f32 v[198:199], v[14:15], v[62:63], v[198:199] op_sel_hi:[0,1,1]
    v_pk_mul_f32 v[192:193], v[14:15], v[192:193] op_sel:[1,0]
    v_pk_mul_f32 v[194:195], v[14:15], v[194:195] op_sel:[1,0]
    v_pk_mul_f32 v[196:197], v[14:15], v[196:197] op_sel:[1,0]
    v_pk_mul_f32 v[198:199], v[14:15], v[198:199] op_sel:[1,0]
    v_cvt_pk_bf16_f32 v227, v198, v199
    v_cvt_pk_bf16_f32 v226, v196, v197
    v_cvt_pk_bf16_f32 v225, v194, v195
    v_cvt_pk_bf16_f32 v224, v192, v193
    ds_read_b128 v[56:59], v36 offset:256
    ds_read_b128 v[60:63], v36 offset:320
    s_waitcnt lgkmcnt(2)
    v_pk_fma_f32 v[184:185], v[20:21], v[48:49], v[184:185] op_sel_hi:[0,1,1]
    v_pk_fma_f32 v[186:187], v[20:21], v[50:51], v[186:187] op_sel_hi:[0,1,1]
    v_pk_fma_f32 v[188:189], v[20:21], v[52:53], v[188:189] op_sel_hi:[0,1,1]
    v_pk_fma_f32 v[190:191], v[20:21], v[54:55], v[190:191] op_sel_hi:[0,1,1]
    v_pk_mul_f32 v[184:185], v[20:21], v[184:185] op_sel:[1,0]
    v_pk_mul_f32 v[186:187], v[20:21], v[186:187] op_sel:[1,0]
    v_pk_mul_f32 v[188:189], v[20:21], v[188:189] op_sel:[1,0]
    v_pk_mul_f32 v[190:191], v[20:21], v[190:191] op_sel:[1,0]
    v_cvt_pk_bf16_f32 v223, v190, v191
    v_cvt_pk_bf16_f32 v222, v188, v189
    v_cvt_pk_bf16_f32 v221, v186, v187
    v_cvt_pk_bf16_f32 v220, v184, v185
    v_pk_fma_f32 v[176:177], v[18:19], v[48:49], v[176:177] op_sel_hi:[0,1,1]
    v_pk_fma_f32 v[178:179], v[18:19], v[50:51], v[178:179] op_sel_hi:[0,1,1]
    v_pk_fma_f32 v[180:181], v[18:19], v[52:53], v[180:181] op_sel_hi:[0,1,1]
    v_pk_fma_f32 v[182:183], v[18:19], v[54:55], v[182:183] op_sel_hi:[0,1,1]
    v_pk_mul_f32 v[176:177], v[18:19], v[176:177] op_sel:[1,0]
    v_pk_mul_f32 v[178:179], v[18:19], v[178:179] op_sel:[1,0]
    v_pk_mul_f32 v[180:181], v[18:19], v[180:181] op_sel:[1,0]
    v_pk_mul_f32 v[182:183], v[18:19], v[182:183] op_sel:[1,0]
    v_cvt_pk_bf16_f32 v219, v182, v183
    v_cvt_pk_bf16_f32 v218, v180, v181
    v_cvt_pk_bf16_f32 v217, v178, v179
    v_cvt_pk_bf16_f32 v216, v176, v177
    v_pk_fma_f32 v[168:169], v[16:17], v[48:49], v[168:169] op_sel_hi:[0,1,1]
    v_pk_fma_f32 v[170:171], v[16:17], v[50:51], v[170:171] op_sel_hi:[0,1,1]
    v_pk_fma_f32 v[172:173], v[16:17], v[52:53], v[172:173] op_sel_hi:[0,1,1]
    v_pk_fma_f32 v[174:175], v[16:17], v[54:55], v[174:175] op_sel_hi:[0,1,1]
    v_pk_mul_f32 v[168:169], v[16:17], v[168:169] op_sel:[1,0]
    v_pk_mul_f32 v[170:171], v[16:17], v[170:171] op_sel:[1,0]
    v_pk_mul_f32 v[172:173], v[16:17], v[172:173] op_sel:[1,0]
    v_pk_mul_f32 v[174:175], v[16:17], v[174:175] op_sel:[1,0]
    v_cvt_pk_bf16_f32 v215, v174, v175
    v_cvt_pk_bf16_f32 v214, v172, v173
    v_cvt_pk_bf16_f32 v213, v170, v171
    v_cvt_pk_bf16_f32 v212, v168, v169
    v_pk_fma_f32 v[160:161], v[14:15], v[48:49], v[160:161] op_sel_hi:[0,1,1]
    v_pk_fma_f32 v[162:163], v[14:15], v[50:51], v[162:163] op_sel_hi:[0,1,1]
    v_pk_fma_f32 v[164:165], v[14:15], v[52:53], v[164:165] op_sel_hi:[0,1,1]
    v_pk_fma_f32 v[166:167], v[14:15], v[54:55], v[166:167] op_sel_hi:[0,1,1]
    v_pk_mul_f32 v[160:161], v[14:15], v[160:161] op_sel:[1,0]
    v_pk_mul_f32 v[162:163], v[14:15], v[162:163] op_sel:[1,0]
    v_pk_mul_f32 v[164:165], v[14:15], v[164:165] op_sel:[1,0]
    v_pk_mul_f32 v[166:167], v[14:15], v[166:167] op_sel:[1,0]
    v_cvt_pk_bf16_f32 v211, v166, v167
    v_cvt_pk_bf16_f32 v210, v164, v165
    v_cvt_pk_bf16_f32 v209, v162, v163
    v_cvt_pk_bf16_f32 v208, v160, v161
    ds_read_b128 v[48:51], v36 offset:128
    ds_read_b128 v[52:55], v36 offset:192
    s_waitcnt lgkmcnt(2)
    v_pk_fma_f32 v[152:153], v[20:21], v[56:57], v[152:153] op_sel_hi:[0,1,1]
    v_pk_fma_f32 v[154:155], v[20:21], v[58:59], v[154:155] op_sel_hi:[0,1,1]
    v_pk_fma_f32 v[156:157], v[20:21], v[60:61], v[156:157] op_sel_hi:[0,1,1]
    v_pk_fma_f32 v[158:159], v[20:21], v[62:63], v[158:159] op_sel_hi:[0,1,1]
    v_pk_mul_f32 v[152:153], v[20:21], v[152:153] op_sel:[1,0]
    v_pk_mul_f32 v[154:155], v[20:21], v[154:155] op_sel:[1,0]
    v_pk_mul_f32 v[156:157], v[20:21], v[156:157] op_sel:[1,0]
    v_pk_mul_f32 v[158:159], v[20:21], v[158:159] op_sel:[1,0]
    v_cvt_pk_bf16_f32 v207, v158, v159
    v_cvt_pk_bf16_f32 v206, v156, v157
    v_cvt_pk_bf16_f32 v205, v154, v155
    v_cvt_pk_bf16_f32 v204, v152, v153
    v_pk_fma_f32 v[144:145], v[18:19], v[56:57], v[144:145] op_sel_hi:[0,1,1]
    v_pk_fma_f32 v[146:147], v[18:19], v[58:59], v[146:147] op_sel_hi:[0,1,1]
    v_pk_fma_f32 v[148:149], v[18:19], v[60:61], v[148:149] op_sel_hi:[0,1,1]
    v_pk_fma_f32 v[150:151], v[18:19], v[62:63], v[150:151] op_sel_hi:[0,1,1]
    v_pk_mul_f32 v[144:145], v[18:19], v[144:145] op_sel:[1,0]
    v_pk_mul_f32 v[146:147], v[18:19], v[146:147] op_sel:[1,0]
    v_pk_mul_f32 v[148:149], v[18:19], v[148:149] op_sel:[1,0]
    v_pk_mul_f32 v[150:151], v[18:19], v[150:151] op_sel:[1,0]
    v_cvt_pk_bf16_f32 v203, v150, v151
    v_cvt_pk_bf16_f32 v202, v148, v149
    v_cvt_pk_bf16_f32 v201, v146, v147
    v_cvt_pk_bf16_f32 v200, v144, v145
    v_pk_fma_f32 v[136:137], v[16:17], v[56:57], v[136:137] op_sel_hi:[0,1,1]
    v_pk_fma_f32 v[138:139], v[16:17], v[58:59], v[138:139] op_sel_hi:[0,1,1]
    v_pk_fma_f32 v[140:141], v[16:17], v[60:61], v[140:141] op_sel_hi:[0,1,1]
    v_pk_fma_f32 v[142:143], v[16:17], v[62:63], v[142:143] op_sel_hi:[0,1,1]
    v_pk_mul_f32 v[136:137], v[16:17], v[136:137] op_sel:[1,0]
    v_pk_mul_f32 v[138:139], v[16:17], v[138:139] op_sel:[1,0]
    v_pk_mul_f32 v[140:141], v[16:17], v[140:141] op_sel:[1,0]
    v_pk_mul_f32 v[142:143], v[16:17], v[142:143] op_sel:[1,0]
    v_cvt_pk_bf16_f32 v199, v142, v143
    v_cvt_pk_bf16_f32 v198, v140, v141
    v_cvt_pk_bf16_f32 v197, v138, v139
    v_cvt_pk_bf16_f32 v196, v136, v137
    v_pk_fma_f32 v[128:129], v[14:15], v[56:57], v[128:129] op_sel_hi:[0,1,1]
    v_pk_fma_f32 v[130:131], v[14:15], v[58:59], v[130:131] op_sel_hi:[0,1,1]
    v_pk_fma_f32 v[132:133], v[14:15], v[60:61], v[132:133] op_sel_hi:[0,1,1]
    v_pk_fma_f32 v[134:135], v[14:15], v[62:63], v[134:135] op_sel_hi:[0,1,1]
    v_pk_mul_f32 v[128:129], v[14:15], v[128:129] op_sel:[1,0]
    v_pk_mul_f32 v[130:131], v[14:15], v[130:131] op_sel:[1,0]
    v_pk_mul_f32 v[132:133], v[14:15], v[132:133] op_sel:[1,0]
    v_pk_mul_f32 v[134:135], v[14:15], v[134:135] op_sel:[1,0]
    v_cvt_pk_bf16_f32 v195, v134, v135
    v_cvt_pk_bf16_f32 v194, v132, v133
    v_cvt_pk_bf16_f32 v193, v130, v131
    v_cvt_pk_bf16_f32 v192, v128, v129
    ds_read_b128 v[56:59], v36 offset:0
    ds_read_b128 v[60:63], v36 offset:64
    s_waitcnt lgkmcnt(2)
    v_pk_fma_f32 v[120:121], v[20:21], v[48:49], v[120:121] op_sel_hi:[0,1,1]
    v_pk_fma_f32 v[122:123], v[20:21], v[50:51], v[122:123] op_sel_hi:[0,1,1]
    v_pk_fma_f32 v[124:125], v[20:21], v[52:53], v[124:125] op_sel_hi:[0,1,1]
    v_pk_fma_f32 v[126:127], v[20:21], v[54:55], v[126:127] op_sel_hi:[0,1,1]
    v_pk_mul_f32 v[120:121], v[20:21], v[120:121] op_sel:[1,0]
    v_pk_mul_f32 v[122:123], v[20:21], v[122:123] op_sel:[1,0]
    v_pk_mul_f32 v[124:125], v[20:21], v[124:125] op_sel:[1,0]
    v_pk_mul_f32 v[126:127], v[20:21], v[126:127] op_sel:[1,0]
    v_cvt_pk_bf16_f32 v191, v126, v127
    v_cvt_pk_bf16_f32 v190, v124, v125
    v_cvt_pk_bf16_f32 v189, v122, v123
    v_cvt_pk_bf16_f32 v188, v120, v121
    v_pk_fma_f32 v[112:113], v[18:19], v[48:49], v[112:113] op_sel_hi:[0,1,1]
    v_pk_fma_f32 v[114:115], v[18:19], v[50:51], v[114:115] op_sel_hi:[0,1,1]
    v_pk_fma_f32 v[116:117], v[18:19], v[52:53], v[116:117] op_sel_hi:[0,1,1]
    v_pk_fma_f32 v[118:119], v[18:19], v[54:55], v[118:119] op_sel_hi:[0,1,1]
    v_pk_mul_f32 v[112:113], v[18:19], v[112:113] op_sel:[1,0]
    v_pk_mul_f32 v[114:115], v[18:19], v[114:115] op_sel:[1,0]
    v_pk_mul_f32 v[116:117], v[18:19], v[116:117] op_sel:[1,0]
    v_pk_mul_f32 v[118:119], v[18:19], v[118:119] op_sel:[1,0]
    v_cvt_pk_bf16_f32 v187, v118, v119
    v_cvt_pk_bf16_f32 v186, v116, v117
    v_cvt_pk_bf16_f32 v185, v114, v115
    v_cvt_pk_bf16_f32 v184, v112, v113
    v_pk_fma_f32 v[104:105], v[16:17], v[48:49], v[104:105] op_sel_hi:[0,1,1]
    v_pk_fma_f32 v[106:107], v[16:17], v[50:51], v[106:107] op_sel_hi:[0,1,1]
    v_pk_fma_f32 v[108:109], v[16:17], v[52:53], v[108:109] op_sel_hi:[0,1,1]
    v_pk_fma_f32 v[110:111], v[16:17], v[54:55], v[110:111] op_sel_hi:[0,1,1]
    v_pk_mul_f32 v[104:105], v[16:17], v[104:105] op_sel:[1,0]
    v_pk_mul_f32 v[106:107], v[16:17], v[106:107] op_sel:[1,0]
    v_pk_mul_f32 v[108:109], v[16:17], v[108:109] op_sel:[1,0]
    v_pk_mul_f32 v[110:111], v[16:17], v[110:111] op_sel:[1,0]
    v_cvt_pk_bf16_f32 v183, v110, v111
    v_cvt_pk_bf16_f32 v182, v108, v109
    v_cvt_pk_bf16_f32 v181, v106, v107
    v_cvt_pk_bf16_f32 v180, v104, v105
    v_pk_fma_f32 v[96:97], v[14:15], v[48:49], v[96:97] op_sel_hi:[0,1,1]
    v_pk_fma_f32 v[98:99], v[14:15], v[50:51], v[98:99] op_sel_hi:[0,1,1]
    v_pk_fma_f32 v[100:101], v[14:15], v[52:53], v[100:101] op_sel_hi:[0,1,1]
    v_pk_fma_f32 v[102:103], v[14:15], v[54:55], v[102:103] op_sel_hi:[0,1,1]
    v_pk_mul_f32 v[96:97], v[14:15], v[96:97] op_sel:[1,0]
    v_pk_mul_f32 v[98:99], v[14:15], v[98:99] op_sel:[1,0]
    v_pk_mul_f32 v[100:101], v[14:15], v[100:101] op_sel:[1,0]
    v_pk_mul_f32 v[102:103], v[14:15], v[102:103] op_sel:[1,0]
    v_cvt_pk_bf16_f32 v179, v102, v103
    v_cvt_pk_bf16_f32 v178, v100, v101
    v_cvt_pk_bf16_f32 v177, v98, v99
    v_cvt_pk_bf16_f32 v176, v96, v97
    s_waitcnt lgkmcnt(0)
    v_pk_fma_f32 v[88:89], v[20:21], v[56:57], v[88:89] op_sel_hi:[0,1,1]
    v_pk_fma_f32 v[90:91], v[20:21], v[58:59], v[90:91] op_sel_hi:[0,1,1]
    v_pk_fma_f32 v[92:93], v[20:21], v[60:61], v[92:93] op_sel_hi:[0,1,1]
    v_pk_fma_f32 v[94:95], v[20:21], v[62:63], v[94:95] op_sel_hi:[0,1,1]
    v_pk_mul_f32 v[88:89], v[20:21], v[88:89] op_sel:[1,0]
    v_pk_mul_f32 v[90:91], v[20:21], v[90:91] op_sel:[1,0]
    v_pk_mul_f32 v[92:93], v[20:21], v[92:93] op_sel:[1,0]
    v_pk_mul_f32 v[94:95], v[20:21], v[94:95] op_sel:[1,0]
    v_cvt_pk_bf16_f32 v175, v94, v95
    v_cvt_pk_bf16_f32 v174, v92, v93
    v_cvt_pk_bf16_f32 v173, v90, v91
    v_cvt_pk_bf16_f32 v172, v88, v89
    v_pk_fma_f32 v[80:81], v[18:19], v[56:57], v[80:81] op_sel_hi:[0,1,1]
    v_pk_fma_f32 v[82:83], v[18:19], v[58:59], v[82:83] op_sel_hi:[0,1,1]
    v_pk_fma_f32 v[84:85], v[18:19], v[60:61], v[84:85] op_sel_hi:[0,1,1]
    v_pk_fma_f32 v[86:87], v[18:19], v[62:63], v[86:87] op_sel_hi:[0,1,1]
    v_pk_mul_f32 v[80:81], v[18:19], v[80:81] op_sel:[1,0]
    v_pk_mul_f32 v[82:83], v[18:19], v[82:83] op_sel:[1,0]
    v_pk_mul_f32 v[84:85], v[18:19], v[84:85] op_sel:[1,0]
    v_pk_mul_f32 v[86:87], v[18:19], v[86:87] op_sel:[1,0]
    v_cvt_pk_bf16_f32 v171, v86, v87
    v_cvt_pk_bf16_f32 v170, v84, v85
    v_cvt_pk_bf16_f32 v169, v82, v83
    v_cvt_pk_bf16_f32 v168, v80, v81
    v_pk_fma_f32 v[72:73], v[16:17], v[56:57], v[72:73] op_sel_hi:[0,1,1]
    v_pk_fma_f32 v[74:75], v[16:17], v[58:59], v[74:75] op_sel_hi:[0,1,1]
    v_pk_fma_f32 v[76:77], v[16:17], v[60:61], v[76:77] op_sel_hi:[0,1,1]
    v_pk_fma_f32 v[78:79], v[16:17], v[62:63], v[78:79] op_sel_hi:[0,1,1]
    v_pk_mul_f32 v[72:73], v[16:17], v[72:73] op_sel:[1,0]
    v_pk_mul_f32 v[74:75], v[16:17], v[74:75] op_sel:[1,0]
    v_pk_mul_f32 v[76:77], v[16:17], v[76:77] op_sel:[1,0]
    v_pk_mul_f32 v[78:79], v[16:17], v[78:79] op_sel:[1,0]
    v_cvt_pk_bf16_f32 v167, v78, v79
    v_cvt_pk_bf16_f32 v166, v76, v77
    v_cvt_pk_bf16_f32 v165, v74, v75
    v_cvt_pk_bf16_f32 v164, v72, v73
    v_pk_fma_f32 v[64:65], v[14:15], v[56:57], v[64:65] op_sel_hi:[0,1,1]
    v_pk_fma_f32 v[66:67], v[14:15], v[58:59], v[66:67] op_sel_hi:[0,1,1]
    v_pk_fma_f32 v[68:69], v[14:15], v[60:61], v[68:69] op_sel_hi:[0,1,1]
    v_pk_fma_f32 v[70:71], v[14:15], v[62:63], v[70:71] op_sel_hi:[0,1,1]
    v_pk_mul_f32 v[64:65], v[14:15], v[64:65] op_sel:[1,0]
    v_pk_mul_f32 v[66:67], v[14:15], v[66:67] op_sel:[1,0]
    v_pk_mul_f32 v[68:69], v[14:15], v[68:69] op_sel:[1,0]
    v_pk_mul_f32 v[70:71], v[14:15], v[70:71] op_sel:[1,0]
    v_cvt_pk_bf16_f32 v163, v70, v71
    v_cvt_pk_bf16_f32 v162, v68, v69
    v_cvt_pk_bf16_f32 v161, v66, v67
    v_cvt_pk_bf16_f32 v160, v64, v65
    ds_read_b128 v[64:67], v36 offset:768
    ds_read_b128 v[68:71], v36 offset:832
    ds_read_b128 v[72:75], v36 offset:896
    ds_read_b128 v[76:79], v36 offset:960
    ds_read_b128 v[80:83], v36 offset:1024
    ds_read_b128 v[84:87], v36 offset:1088
    ds_read_b128 a[192:195], v2 offset:0
    ds_read_b128 a[196:199], v3 offset:0
    ds_read_b128 a[200:203], v2 offset:128
    ds_read_b128 a[204:207], v3 offset:128
    ds_read_b128 a[208:211], v2 offset:256
    ds_read_b128 a[212:215], v3 offset:256
    s_waitcnt lgkmcnt(6)
    ds_read_b128 a[216:219], v2 offset:6144
    ds_read_b128 a[220:223], v3 offset:6144
    ds_read_b128 a[224:227], v2 offset:6272
    ds_read_b128 a[228:231], v3 offset:6272
    ds_read_b128 a[232:235], v2 offset:6400
    ds_read_b128 a[236:239], v3 offset:6400
    v_accvgpr_read_b32 v96, a0
    v_accvgpr_read_b32 v97, a1
    v_accvgpr_read_b32 v98, a2
    v_accvgpr_read_b32 v99, a3
    v_accvgpr_read_b32 v100, a48
    v_accvgpr_read_b32 v101, a49
    v_accvgpr_read_b32 v102, a50
    v_accvgpr_read_b32 v103, a51
    v_pk_fma_f32 v[96:97], v[14:15], v[64:65], v[96:97] op_sel_hi:[0,1,1]
    v_pk_fma_f32 v[98:99], v[14:15], v[66:67], v[98:99] op_sel_hi:[0,1,1]
    v_pk_fma_f32 v[100:101], v[14:15], v[76:77], v[100:101] op_sel_hi:[0,1,1]
    v_pk_fma_f32 v[102:103], v[14:15], v[78:79], v[102:103] op_sel_hi:[0,1,1]
    v_pk_mul_f32 v[104:105], v[40:41], v[96:97] op_sel_hi:[0,1]
    v_pk_mul_f32 v[106:107], v[40:41], v[98:99] op_sel_hi:[0,1]
    v_exp_f32 v104, v104
    v_exp_f32 v105, v105
    v_exp_f32 v106, v106
    v_exp_f32 v107, v107
    v_pk_mul_f32 v[96:97], v[96:97], v[100:101]
    v_pk_mul_f32 v[98:99], v[98:99], v[102:103]
    v_pk_fma_f32 v[104:105], v[104:105], v[40:41], v[40:41] op_sel:[0,1,1]
    v_pk_fma_f32 v[106:107], v[106:107], v[40:41], v[40:41] op_sel:[0,1,1]
    v_rcp_f32 v104, v104
    v_rcp_f32 v105, v105
    v_rcp_f32 v106, v106
    v_rcp_f32 v107, v107
    s_nop 0
    v_pk_mul_f32 v[96:97], v[96:97], v[104:105]
    v_pk_mul_f32 v[98:99], v[98:99], v[106:107]
    v_cvt_pk_bf16_f32 v148, v96, v97
    v_cvt_pk_bf16_f32 v149, v98, v99
    v_accvgpr_read_b32 v108, a16
    v_accvgpr_read_b32 v109, a17
    v_accvgpr_read_b32 v110, a18
    v_accvgpr_read_b32 v111, a19
    v_accvgpr_read_b32 v112, a64
    v_accvgpr_read_b32 v113, a65
    v_accvgpr_read_b32 v114, a66
    v_accvgpr_read_b32 v115, a67
    v_pk_fma_f32 v[108:109], v[14:15], v[68:69], v[108:109] op_sel_hi:[0,1,1]
    v_pk_fma_f32 v[110:111], v[14:15], v[70:71], v[110:111] op_sel_hi:[0,1,1]
    v_pk_fma_f32 v[112:113], v[14:15], v[80:81], v[112:113] op_sel_hi:[0,1,1]
    v_pk_fma_f32 v[114:115], v[14:15], v[82:83], v[114:115] op_sel_hi:[0,1,1]
    v_pk_mul_f32 v[116:117], v[40:41], v[108:109] op_sel_hi:[0,1]
    v_pk_mul_f32 v[118:119], v[40:41], v[110:111] op_sel_hi:[0,1]
    v_exp_f32 v116, v116
    v_exp_f32 v117, v117
    v_exp_f32 v118, v118
    v_exp_f32 v119, v119
    v_pk_mul_f32 v[108:109], v[108:109], v[112:113]
    v_pk_mul_f32 v[110:111], v[110:111], v[114:115]
    v_pk_fma_f32 v[116:117], v[116:117], v[40:41], v[40:41] op_sel:[0,1,1]
    v_pk_fma_f32 v[118:119], v[118:119], v[40:41], v[40:41] op_sel:[0,1,1]
    v_rcp_f32 v116, v116
    v_rcp_f32 v117, v117
    v_rcp_f32 v118, v118
    v_rcp_f32 v119, v119
    s_nop 0
    v_pk_mul_f32 v[108:109], v[108:109], v[116:117]
    v_pk_mul_f32 v[110:111], v[110:111], v[118:119]
    v_cvt_pk_bf16_f32 v150, v108, v109
    v_cvt_pk_bf16_f32 v151, v110, v111
    buffer_store_dwordx4 v[148:151], v39, s[24:27], s37 offen sc1
    s_add_u32 s37, s37, 245760
    v_accvgpr_read_b32 v120, a32
    v_accvgpr_read_b32 v121, a33
    v_accvgpr_read_b32 v122, a34
    v_accvgpr_read_b32 v123, a35
    v_accvgpr_read_b32 v124, a80
    v_accvgpr_read_b32 v125, a81
    v_accvgpr_read_b32 v126, a82
    v_accvgpr_read_b32 v127, a83
    v_pk_fma_f32 v[120:121], v[14:15], v[72:73], v[120:121] op_sel_hi:[0,1,1]
    v_pk_fma_f32 v[122:123], v[14:15], v[74:75], v[122:123] op_sel_hi:[0,1,1]
    v_pk_fma_f32 v[124:125], v[14:15], v[84:85], v[124:125] op_sel_hi:[0,1,1]
    v_pk_fma_f32 v[126:127], v[14:15], v[86:87], v[126:127] op_sel_hi:[0,1,1]
    v_pk_mul_f32 v[128:129], v[40:41], v[120:121] op_sel_hi:[0,1]
    v_pk_mul_f32 v[130:131], v[40:41], v[122:123] op_sel_hi:[0,1]
    v_exp_f32 v128, v128
    v_exp_f32 v129, v129
    v_exp_f32 v130, v130
    v_exp_f32 v131, v131
    v_pk_mul_f32 v[120:121], v[120:121], v[124:125]
    v_pk_mul_f32 v[122:123], v[122:123], v[126:127]
    v_pk_fma_f32 v[128:129], v[128:129], v[40:41], v[40:41] op_sel:[0,1,1]
    v_pk_fma_f32 v[130:131], v[130:131], v[40:41], v[40:41] op_sel:[0,1,1]
    v_rcp_f32 v128, v128
    v_rcp_f32 v129, v129
    v_rcp_f32 v130, v130
    v_rcp_f32 v131, v131
    s_nop 0
    v_pk_mul_f32 v[120:121], v[120:121], v[128:129]
    v_pk_mul_f32 v[122:123], v[122:123], v[130:131]
    v_cvt_pk_bf16_f32 v152, v120, v121
    v_cvt_pk_bf16_f32 v153, v122, v123
    buffer_store_dwordx2 v[152:153], v37, s[24:27], s38 offen sc1
    s_add_u32 s38, s38, 245760
    v_accvgpr_read_b32 v132, a4
    v_accvgpr_read_b32 v133, a5
    v_accvgpr_read_b32 v134, a6
    v_accvgpr_read_b32 v135, a7
    v_accvgpr_read_b32 v136, a52
    v_accvgpr_read_b32 v137, a53
    v_accvgpr_read_b32 v138, a54
    v_accvgpr_read_b32 v139, a55
    v_pk_fma_f32 v[132:133], v[16:17], v[64:65], v[132:133] op_sel_hi:[0,1,1]
    v_pk_fma_f32 v[134:135], v[16:17], v[66:67], v[134:135] op_sel_hi:[0,1,1]
    v_pk_fma_f32 v[136:137], v[16:17], v[76:77], v[136:137] op_sel_hi:[0,1,1]
    v_pk_fma_f32 v[138:139], v[16:17], v[78:79], v[138:139] op_sel_hi:[0,1,1]
    v_pk_mul_f32 v[140:141], v[42:43], v[132:133] op_sel_hi:[0,1]
    v_pk_mul_f32 v[142:143], v[42:43], v[134:135] op_sel_hi:[0,1]
    v_exp_f32 v140, v140
    v_exp_f32 v141, v141
    v_exp_f32 v142, v142
    v_exp_f32 v143, v143
    v_pk_mul_f32 v[132:133], v[132:133], v[136:137]
    v_pk_mul_f32 v[134:135], v[134:135], v[138:139]
    v_pk_fma_f32 v[140:141], v[140:141], v[42:43], v[42:43] op_sel:[0,1,1]
    v_pk_fma_f32 v[142:143], v[142:143], v[42:43], v[42:43] op_sel:[0,1,1]
    v_rcp_f32 v140, v140
    v_rcp_f32 v141, v141
    v_rcp_f32 v142, v142
    v_rcp_f32 v143, v143
    s_nop 0
    v_pk_mul_f32 v[132:133], v[132:133], v[140:141]
    v_pk_mul_f32 v[134:135], v[134:135], v[142:143]
    v_cvt_pk_bf16_f32 v154, v132, v133
    v_cvt_pk_bf16_f32 v155, v134, v135
    v_accvgpr_read_b32 v96, a20
    v_accvgpr_read_b32 v97, a21
    v_accvgpr_read_b32 v98, a22
    v_accvgpr_read_b32 v99, a23
    v_accvgpr_read_b32 v100, a68
    v_accvgpr_read_b32 v101, a69
    v_accvgpr_read_b32 v102, a70
    v_accvgpr_read_b32 v103, a71
    v_pk_fma_f32 v[96:97], v[16:17], v[68:69], v[96:97] op_sel_hi:[0,1,1]
    v_pk_fma_f32 v[98:99], v[16:17], v[70:71], v[98:99] op_sel_hi:[0,1,1]
    v_pk_fma_f32 v[100:101], v[16:17], v[80:81], v[100:101] op_sel_hi:[0,1,1]
    v_pk_fma_f32 v[102:103], v[16:17], v[82:83], v[102:103] op_sel_hi:[0,1,1]
    v_pk_mul_f32 v[104:105], v[42:43], v[96:97] op_sel_hi:[0,1]
    v_pk_mul_f32 v[106:107], v[42:43], v[98:99] op_sel_hi:[0,1]
    v_exp_f32 v104, v104
    v_exp_f32 v105, v105
    v_exp_f32 v106, v106
    v_exp_f32 v107, v107
    v_pk_mul_f32 v[96:97], v[96:97], v[100:101]
    v_pk_mul_f32 v[98:99], v[98:99], v[102:103]
    v_pk_fma_f32 v[104:105], v[104:105], v[42:43], v[42:43] op_sel:[0,1,1]
    v_pk_fma_f32 v[106:107], v[106:107], v[42:43], v[42:43] op_sel:[0,1,1]
    v_rcp_f32 v104, v104
    v_rcp_f32 v105, v105
    v_rcp_f32 v106, v106
    v_rcp_f32 v107, v107
    s_nop 0
    v_pk_mul_f32 v[96:97], v[96:97], v[104:105]
    v_pk_mul_f32 v[98:99], v[98:99], v[106:107]
    v_cvt_pk_bf16_f32 v156, v96, v97
    v_cvt_pk_bf16_f32 v157, v98, v99
    buffer_store_dwordx4 v[154:157], v39, s[24:27], s37 offen sc1
    s_add_u32 s37, s37, 245760
    v_accvgpr_read_b32 v108, a36
    v_accvgpr_read_b32 v109, a37
    v_accvgpr_read_b32 v110, a38
    v_accvgpr_read_b32 v111, a39
    v_accvgpr_read_b32 v112, a84
    v_accvgpr_read_b32 v113, a85
    v_accvgpr_read_b32 v114, a86
    v_accvgpr_read_b32 v115, a87
    v_pk_fma_f32 v[108:109], v[16:17], v[72:73], v[108:109] op_sel_hi:[0,1,1]
    v_pk_fma_f32 v[110:111], v[16:17], v[74:75], v[110:111] op_sel_hi:[0,1,1]
    v_pk_fma_f32 v[112:113], v[16:17], v[84:85], v[112:113] op_sel_hi:[0,1,1]
    v_pk_fma_f32 v[114:115], v[16:17], v[86:87], v[114:115] op_sel_hi:[0,1,1]
    v_pk_mul_f32 v[116:117], v[42:43], v[108:109] op_sel_hi:[0,1]
    v_pk_mul_f32 v[118:119], v[42:43], v[110:111] op_sel_hi:[0,1]
    v_exp_f32 v116, v116
    v_exp_f32 v117, v117
    v_exp_f32 v118, v118
    v_exp_f32 v119, v119
    v_pk_mul_f32 v[108:109], v[108:109], v[112:113]
    v_pk_mul_f32 v[110:111], v[110:111], v[114:115]
    v_pk_fma_f32 v[116:117], v[116:117], v[42:43], v[42:43] op_sel:[0,1,1]
    v_pk_fma_f32 v[118:119], v[118:119], v[42:43], v[42:43] op_sel:[0,1,1]
    v_rcp_f32 v116, v116
    v_rcp_f32 v117, v117
    v_rcp_f32 v118, v118
    v_rcp_f32 v119, v119
    s_nop 0
    v_pk_mul_f32 v[108:109], v[108:109], v[116:117]
    v_pk_mul_f32 v[110:111], v[110:111], v[118:119]
    v_cvt_pk_bf16_f32 v158, v108, v109
    v_cvt_pk_bf16_f32 v159, v110, v111
    buffer_store_dwordx2 v[158:159], v37, s[24:27], s38 offen sc1
    s_add_u32 s38, s38, 245760
    v_accvgpr_read_b32 v120, a8
    v_accvgpr_read_b32 v121, a9
    v_accvgpr_read_b32 v122, a10
    v_accvgpr_read_b32 v123, a11
    v_accvgpr_read_b32 v124, a56
    v_accvgpr_read_b32 v125, a57
    v_accvgpr_read_b32 v126, a58
    v_accvgpr_read_b32 v127, a59
    v_pk_fma_f32 v[120:121], v[18:19], v[64:65], v[120:121] op_sel_hi:[0,1,1]
    v_pk_fma_f32 v[122:123], v[18:19], v[66:67], v[122:123] op_sel_hi:[0,1,1]
    v_pk_fma_f32 v[124:125], v[18:19], v[76:77], v[124:125] op_sel_hi:[0,1,1]
    v_pk_fma_f32 v[126:127], v[18:19], v[78:79], v[126:127] op_sel_hi:[0,1,1]
    v_pk_mul_f32 v[128:129], v[44:45], v[120:121] op_sel_hi:[0,1]
    v_pk_mul_f32 v[130:131], v[44:45], v[122:123] op_sel_hi:[0,1]
    v_exp_f32 v128, v128
    v_exp_f32 v129, v129
    v_exp_f32 v130, v130
    v_exp_f32 v131, v131
    v_pk_mul_f32 v[120:121], v[120:121], v[124:125]
    v_pk_mul_f32 v[122:123], v[122:123], v[126:127]
    v_pk_fma_f32 v[128:129], v[128:129], v[44:45], v[44:45] op_sel:[0,1,1]
    v_pk_fma_f32 v[130:131], v[130:131], v[44:45], v[44:45] op_sel:[0,1,1]
    v_rcp_f32 v128, v128
    v_rcp_f32 v129, v129
    v_rcp_f32 v130, v130
    v_rcp_f32 v131, v131
    s_nop 0
    v_pk_mul_f32 v[120:121], v[120:121], v[128:129]
    v_pk_mul_f32 v[122:123], v[122:123], v[130:131]
    v_cvt_pk_bf16_f32 v148, v120, v121
    v_cvt_pk_bf16_f32 v149, v122, v123
    v_accvgpr_read_b32 v132, a24
    v_accvgpr_read_b32 v133, a25
    v_accvgpr_read_b32 v134, a26
    v_accvgpr_read_b32 v135, a27
    v_accvgpr_read_b32 v136, a72
    v_accvgpr_read_b32 v137, a73
    v_accvgpr_read_b32 v138, a74
    v_accvgpr_read_b32 v139, a75
    v_pk_fma_f32 v[132:133], v[18:19], v[68:69], v[132:133] op_sel_hi:[0,1,1]
    v_pk_fma_f32 v[134:135], v[18:19], v[70:71], v[134:135] op_sel_hi:[0,1,1]
    v_pk_fma_f32 v[136:137], v[18:19], v[80:81], v[136:137] op_sel_hi:[0,1,1]
    v_pk_fma_f32 v[138:139], v[18:19], v[82:83], v[138:139] op_sel_hi:[0,1,1]
    v_pk_mul_f32 v[140:141], v[44:45], v[132:133] op_sel_hi:[0,1]
    v_pk_mul_f32 v[142:143], v[44:45], v[134:135] op_sel_hi:[0,1]
    v_exp_f32 v140, v140
    v_exp_f32 v141, v141
    v_exp_f32 v142, v142
    v_exp_f32 v143, v143
    v_pk_mul_f32 v[132:133], v[132:133], v[136:137]
    v_pk_mul_f32 v[134:135], v[134:135], v[138:139]
    v_pk_fma_f32 v[140:141], v[140:141], v[44:45], v[44:45] op_sel:[0,1,1]
    v_pk_fma_f32 v[142:143], v[142:143], v[44:45], v[44:45] op_sel:[0,1,1]
    v_rcp_f32 v140, v140
    v_rcp_f32 v141, v141
    v_rcp_f32 v142, v142
    v_rcp_f32 v143, v143
    s_nop 0
    v_pk_mul_f32 v[132:133], v[132:133], v[140:141]
    v_pk_mul_f32 v[134:135], v[134:135], v[142:143]
    v_cvt_pk_bf16_f32 v150, v132, v133
    v_cvt_pk_bf16_f32 v151, v134, v135
    buffer_store_dwordx4 v[148:151], v39, s[24:27], s37 offen sc1
    s_add_u32 s37, s37, 245760
    v_accvgpr_read_b32 v96, a40
    v_accvgpr_read_b32 v97, a41
    v_accvgpr_read_b32 v98, a42
    v_accvgpr_read_b32 v99, a43
    v_accvgpr_read_b32 v100, a88
    v_accvgpr_read_b32 v101, a89
    v_accvgpr_read_b32 v102, a90
    v_accvgpr_read_b32 v103, a91
    v_pk_fma_f32 v[96:97], v[18:19], v[72:73], v[96:97] op_sel_hi:[0,1,1]
    v_pk_fma_f32 v[98:99], v[18:19], v[74:75], v[98:99] op_sel_hi:[0,1,1]
    v_pk_fma_f32 v[100:101], v[18:19], v[84:85], v[100:101] op_sel_hi:[0,1,1]
    v_pk_fma_f32 v[102:103], v[18:19], v[86:87], v[102:103] op_sel_hi:[0,1,1]
    v_pk_mul_f32 v[104:105], v[44:45], v[96:97] op_sel_hi:[0,1]
    v_pk_mul_f32 v[106:107], v[44:45], v[98:99] op_sel_hi:[0,1]
    v_exp_f32 v104, v104
    v_exp_f32 v105, v105
    v_exp_f32 v106, v106
    v_exp_f32 v107, v107
    v_pk_mul_f32 v[96:97], v[96:97], v[100:101]
    v_pk_mul_f32 v[98:99], v[98:99], v[102:103]
    v_pk_fma_f32 v[104:105], v[104:105], v[44:45], v[44:45] op_sel:[0,1,1]
    v_pk_fma_f32 v[106:107], v[106:107], v[44:45], v[44:45] op_sel:[0,1,1]
    v_rcp_f32 v104, v104
    v_rcp_f32 v105, v105
    v_rcp_f32 v106, v106
    v_rcp_f32 v107, v107
    s_nop 0
    v_pk_mul_f32 v[96:97], v[96:97], v[104:105]
    v_pk_mul_f32 v[98:99], v[98:99], v[106:107]
    v_cvt_pk_bf16_f32 v152, v96, v97
    v_cvt_pk_bf16_f32 v153, v98, v99
    buffer_store_dwordx2 v[152:153], v37, s[24:27], s38 offen sc1
    s_add_u32 s38, s38, 245760
    v_accvgpr_read_b32 v108, a12
    v_accvgpr_read_b32 v109, a13
    v_accvgpr_read_b32 v110, a14
    v_accvgpr_read_b32 v111, a15
    v_accvgpr_read_b32 v112, a60
    v_accvgpr_read_b32 v113, a61
    v_accvgpr_read_b32 v114, a62
    v_accvgpr_read_b32 v115, a63
    v_pk_fma_f32 v[108:109], v[20:21], v[64:65], v[108:109] op_sel_hi:[0,1,1]
    v_pk_fma_f32 v[110:111], v[20:21], v[66:67], v[110:111] op_sel_hi:[0,1,1]
    v_pk_fma_f32 v[112:113], v[20:21], v[76:77], v[112:113] op_sel_hi:[0,1,1]
    v_pk_fma_f32 v[114:115], v[20:21], v[78:79], v[114:115] op_sel_hi:[0,1,1]
    v_pk_mul_f32 v[116:117], v[46:47], v[108:109] op_sel_hi:[0,1]
    v_pk_mul_f32 v[118:119], v[46:47], v[110:111] op_sel_hi:[0,1]
    v_exp_f32 v116, v116
    v_exp_f32 v117, v117
    v_exp_f32 v118, v118
    v_exp_f32 v119, v119
    v_pk_mul_f32 v[108:109], v[108:109], v[112:113]
    v_pk_mul_f32 v[110:111], v[110:111], v[114:115]
    v_pk_fma_f32 v[116:117], v[116:117], v[46:47], v[46:47] op_sel:[0,1,1]
    v_pk_fma_f32 v[118:119], v[118:119], v[46:47], v[46:47] op_sel:[0,1,1]
    v_rcp_f32 v116, v116
    v_rcp_f32 v117, v117
    v_rcp_f32 v118, v118
    v_rcp_f32 v119, v119
    s_nop 0
    v_pk_mul_f32 v[108:109], v[108:109], v[116:117]
    v_pk_mul_f32 v[110:111], v[110:111], v[118:119]
    v_cvt_pk_bf16_f32 v154, v108, v109
    v_cvt_pk_bf16_f32 v155, v110, v111
    v_accvgpr_read_b32 v120, a28
    v_accvgpr_read_b32 v121, a29
    v_accvgpr_read_b32 v122, a30
    v_accvgpr_read_b32 v123, a31
    v_accvgpr_read_b32 v124, a76
    v_accvgpr_read_b32 v125, a77
    v_accvgpr_read_b32 v126, a78
    v_accvgpr_read_b32 v127, a79
    v_pk_fma_f32 v[120:121], v[20:21], v[68:69], v[120:121] op_sel_hi:[0,1,1]
    v_pk_fma_f32 v[122:123], v[20:21], v[70:71], v[122:123] op_sel_hi:[0,1,1]
    v_pk_fma_f32 v[124:125], v[20:21], v[80:81], v[124:125] op_sel_hi:[0,1,1]
    v_pk_fma_f32 v[126:127], v[20:21], v[82:83], v[126:127] op_sel_hi:[0,1,1]
    v_pk_mul_f32 v[128:129], v[46:47], v[120:121] op_sel_hi:[0,1]
    v_pk_mul_f32 v[130:131], v[46:47], v[122:123] op_sel_hi:[0,1]
    v_exp_f32 v128, v128
    v_exp_f32 v129, v129
    v_exp_f32 v130, v130
    v_exp_f32 v131, v131
    v_pk_mul_f32 v[120:121], v[120:121], v[124:125]
    v_pk_mul_f32 v[122:123], v[122:123], v[126:127]
    v_pk_fma_f32 v[128:129], v[128:129], v[46:47], v[46:47] op_sel:[0,1,1]
    v_pk_fma_f32 v[130:131], v[130:131], v[46:47], v[46:47] op_sel:[0,1,1]
    v_rcp_f32 v128, v128
    v_rcp_f32 v129, v129
    v_rcp_f32 v130, v130
    v_rcp_f32 v131, v131
    s_nop 0
    v_pk_mul_f32 v[120:121], v[120:121], v[128:129]
    v_pk_mul_f32 v[122:123], v[122:123], v[130:131]
    v_cvt_pk_bf16_f32 v156, v120, v121
    v_cvt_pk_bf16_f32 v157, v122, v123
    buffer_store_dwordx4 v[154:157], v39, s[24:27], s37 offen sc1
    s_add_u32 s37, s37, 245760
    v_accvgpr_read_b32 v132, a44
    v_accvgpr_read_b32 v133, a45
    v_accvgpr_read_b32 v134, a46
    v_accvgpr_read_b32 v135, a47
    v_accvgpr_read_b32 v136, a92
    v_accvgpr_read_b32 v137, a93
    v_accvgpr_read_b32 v138, a94
    v_accvgpr_read_b32 v139, a95
    v_pk_fma_f32 v[132:133], v[20:21], v[72:73], v[132:133] op_sel_hi:[0,1,1]
    v_pk_fma_f32 v[134:135], v[20:21], v[74:75], v[134:135] op_sel_hi:[0,1,1]
    v_pk_fma_f32 v[136:137], v[20:21], v[84:85], v[136:137] op_sel_hi:[0,1,1]
    v_pk_fma_f32 v[138:139], v[20:21], v[86:87], v[138:139] op_sel_hi:[0,1,1]
    v_pk_mul_f32 v[140:141], v[46:47], v[132:133] op_sel_hi:[0,1]
    v_pk_mul_f32 v[142:143], v[46:47], v[134:135] op_sel_hi:[0,1]
    v_exp_f32 v140, v140
    v_exp_f32 v141, v141
    v_exp_f32 v142, v142
    v_exp_f32 v143, v143
    v_pk_mul_f32 v[132:133], v[132:133], v[136:137]
    v_pk_mul_f32 v[134:135], v[134:135], v[138:139]
    v_pk_fma_f32 v[140:141], v[140:141], v[46:47], v[46:47] op_sel:[0,1,1]
    v_pk_fma_f32 v[142:143], v[142:143], v[46:47], v[46:47] op_sel:[0,1,1]
    v_rcp_f32 v140, v140
    v_rcp_f32 v141, v141
    v_rcp_f32 v142, v142
    v_rcp_f32 v143, v143
    s_nop 0
    v_pk_mul_f32 v[132:133], v[132:133], v[140:141]
    v_pk_mul_f32 v[134:135], v[134:135], v[142:143]
    v_cvt_pk_bf16_f32 v158, v132, v133
    v_cvt_pk_bf16_f32 v159, v134, v135
    buffer_store_dwordx2 v[158:159], v37, s[24:27], s38 offen sc1
    s_add_u32 s38, s38, 245760
    s_waitcnt lgkmcnt(0)
    s_nop 1
    v_mfma_f32_16x16x32_bf16 v[96:99], a[192:195], v[160:163], 0
    s_mov_b32 s55, 0
    s_mov_b32 s30, 36864
    v_mfma_f32_16x16x32_bf16 v[96:99], a[196:199], v[176:179], v[96:99]
    s_cmp_eq_u32 s28, 0
    s_cselect_b32 s59, 4, 1
    v_mfma_f32_16x16x32_bf16 v[96:99], a[200:203], v[192:195], v[96:99]
    s_mov_b32 s56, 0
    s_mov_b32 s57, 0
    v_mfma_f32_16x16x32_bf16 v[96:99], a[204:207], v[208:211], v[96:99]
    s_mul_i32 s33, s28, 491520
    v_add_u32 v26, s33, v39
    v_mfma_f32_16x16x32_bf16 v[96:99], a[208:211], v[224:227], v[96:99]
    v_add_u32 v27, 243712, v26
    s_lshr_b32 s33, s28, 1
    v_mfma_f32_16x16x32_bf16 v[96:99], a[212:215], v[240:243], v[96:99]
    s_mul_i32 s33, s33, 40960
    s_and_b32 s35, s28, 1
    v_mfma_f32_16x16x32_bf16 v[100:103], a[212:215], v[244:247], 0
    s_mul_i32 s35, s35, 5120
    s_add_u32 s33, s33, s35
    v_mfma_f32_16x16x32_bf16 v[100:103], a[208:211], v[228:231], v[100:103]
    v_add_u32 v28, s33, v39
    v_add_u32 v29, 4096, v28
    v_mfma_f32_16x16x32_bf16 v[100:103], a[204:207], v[212:215], v[100:103]
    v_mov_b32 v18, -1
    v_mov_b32 v19, -1
    v_mfma_f32_16x16x32_bf16 v[100:103], a[200:203], v[196:199], v[100:103]
    v_mov_b32 v20, -1
    v_mov_b32 v21, -1
    v_mfma_f32_16x16x32_bf16 v[100:103], a[196:199], v[180:183], v[100:103]
    v_and_b32 v25, 7, v0
    v_lshlrev_b32 v25, 3, v25
    v_mfma_f32_16x16x32_bf16 v[100:103], a[192:195], v[164:167], v[100:103]
    v_mov_b32 v23, 0
    s_mov_b64 exec, 3
    global_store_dword v1, v23, s[52:53] sc1
    s_mov_b64 exec, -1
    v_mfma_f32_16x16x32_bf16 v[104:107], a[192:195], v[168:171], 0
    v_mov_b32 v40, 0
    v_mov_b32 v41, 0
    v_mfma_f32_16x16x32_bf16 v[104:107], a[196:199], v[184:187], v[104:107]
    v_mov_b32 v42, 0
    v_mov_b32 v43, 0
    v_mfma_f32_16x16x32_bf16 v[104:107], a[200:203], v[200:203], v[104:107]
    v_mov_b32 v44, 0
    v_mov_b32 v45, 0
    v_mfma_f32_16x16x32_bf16 v[104:107], a[204:207], v[216:219], v[104:107]
    v_mov_b32 v46, 0
    v_mov_b32 v47, 0
    v_mfma_f32_16x16x32_bf16 v[104:107], a[208:211], v[232:235], v[104:107]
    v_mfma_f32_16x16x32_bf16 v[104:107], a[212:215], v[248:251], v[104:107]
    v_mfma_f32_16x16x32_bf16 v[108:111], a[212:215], v[252:255], 0
    v_mfma_f32_16x16x32_bf16 v[108:111], a[208:211], v[236:239], v[108:111]
    v_mfma_f32_16x16x32_bf16 v[108:111], a[204:207], v[220:223], v[108:111]
    v_mfma_f32_16x16x32_bf16 v[108:111], a[200:203], v[204:207], v[108:111]
    v_mfma_f32_16x16x32_bf16 v[108:111], a[196:199], v[188:191], v[108:111]
    v_mfma_f32_16x16x32_bf16 v[108:111], a[192:195], v[172:175], v[108:111]
    v_mfma_f32_16x16x32_bf16 v[48:51], a[216:219], v[160:163], 0
    s_waitcnt vmcnt(9)
    s_barrier
    v_mfma_f32_16x16x32_bf16 v[48:51], a[220:223], v[176:179], v[48:51]
    ds_read_b128 a[192:195], v2 offset:18432
    v_mfma_f32_16x16x32_bf16 v[48:51], a[224:227], v[192:195], v[48:51]
    ds_read_b128 a[196:199], v3 offset:18432
    v_mfma_f32_16x16x32_bf16 v[48:51], a[228:231], v[208:211], v[48:51]
    ds_read_b128 a[200:203], v2 offset:18560
    v_mfma_f32_16x16x32_bf16 v[48:51], a[232:235], v[224:227], v[48:51]
    ds_read_b128 a[204:207], v3 offset:18560
    v_mfma_f32_16x16x32_bf16 v[48:51], a[236:239], v[240:243], v[48:51]
    ds_read_b128 a[208:211], v2 offset:18688
    ds_read_b128 a[212:215], v3 offset:18688
    v_mfma_f32_16x16x32_bf16 v[52:55], a[236:239], v[244:247], 0
    v_max3_f32 v22, v96, v97, v98
    v_max_f32 v22, v22, v99
    v_mfma_f32_16x16x32_bf16 v[52:55], a[232:235], v[228:231], v[52:55]
    v_max3_f32 v24, v100, v101, v102
    v_max_f32 v24, v24, v103
    v_mfma_f32_16x16x32_bf16 v[52:55], a[228:231], v[212:215], v[52:55]
    v_max3_f32 v36, v104, v105, v106
    v_max_f32 v36, v36, v107
    v_mfma_f32_16x16x32_bf16 v[52:55], a[224:227], v[196:199], v[52:55]
    v_max3_f32 v38, v108, v109, v110
    v_max_f32 v38, v38, v111
    v_mfma_f32_16x16x32_bf16 v[52:55], a[220:223], v[180:183], v[52:55]
    v_mov_b32 v14, v22
    v_mov_b32 v15, v24
    v_mfma_f32_16x16x32_bf16 v[52:55], a[216:219], v[164:167], v[52:55]
    v_mov_b32 v16, v36
    v_mov_b32 v17, v38
    v_mfma_f32_16x16x32_bf16 v[56:59], a[216:219], v[168:171], 0
    s_nop 1
    v_permlane32_swap_b32 v14, v22
    v_mfma_f32_16x16x32_bf16 v[56:59], a[220:223], v[184:187], v[56:59]
    v_permlane32_swap_b32 v15, v24
    v_permlane32_swap_b32 v16, v36
    v_mfma_f32_16x16x32_bf16 v[56:59], a[224:227], v[200:203], v[56:59]
    v_permlane32_swap_b32 v17, v38
    s_nop 1
    v_mfma_f32_16x16x32_bf16 v[56:59], a[228:231], v[216:219], v[56:59]
    v_max_f32 v22, v22, v14
    v_max_f32 v24, v24, v15
    v_mfma_f32_16x16x32_bf16 v[56:59], a[232:235], v[232:235], v[56:59]
    v_max_f32 v36, v36, v16
    v_max_f32 v38, v38, v17
    v_mfma_f32_16x16x32_bf16 v[56:59], a[236:239], v[248:251], v[56:59]
    v_mov_b32 v14, v22
    v_mov_b32 v15, v24
    v_mfma_f32_16x16x32_bf16 v[60:63], a[236:239], v[252:255], 0
    v_mov_b32 v16, v36
    v_mov_b32 v17, v38
    v_mfma_f32_16x16x32_bf16 v[60:63], a[232:235], v[236:239], v[60:63]
    s_nop 1
    v_permlane16_swap_b32 v14, v22
    v_mfma_f32_16x16x32_bf16 v[60:63], a[228:231], v[220:223], v[60:63]
    v_permlane16_swap_b32 v15, v24
    v_permlane16_swap_b32 v16, v36
    v_mfma_f32_16x16x32_bf16 v[60:63], a[224:227], v[204:207], v[60:63]
    v_permlane16_swap_b32 v17, v38
    s_nop 1
    v_mfma_f32_16x16x32_bf16 v[60:63], a[220:223], v[188:191], v[60:63]
    v_max_f32 v22, v22, v14
    v_max_f32 v24, v24, v15
    v_mfma_f32_16x16x32_bf16 v[60:63], a[216:219], v[172:175], v[60:63]
    v_max_f32 v36, v36, v16
    v_max_f32 v38, v38, v17
    ds_read_b128 a[216:219], v2 offset:12288
    ds_read_b128 a[220:223], v3 offset:12288
    ds_read_b128 a[224:227], v2 offset:12416
    ds_read_b128 a[228:231], v3 offset:12416
    ds_read_b128 a[232:235], v2 offset:12544
    ds_read_b128 a[236:239], v3 offset:12544
    v_sub_f32 v80, 0, v22
    v_sub_f32 v81, 0, v22
    v_sub_f32 v82, 0, v22
    v_sub_f32 v83, 0, v22
    v_sub_f32 v84, 0, v24
    v_sub_f32 v85, 0, v24
    v_sub_f32 v86, 0, v24
    v_sub_f32 v87, 0, v24
    v_sub_f32 v88, 0, v36
    v_sub_f32 v89, 0, v36
    v_sub_f32 v90, 0, v36
    v_sub_f32 v91, 0, v36
    v_sub_f32 v92, 0, v38
    v_sub_f32 v93, 0, v38
    v_sub_f32 v94, 0, v38
    v_sub_f32 v95, 0, v38
    v_sub_f32 v96, v96, v22
    v_sub_f32 v97, v97, v22
    v_sub_f32 v98, v98, v22
    v_sub_f32 v99, v99, v22
    v_sub_f32 v100, v100, v24
    v_sub_f32 v101, v101, v24
    v_sub_f32 v102, v102, v24
    v_sub_f32 v103, v103, v24
    v_sub_f32 v104, v104, v36
    v_sub_f32 v105, v105, v36
    v_sub_f32 v106, v106, v36
    v_sub_f32 v107, v107, v36
    v_sub_f32 v108, v108, v38
    v_sub_f32 v109, v109, v38
    v_sub_f32 v110, v110, v38
    v_sub_f32 v111, v111, v38
    v_sub_f32 v48, v48, v22
    v_sub_f32 v49, v49, v22
    v_sub_f32 v50, v50, v22
    v_sub_f32 v51, v51, v22
    v_sub_f32 v52, v52, v24
    v_sub_f32 v53, v53, v24
    v_sub_f32 v54, v54, v24
    v_sub_f32 v55, v55, v24
    v_sub_f32 v56, v56, v36
    v_sub_f32 v57, v57, v36
    v_sub_f32 v58, v58, v36
    v_sub_f32 v59, v59, v36
    v_sub_f32 v60, v60, v38
    v_sub_f32 v61, v61, v38
    v_sub_f32 v62, v62, v38
    v_sub_f32 v63, v63, v38
K1_SKIPMAX:
    v_exp_f32 v96, v96
    v_exp_f32 v97, v97
    v_exp_f32 v98, v98
    v_exp_f32 v99, v99
    v_exp_f32 v48, v48
    v_exp_f32 v49, v49
    v_exp_f32 v50, v50
    v_exp_f32 v51, v51
    s_nop 0
    v_add_f32 v40, v40, v96
    v_add_f32 v41, v41, v97
    v_cvt_pk_bf16_f32 v96, v96, v97
    v_add_f32 v40, v40, v98
    v_add_f32 v41, v41, v99
    v_cvt_pk_bf16_f32 v97, v98, v99
    v_add_f32 v40, v40, v48
    v_add_f32 v41, v41, v49
    v_cvt_pk_bf16_f32 v98, v48, v49
    v_add_f32 v40, v40, v50
    v_add_f32 v41, v41, v51
    v_cvt_pk_bf16_f32 v99, v50, v51
    s_waitcnt lgkmcnt(0)
    v_mfma_f32_16x16x32_bf16 v[112:115], a[216:219], v[160:163], v[80:83]
    v_exp_f32 v100, v100
    v_mfma_f32_16x16x32_bf16 v[112:115], a[220:223], v[176:179], v[112:115]
    v_add_f32 v42, v42, v100
    s_add_u32 m0, s29, 36864
    v_mfma_f32_16x16x32_bf16 v[112:115], a[224:227], v[192:195], v[112:115]
    v_exp_f32 v101, v101
    v_mfma_f32_16x16x32_bf16 v[112:115], a[228:231], v[208:211], v[112:115]
    buffer_load_dwordx4 v8, s[16:19], s30 offen offset:0 lds
    v_add_f32 v43, v43, v101
    v_mfma_f32_16x16x32_bf16 v[112:115], a[232:235], v[224:227], v[112:115]
    v_exp_f32 v102, v102
    v_mfma_f32_16x16x32_bf16 v[112:115], a[236:239], v[240:243], v[112:115]
    v_exp_f32 v103, v103
    v_mfma_f32_16x16x32_bf16 v[116:119], a[236:239], v[244:247], v[84:87]
    v_cvt_pk_bf16_f32 v100, v100, v101
    v_add_f32 v42, v42, v102
    v_mfma_f32_16x16x32_bf16 v[116:119], a[232:235], v[228:231], v[116:119]
    v_exp_f32 v52, v52
    v_mfma_f32_16x16x32_bf16 v[116:119], a[228:231], v[212:215], v[116:119]
    v_exp_f32 v53, v53
    v_mfma_f32_16x16x32_bf16 v[116:119], a[224:227], v[196:199], v[116:119]
    buffer_load_dwordx4 v9, s[16:19], s30 offen offset:1024 lds
    v_add_f32 v43, v43, v103
    v_mfma_f32_16x16x32_bf16 v[116:119], a[220:223], v[180:183], v[116:119]
    v_cvt_pk_bf16_f32 v101, v102, v103
    v_add_f32 v42, v42, v52
    v_mfma_f32_16x16x32_bf16 v[116:119], a[216:219], v[164:167], v[116:119]
    v_exp_f32 v54, v54
    v_mfma_f32_16x16x32_bf16 v[120:123], a[216:219], v[168:171], v[88:91]
    v_exp_f32 v55, v55
    v_mfma_f32_16x16x32_bf16 v[120:123], a[220:223], v[184:187], v[120:123]
    v_add_f32 v43, v43, v53
    v_cvt_pk_bf16_f32 v102, v52, v53
    v_mfma_f32_16x16x32_bf16 v[120:123], a[224:227], v[200:203], v[120:123]
    v_exp_f32 v104, v104
    v_mfma_f32_16x16x32_bf16 v[120:123], a[228:231], v[216:219], v[120:123]
    buffer_load_dwordx4 v10, s[16:19], s30 offen offset:2048 lds
    s_sub_u32 s30, s30, 12288
    v_mfma_f32_16x16x32_bf16 v[120:123], a[232:235], v[232:235], v[120:123]
    v_add_f32 v42, v42, v54
    v_add_f32 v43, v43, v55
    v_mfma_f32_16x16x32_bf16 v[120:123], a[236:239], v[248:251], v[120:123]
    v_exp_f32 v105, v105
    v_mfma_f32_16x16x32_bf16 v[124:127], a[236:239], v[252:255], v[92:95]
    v_cvt_pk_bf16_f32 v103, v54, v55
    v_add_f32 v44, v44, v104
    v_mfma_f32_16x16x32_bf16 v[124:127], a[232:235], v[236:239], v[124:127]
    v_exp_f32 v106, v106
    v_mfma_f32_16x16x32_bf16 v[124:127], a[228:231], v[220:223], v[124:127]
    v_add_f32 v45, v45, v105
    s_add_u32 m0, s29, 110592
    v_mfma_f32_16x16x32_bf16 v[124:127], a[224:227], v[204:207], v[124:127]
    buffer_load_dwordx4 v11, s[20:23], s30 offen offset:0 lds
    v_cvt_pk_bf16_f32 v104, v104, v105
    v_mfma_f32_16x16x32_bf16 v[124:127], a[220:223], v[188:191], v[124:127]
    v_exp_f32 v107, v107
    v_mfma_f32_16x16x32_bf16 v[124:127], a[216:219], v[172:175], v[124:127]
    v_exp_f32 v56, v56
    v_mfma_f32_16x16x32_bf16 v[64:67], a[192:195], v[160:163], v[80:83]
    v_add_f32 v44, v44, v106
    v_add_f32 v45, v45, v107
    v_mfma_f32_16x16x32_bf16 v[64:67], a[196:199], v[176:179], v[64:67]
    v_exp_f32 v57, v57
    v_mfma_f32_16x16x32_bf16 v[64:67], a[200:203], v[192:195], v[64:67]
    v_cvt_pk_bf16_f32 v105, v106, v107
    v_add_f32 v44, v44, v56
    v_mfma_f32_16x16x32_bf16 v[64:67], a[204:207], v[208:211], v[64:67]
    buffer_load_dwordx4 v12, s[20:23], s30 offen offset:1024 lds
    v_add_f32 v45, v45, v57
    v_mfma_f32_16x16x32_bf16 v[64:67], a[208:211], v[224:227], v[64:67]
    v_exp_f32 v58, v58
    v_mfma_f32_16x16x32_bf16 v[64:67], a[212:215], v[240:243], v[64:67]
    v_exp_f32 v59, v59
    v_mfma_f32_16x16x32_bf16 v[68:71], a[212:215], v[244:247], v[84:87]
    v_cvt_pk_bf16_f32 v106, v56, v57
    v_add_f32 v44, v44, v58
    v_mfma_f32_16x16x32_bf16 v[68:71], a[208:211], v[228:231], v[68:71]
    v_exp_f32 v108, v108
    v_mfma_f32_16x16x32_bf16 v[68:71], a[204:207], v[212:215], v[68:71]
    v_exp_f32 v109, v109
    v_mfma_f32_16x16x32_bf16 v[68:71], a[200:203], v[196:199], v[68:71]
    buffer_load_dwordx4 v13, s[20:23], s30 offen offset:2048 lds
    s_add_u32 s30, s30, 12288
    v_mfma_f32_16x16x32_bf16 v[68:71], a[196:199], v[180:183], v[68:71]
    v_add_f32 v45, v45, v59
    v_cvt_pk_bf16_f32 v107, v58, v59
    v_mfma_f32_16x16x32_bf16 v[68:71], a[192:195], v[164:167], v[68:71]
    v_exp_f32 v110, v110
    v_mfma_f32_16x16x32_bf16 v[72:75], a[192:195], v[168:171], v[88:91]
    v_add_f32 v46, v46, v108
    v_add_f32 v47, v47, v109
    v_mfma_f32_16x16x32_bf16 v[72:75], a[196:199], v[184:187], v[72:75]
    v_exp_f32 v111, v111
    v_mfma_f32_16x16x32_bf16 v[72:75], a[200:203], v[200:203], v[72:75]
    v_cvt_pk_bf16_f32 v108, v108, v109
    v_add_f32 v46, v46, v110
    v_mfma_f32_16x16x32_bf16 v[72:75], a[204:207], v[216:219], v[72:75]
    v_exp_f32 v60, v60
    v_mfma_f32_16x16x32_bf16 v[72:75], a[208:211], v[232:235], v[72:75]
    v_exp_f32 v61, v61
    v_mfma_f32_16x16x32_bf16 v[72:75], a[212:215], v[248:251], v[72:75]
    v_add_f32 v47, v47, v111
    v_cvt_pk_bf16_f32 v109, v110, v111
    v_mfma_f32_16x16x32_bf16 v[76:79], a[212:215], v[252:255], v[92:95]
    v_exp_f32 v62, v62
    v_mfma_f32_16x16x32_bf16 v[76:79], a[208:211], v[236:239], v[76:79]
    v_add_f32 v46, v46, v60
    v_add_f32 v47, v47, v61
    v_mfma_f32_16x16x32_bf16 v[76:79], a[204:207], v[220:223], v[76:79]
    v_exp_f32 v63, v63
    v_mfma_f32_16x16x32_bf16 v[76:79], a[200:203], v[204:207], v[76:79]
    v_cvt_pk_bf16_f32 v110, v60, v61
    v_add_f32 v46, v46, v62
    v_mfma_f32_16x16x32_bf16 v[76:79], a[196:199], v[188:191], v[76:79]
    v_add_f32 v47, v47, v63
    v_cvt_pk_bf16_f32 v111, v62, v63
    v_mfma_f32_16x16x32_bf16 v[76:79], a[192:195], v[172:175], v[76:79]
    ds_read_b128 a[192:195], v2 offset:24576
    ds_read_b128 a[196:199], v3 offset:24576
    ds_read_b128 a[200:203], v2 offset:24704
    ds_read_b128 a[204:207], v3 offset:24704
    ds_read_b128 a[208:211], v2 offset:24832
    ds_read_b128 a[212:215], v3 offset:24832
    v_exp_f32 v112, v112
    v_exp_f32 v113, v113
    v_exp_f32 v114, v114
    v_exp_f32 v115, v115
    v_exp_f32 v64, v64
    v_exp_f32 v65, v65
    v_exp_f32 v66, v66
    v_exp_f32 v67, v67
    v_exp_f32 v116, v116
    v_exp_f32 v117, v117
    v_exp_f32 v118, v118
    v_exp_f32 v119, v119
    v_exp_f32 v68, v68
    v_exp_f32 v69, v69
    v_exp_f32 v70, v70
    v_exp_f32 v71, v71
    s_nop 0
    v_add_f32 v40, v40, v112
    v_add_f32 v41, v41, v113
    v_cvt_pk_bf16_f32 v112, v112, v113
    v_add_f32 v40, v40, v114
    v_add_f32 v41, v41, v115
    v_cvt_pk_bf16_f32 v113, v114, v115
    v_add_f32 v40, v40, v64
    v_add_f32 v41, v41, v65
    v_cvt_pk_bf16_f32 v114, v64, v65
    v_add_f32 v40, v40, v66
    v_add_f32 v41, v41, v67
    v_cvt_pk_bf16_f32 v115, v66, v67
    v_add_f32 v42, v42, v116
    v_add_f32 v43, v43, v117
    v_cvt_pk_bf16_f32 v116, v116, v117
    v_add_f32 v42, v42, v118
    v_add_f32 v43, v43, v119
    v_cvt_pk_bf16_f32 v117, v118, v119
    v_add_f32 v42, v42, v68
    v_add_f32 v43, v43, v69
    v_cvt_pk_bf16_f32 v118, v68, v69
    v_add_f32 v42, v42, v70
    v_add_f32 v43, v43, v71
    v_cvt_pk_bf16_f32 v119, v70, v71
    s_mov_b32 s54, 15
    s_waitcnt lgkmcnt(0)
    v_mfma_f32_16x16x32_bf16 v[128:131], a[192:195], v[160:163], v[80:83]
    v_exp_f32 v120, v120
    v_mfma_f32_16x16x32_bf16 v[128:131], a[196:199], v[176:179], v[128:131]
    ds_read_b128 a[216:219], v2 offset:30720
    s_add_u32 m0, s29, 122880
    v_mfma_f32_16x16x32_bf16 v[128:131], a[200:203], v[192:195], v[128:131]
    v_exp_f32 v121, v121
    v_mfma_f32_16x16x32_bf16 v[128:131], a[204:207], v[208:211], v[128:131]
    buffer_load_dwordx4 v11, s[20:23], s30 offen offset:0 lds
    v_add_f32 v44, v44, v120
    v_mfma_f32_16x16x32_bf16 v[128:131], a[208:211], v[224:227], v[128:131]
    ds_read_b128 a[220:223], v3 offset:30720
    v_add_f32 v45, v45, v121
    v_mfma_f32_16x16x32_bf16 v[128:131], a[212:215], v[240:243], v[128:131]
    v_exp_f32 v122, v122
    v_mfma_f32_16x16x32_bf16 v[132:135], a[212:215], v[244:247], v[84:87]
    v_exp_f32 v123, v123
    v_mfma_f32_16x16x32_bf16 v[132:135], a[208:211], v[228:231], v[132:135]
    ds_read_b128 a[224:227], v2 offset:30848
    v_cvt_pk_bf16_f32 v120, v120, v121
    v_mfma_f32_16x16x32_bf16 v[132:135], a[204:207], v[212:215], v[132:135]
    buffer_load_dwordx4 v12, s[20:23], s30 offen offset:1024 lds
    v_add_f32 v44, v44, v122
    v_mfma_f32_16x16x32_bf16 v[132:135], a[200:203], v[196:199], v[132:135]
    v_exp_f32 v72, v72
    v_mfma_f32_16x16x32_bf16 v[132:135], a[196:199], v[180:183], v[132:135]
    ds_read_b128 a[228:231], v3 offset:30848
    v_add_f32 v45, v45, v123
    v_mfma_f32_16x16x32_bf16 v[132:135], a[192:195], v[164:167], v[132:135]
    v_exp_f32 v73, v73
    v_mfma_f32_16x16x32_bf16 v[136:139], a[192:195], v[168:171], v[88:91]
    buffer_load_dwordx4 v13, s[20:23], s30 offen offset:2048 lds
    v_cvt_pk_bf16_f32 v121, v122, v123
    v_mfma_f32_16x16x32_bf16 v[136:139], a[196:199], v[184:187], v[136:139]
    ds_read_b128 a[232:235], v2 offset:30976
    s_add_u32 s30, s30, 12288
    v_mfma_f32_16x16x32_bf16 v[136:139], a[200:203], v[200:203], v[136:139]
    v_exp_f32 v74, v74
    v_mfma_f32_16x16x32_bf16 v[136:139], a[204:207], v[216:219], v[136:139]
    v_add_f32 v44, v44, v72
    v_add_f32 v45, v45, v73
    v_mfma_f32_16x16x32_bf16 v[136:139], a[208:211], v[232:235], v[136:139]
    ds_read_b128 a[236:239], v3 offset:30976
    v_cvt_pk_bf16_f32 v122, v72, v73
    v_mfma_f32_16x16x32_bf16 v[136:139], a[212:215], v[248:251], v[136:139]
    v_exp_f32 v75, v75
    v_mfma_f32_16x16x32_bf16 v[140:143], a[212:215], v[252:255], v[92:95]
    v_exp_f32 v124, v124
    v_mfma_f32_16x16x32_bf16 v[140:143], a[208:211], v[236:239], v[140:143]
    v_add_f32 v44, v44, v74
    v_add_f32 v45, v45, v75
    v_mfma_f32_16x16x32_bf16 v[140:143], a[204:207], v[220:223], v[140:143]
    v_cvt_pk_bf16_f32 v123, v74, v75
    s_add_u32 m0, s58, 0
    v_mfma_f32_16x16x32_bf16 v[140:143], a[200:203], v[204:207], v[140:143]
    buffer_load_dwordx4 v30, s[40:43], 0 offen nt lds
    v_add_f32 v46, v46, v124
    v_mfma_f32_16x16x32_bf16 v[140:143], a[196:199], v[188:191], v[140:143]
    v_exp_f32 v125, v125
    v_mfma_f32_16x16x32_bf16 v[140:143], a[192:195], v[172:175], v[140:143]
    v_add_f32 v47, v47, v125
    s_waitcnt lgkmcnt(0)
    v_mfma_f32_16x16x32_bf16 v[48:51], a[216:219], v[160:163], v[80:83]
    v_exp_f32 v126, v126
    v_mfma_f32_16x16x32_bf16 v[48:51], a[220:223], v[176:179], v[48:51]
    v_exp_f32 v127, v127
    v_mfma_f32_16x16x32_bf16 v[48:51], a[224:227], v[192:195], v[48:51]
    ds_read_b64_tr_b16 a[240:241], v4 offset:0
    v_cvt_pk_bf16_f32 v124, v124, v125
    v_mfma_f32_16x16x32_bf16 v[48:51], a[228:231], v[208:211], v[48:51]
    v_exp_f32 v76, v76
    v_mfma_f32_16x16x32_bf16 v[48:51], a[232:235], v[224:227], v[48:51]
    ds_read_b64_tr_b16 a[242:243], v4 offset:6144
    v_add_f32 v46, v46, v126
    v_mfma_f32_16x16x32_bf16 v[48:51], a[236:239], v[240:243], v[48:51]
    v_exp_f32 v77, v77
    v_mfma_f32_16x16x32_bf16 v[52:55], a[236:239], v[244:247], v[84:87]
    ds_read_b64_tr_b16 a[244:245], v4 offset:12288
    v_add_f32 v47, v47, v127
    v_mfma_f32_16x16x32_bf16 v[52:55], a[232:235], v[228:231], v[52:55]
    v_cvt_pk_bf16_f32 v125, v126, v127
    v_add_f32 v46, v46, v76
    v_mfma_f32_16x16x32_bf16 v[52:55], a[228:231], v[212:215], v[52:55]
    ds_read_b64_tr_b16 a[246:247], v4 offset:18432
    s_add_u32 m0, s58, 1024
    v_mfma_f32_16x16x32_bf16 v[52:55], a[224:227], v[196:199], v[52:55]
    buffer_load_dwordx4 v31, s[40:43], 0 offen nt lds
    v_add_f32 v47, v47, v77
    v_mfma_f32_16x16x32_bf16 v[52:55], a[220:223], v[180:183], v[52:55]
    ds_read_b64_tr_b16 a[248:249], v5 offset:0
    v_cvt_pk_bf16_f32 v126, v76, v77
    v_mfma_f32_16x16x32_bf16 v[52:55], a[216:219], v[164:167], v[52:55]
    v_exp_f32 v78, v78
    v_mfma_f32_16x16x32_bf16 v[56:59], a[216:219], v[168:171], v[88:91]
    ds_read_b64_tr_b16 a[250:251], v5 offset:6144
    v_add_f32 v46, v46, v78
    v_mfma_f32_16x16x32_bf16 v[56:59], a[220:223], v[184:187], v[56:59]
    v_exp_f32 v79, v79
    v_mfma_f32_16x16x32_bf16 v[56:59], a[224:227], v[200:203], v[56:59]
    ds_read_b64_tr_b16 a[252:253], v5 offset:12288
    v_add_f32 v47, v47, v79
    v_mfma_f32_16x16x32_bf16 v[56:59], a[228:231], v[216:219], v[56:59]
    v_cvt_pk_bf16_f32 v127, v78, v79
    v_mfma_f32_16x16x32_bf16 v[56:59], a[232:235], v[232:235], v[56:59]
    ds_read_b64_tr_b16 a[254:255], v5 offset:18432
    v_mfma_f32_16x16x32_bf16 v[56:59], a[236:239], v[248:251], v[56:59]
    v_mfma_f32_16x16x32_bf16 v[60:63], a[236:239], v[252:255], v[92:95]
    ds_read_b64_tr_b16 a[192:193], v6 offset:0
    v_mfma_f32_16x16x32_bf16 v[60:63], a[232:235], v[236:239], v[60:63]
    v_mfma_f32_16x16x32_bf16 v[60:63], a[228:231], v[220:223], v[60:63]
    ds_read_b64_tr_b16 a[194:195], v6 offset:6144
    s_add_u32 m0, s58, 2048
    v_mfma_f32_16x16x32_bf16 v[60:63], a[224:227], v[204:207], v[60:63]
    buffer_load_dwordx4 v32, s[40:43], 0 offen nt lds
    v_mfma_f32_16x16x32_bf16 v[60:63], a[220:223], v[188:191], v[60:63]
    ds_read_b64_tr_b16 a[196:197], v6 offset:12288
    v_mfma_f32_16x16x32_bf16 v[60:63], a[216:219], v[172:175], v[60:63]
    s_waitcnt lgkmcnt(3)
    v_mfma_f32_16x16x32_bf16 a[0:3], v[96:99], a[240:243], 0
    ds_read_b64_tr_b16 a[198:199], v6 offset:18432
    v_mfma_f32_16x16x32_bf16 a[0:3], v[112:115], a[244:247], a[0:3]
    v_exp_f32 v128, v128
    v_mfma_f32_16x16x32_bf16 a[4:7], v[116:119], a[244:247], 0
    ds_read_b64_tr_b16 a[200:201], v7 offset:0
    v_add_f32 v40, v40, v128
    v_mfma_f32_16x16x32_bf16 a[4:7], v[100:103], a[240:243], a[4:7]
    v_exp_f32 v129, v129
    v_mfma_f32_16x16x32_bf16 a[8:11], v[104:107], a[240:243], 0
    ds_read_b64_tr_b16 a[202:203], v7 offset:6144
    v_add_f32 v41, v41, v129
    v_mfma_f32_16x16x32_bf16 a[8:11], v[120:123], a[244:247], a[8:11]
    v_exp_f32 v130, v130
    v_mfma_f32_16x16x32_bf16 a[12:15], v[124:127], a[244:247], 0
    ds_read_b64_tr_b16 a[204:205], v7 offset:12288
    v_cvt_pk_bf16_f32 v128, v128, v129
    v_mfma_f32_16x16x32_bf16 a[12:15], v[108:111], a[240:243], a[12:15]
    v_exp_f32 v131, v131
    v_mfma_f32_16x16x32_bf16 a[28:31], v[108:111], a[248:251], 0
    ds_read_b64_tr_b16 a[206:207], v7 offset:18432
    s_add_u32 m0, s58, 3072
    v_mfma_f32_16x16x32_bf16 a[28:31], v[124:127], a[252:255], a[28:31]
    buffer_load_dwordx4 v33, s[40:43], 0 offen nt lds
    v_add_f32 v40, v40, v130
    v_mfma_f32_16x16x32_bf16 a[24:27], v[120:123], a[252:255], 0
    ds_read_b64_tr_b16 a[208:209], v4 offset:128
    v_add_f32 v41, v41, v131
    v_mfma_f32_16x16x32_bf16 a[24:27], v[104:107], a[248:251], a[24:27]
    v_exp_f32 v48, v48
    v_mfma_f32_16x16x32_bf16 a[20:23], v[100:103], a[248:251], 0
    ds_read_b64_tr_b16 a[210:211], v4 offset:6272
    v_cvt_pk_bf16_f32 v129, v130, v131
    v_mfma_f32_16x16x32_bf16 a[20:23], v[116:119], a[252:255], a[20:23]
    v_exp_f32 v49, v49
    v_mfma_f32_16x16x32_bf16 a[16:19], v[112:115], a[252:255], 0
    ds_read_b64_tr_b16 a[212:213], v4 offset:12416
    v_add_f32 v40, v40, v48
    v_mfma_f32_16x16x32_bf16 a[16:19], v[96:99], a[248:251], a[16:19]
    v_add_f32 v41, v41, v49
    s_waitcnt lgkmcnt(3)
    v_mfma_f32_16x16x32_bf16 a[32:35], v[96:99], a[192:195], 0
    ds_read_b64_tr_b16 a[214:215], v4 offset:18560
    v_cvt_pk_bf16_f32 v130, v48, v49
    v_mfma_f32_16x16x32_bf16 a[32:35], v[112:115], a[196:199], a[32:35]
    v_exp_f32 v50, v50
    v_mfma_f32_16x16x32_bf16 a[36:39], v[116:119], a[196:199], 0
    ds_read_b64_tr_b16 a[240:241], v5 offset:128
    v_add_f32 v40, v40, v50
    v_mfma_f32_16x16x32_bf16 a[36:39], v[100:103], a[192:195], a[36:39]
    v_exp_f32 v51, v51
    v_mfma_f32_16x16x32_bf16 a[40:43], v[104:107], a[192:195], 0
    ds_read_b64_tr_b16 a[242:243], v5 offset:6272
    s_add_u32 m0, s58, 4096
    v_mfma_f32_16x16x32_bf16 a[40:43], v[120:123], a[196:199], a[40:43]
    buffer_load_dwordx4 v34, s[40:43], 0 offen nt lds
    v_add_f32 v41, v41, v51
    v_mfma_f32_16x16x32_bf16 a[44:47], v[124:127], a[196:199], 0
    ds_read_b64_tr_b16 a[244:245], v5 offset:12416
    v_cvt_pk_bf16_f32 v131, v50, v51
    v_mfma_f32_16x16x32_bf16 a[44:47], v[108:111], a[192:195], a[44:47]
    v_exp_f32 v132, v132
    v_mfma_f32_16x16x32_bf16 a[60:63], v[108:111], a[200:203], 0
    ds_read_b64_tr_b16 a[246:247], v5 offset:18560
    v_add_f32 v42, v42, v132
    v_mfma_f32_16x16x32_bf16 a[60:63], v[124:127], a[204:207], a[60:63]
    v_exp_f32 v133, v133
    v_mfma_f32_16x16x32_bf16 a[56:59], v[120:123], a[204:207], 0
    v_exp_f32 v134, v134
    v_mfma_f32_16x16x32_bf16 a[56:59], v[104:107], a[200:203], a[56:59]
    v_exp_f32 v135, v135
    v_mfma_f32_16x16x32_bf16 a[52:55], v[100:103], a[200:203], 0
    v_add_f32 v43, v43, v133
    v_cvt_pk_bf16_f32 v132, v132, v133
    v_mfma_f32_16x16x32_bf16 a[52:55], v[116:119], a[204:207], a[52:55]
    v_exp_f32 v52, v52
    v_mfma_f32_16x16x32_bf16 a[48:51], v[112:115], a[204:207], 0
    v_add_f32 v42, v42, v134
    s_add_u32 m0, s29, 49152
    v_mfma_f32_16x16x32_bf16 a[48:51], v[96:99], a[200:203], a[48:51]
    s_waitcnt lgkmcnt(0)
    s_barrier
    v_mfma_f32_16x16x32_bf16 a[64:67], v[96:99], a[208:211], 0
    buffer_load_dwordx4 v8, s[16:19], s30 offen offset:0 lds
    v_add_f32 v43, v43, v135
    v_mfma_f32_16x16x32_bf16 a[64:67], v[112:115], a[212:215], a[64:67]
    ds_read_b128 a[216:219], v2 offset:36864
    v_cvt_pk_bf16_f32 v133, v134, v135
    v_mfma_f32_16x16x32_bf16 a[68:71], v[116:119], a[212:215], 0
    ds_read_b128 a[220:223], v3 offset:36864
    v_add_f32 v42, v42, v52
    v_mfma_f32_16x16x32_bf16 a[68:71], v[100:103], a[208:211], a[68:71]
    ds_read_b128 a[224:227], v2 offset:36992
    v_mfma_f32_16x16x32_bf16 a[72:75], v[104:107], a[208:211], 0
    ds_read_b128 a[228:231], v3 offset:36992
    v_mfma_f32_16x16x32_bf16 a[72:75], v[120:123], a[212:215], a[72:75]
    ds_read_b128 a[232:235], v2 offset:37120
    v_mfma_f32_16x16x32_bf16 a[76:79], v[124:127], a[212:215], 0
    ds_read_b128 a[236:239], v3 offset:37120
    v_mfma_f32_16x16x32_bf16 a[76:79], v[108:111], a[208:211], a[76:79]
    v_exp_f32 v53, v53
    v_mfma_f32_16x16x32_bf16 a[92:95], v[108:111], a[240:243], 0
    buffer_load_dwordx4 v9, s[16:19], s30 offen offset:1024 lds
    v_add_f32 v43, v43, v53
    v_mfma_f32_16x16x32_bf16 a[92:95], v[124:127], a[244:247], a[92:95]
    v_exp_f32 v54, v54
    v_mfma_f32_16x16x32_bf16 a[88:91], v[120:123], a[244:247], 0
    v_exp_f32 v55, v55
    v_mfma_f32_16x16x32_bf16 a[88:91], v[104:107], a[240:243], a[88:91]
    v_cvt_pk_bf16_f32 v134, v52, v53
    v_add_f32 v42, v42, v54
    v_mfma_f32_16x16x32_bf16 a[84:87], v[100:103], a[240:243], 0
    v_add_f32 v43, v43, v55
    v_cvt_pk_bf16_f32 v135, v54, v55
    v_mfma_f32_16x16x32_bf16 a[84:87], v[116:119], a[244:247], a[84:87]
    buffer_load_dwordx4 v10, s[16:19], s30 offen offset:2048 lds
    s_add_u32 s30, s30, 12288
    v_mfma_f32_16x16x32_bf16 a[80:83], v[112:115], a[244:247], 0
    v_mfma_f32_16x16x32_bf16 a[80:83], v[96:99], a[240:243], a[80:83]
    s_waitcnt lgkmcnt(0)
    v_mfma_f32_16x16x32_bf16 v[144:147], a[216:219], v[160:163], v[80:83]
    v_exp_f32 v136, v136
    v_mfma_f32_16x16x32_bf16 v[144:147], a[220:223], v[176:179], v[144:147]
    ds_read_b128 a[192:195], v2 offset:43008
    s_add_u32 m0, s29, 61440
    v_mfma_f32_16x16x32_bf16 v[144:147], a[224:227], v[192:195], v[144:147]
    v_exp_f32 v137, v137
    v_mfma_f32_16x16x32_bf16 v[144:147], a[228:231], v[208:211], v[144:147]
    buffer_load_dwordx4 v8, s[16:19], s30 offen offset:0 lds
    v_add_f32 v44, v44, v136
    v_mfma_f32_16x16x32_bf16 v[144:147], a[232:235], v[224:227], v[144:147]
    ds_read_b128 a[196:199], v3 offset:43008
    v_add_f32 v45, v45, v137
    v_mfma_f32_16x16x32_bf16 v[144:147], a[236:239], v[240:243], v[144:147]
    v_exp_f32 v138, v138
    v_mfma_f32_16x16x32_bf16 v[148:151], a[236:239], v[244:247], v[84:87]
    v_exp_f32 v139, v139
    v_mfma_f32_16x16x32_bf16 v[148:151], a[232:235], v[228:231], v[148:151]
    ds_read_b128 a[200:203], v2 offset:43136
    v_cvt_pk_bf16_f32 v136, v136, v137
    v_mfma_f32_16x16x32_bf16 v[148:151], a[228:231], v[212:215], v[148:151]
    buffer_load_dwordx4 v9, s[16:19], s30 offen offset:1024 lds
    v_add_f32 v44, v44, v138
    v_mfma_f32_16x16x32_bf16 v[148:151], a[224:227], v[196:199], v[148:151]
    v_exp_f32 v56, v56
    v_mfma_f32_16x16x32_bf16 v[148:151], a[220:223], v[180:183], v[148:151]
    ds_read_b128 a[204:207], v3 offset:43136
    v_add_f32 v45, v45, v139
    v_mfma_f32_16x16x32_bf16 v[148:151], a[216:219], v[164:167], v[148:151]
    v_exp_f32 v57, v57
    v_mfma_f32_16x16x32_bf16 v[152:155], a[216:219], v[168:171], v[88:91]
    buffer_load_dwordx4 v10, s[16:19], s30 offen offset:2048 lds
    v_cvt_pk_bf16_f32 v137, v138, v139
    v_mfma_f32_16x16x32_bf16 v[152:155], a[220:223], v[184:187], v[152:155]
    ds_read_b128 a[208:211], v2 offset:43264
    s_sub_u32 s30, s30, 12288
    v_mfma_f32_16x16x32_bf16 v[152:155], a[224:227], v[200:203], v[152:155]
    v_exp_f32 v58, v58
    v_mfma_f32_16x16x32_bf16 v[152:155], a[228:231], v[216:219], v[152:155]
    v_add_f32 v44, v44, v56
    v_add_f32 v45, v45, v57
    v_mfma_f32_16x16x32_bf16 v[152:155], a[232:235], v[232:235], v[152:155]
    ds_read_b128 a[212:215], v3 offset:43264
    v_cvt_pk_bf16_f32 v138, v56, v57
    v_mfma_f32_16x16x32_bf16 v[152:155], a[236:239], v[248:251], v[152:155]
    v_exp_f32 v59, v59
    v_mfma_f32_16x16x32_bf16 v[156:159], a[236:239], v[252:255], v[92:95]
    v_exp_f32 v140, v140
    v_mfma_f32_16x16x32_bf16 v[156:159], a[232:235], v[236:239], v[156:159]
    v_add_f32 v44, v44, v58
    v_add_f32 v45, v45, v59
    v_mfma_f32_16x16x32_bf16 v[156:159], a[228:231], v[220:223], v[156:159]
    v_cvt_pk_bf16_f32 v139, v58, v59
    s_add_u32 m0, s58, 5120
    v_mfma_f32_16x16x32_bf16 v[156:159], a[224:227], v[204:207], v[156:159]
    buffer_load_dwordx4 v30, s[40:43], s39 offen nt lds
    v_add_f32 v46, v46, v140
    v_mfma_f32_16x16x32_bf16 v[156:159], a[220:223], v[188:191], v[156:159]
    v_exp_f32 v141, v141
    v_mfma_f32_16x16x32_bf16 v[156:159], a[216:219], v[172:175], v[156:159]
    v_add_f32 v47, v47, v141
    s_waitcnt lgkmcnt(0)
    v_mfma_f32_16x16x32_bf16 v[64:67], a[192:195], v[160:163], v[80:83]
    v_exp_f32 v142, v142
    v_mfma_f32_16x16x32_bf16 v[64:67], a[196:199], v[176:179], v[64:67]
    v_exp_f32 v143, v143
    v_mfma_f32_16x16x32_bf16 v[64:67], a[200:203], v[192:195], v[64:67]
    ds_read_b64_tr_b16 a[240:241], v6 offset:128
    v_cvt_pk_bf16_f32 v140, v140, v141
    v_mfma_f32_16x16x32_bf16 v[64:67], a[204:207], v[208:211], v[64:67]
    v_exp_f32 v60, v60
    v_mfma_f32_16x16x32_bf16 v[64:67], a[208:211], v[224:227], v[64:67]
    ds_read_b64_tr_b16 a[242:243], v6 offset:6272
    v_add_f32 v46, v46, v142
    v_mfma_f32_16x16x32_bf16 v[64:67], a[212:215], v[240:243], v[64:67]
    v_exp_f32 v61, v61
    v_mfma_f32_16x16x32_bf16 v[68:71], a[212:215], v[244:247], v[84:87]
    ds_read_b64_tr_b16 a[244:245], v6 offset:12416
    v_add_f32 v47, v47, v143
    v_mfma_f32_16x16x32_bf16 v[68:71], a[208:211], v[228:231], v[68:71]
    v_cvt_pk_bf16_f32 v141, v142, v143
    v_add_f32 v46, v46, v60
    v_mfma_f32_16x16x32_bf16 v[68:71], a[204:207], v[212:215], v[68:71]
    ds_read_b64_tr_b16 a[246:247], v6 offset:18560
    s_add_u32 m0, s58, 6144
    v_mfma_f32_16x16x32_bf16 v[68:71], a[200:203], v[196:199], v[68:71]
    buffer_load_dwordx4 v31, s[40:43], s39 offen nt lds
    v_add_f32 v47, v47, v61
    v_mfma_f32_16x16x32_bf16 v[68:71], a[196:199], v[180:183], v[68:71]
    ds_read_b64_tr_b16 a[248:249], v7 offset:128
    v_cvt_pk_bf16_f32 v142, v60, v61
    v_mfma_f32_16x16x32_bf16 v[68:71], a[192:195], v[164:167], v[68:71]
    v_exp_f32 v62, v62
    v_mfma_f32_16x16x32_bf16 v[72:75], a[192:195], v[168:171], v[88:91]
    ds_read_b64_tr_b16 a[250:251], v7 offset:6272
    v_add_f32 v46, v46, v62
    v_mfma_f32_16x16x32_bf16 v[72:75], a[196:199], v[184:187], v[72:75]
    v_exp_f32 v63, v63
    v_mfma_f32_16x16x32_bf16 v[72:75], a[200:203], v[200:203], v[72:75]
    ds_read_b64_tr_b16 a[252:253], v7 offset:12416
    v_add_f32 v47, v47, v63
    v_mfma_f32_16x16x32_bf16 v[72:75], a[204:207], v[216:219], v[72:75]
    v_cvt_pk_bf16_f32 v143, v62, v63
    v_mfma_f32_16x16x32_bf16 v[72:75], a[208:211], v[232:235], v[72:75]
    ds_read_b64_tr_b16 a[254:255], v7 offset:18560
    v_mfma_f32_16x16x32_bf16 v[72:75], a[212:215], v[248:251], v[72:75]
    v_mfma_f32_16x16x32_bf16 v[76:79], a[212:215], v[252:255], v[92:95]
    ds_read_b64_tr_b16 a[216:217], v4 offset:256
    v_mfma_f32_16x16x32_bf16 v[76:79], a[208:211], v[236:239], v[76:79]
    v_mfma_f32_16x16x32_bf16 v[76:79], a[204:207], v[220:223], v[76:79]
    ds_read_b64_tr_b16 a[218:219], v4 offset:6400
    s_add_u32 m0, s58, 7168
    v_mfma_f32_16x16x32_bf16 v[76:79], a[200:203], v[204:207], v[76:79]
    buffer_load_dwordx4 v32, s[40:43], s39 offen nt lds
    v_mfma_f32_16x16x32_bf16 v[76:79], a[196:199], v[188:191], v[76:79]
    ds_read_b64_tr_b16 a[220:221], v4 offset:12544
    v_mfma_f32_16x16x32_bf16 v[76:79], a[192:195], v[172:175], v[76:79]
    s_waitcnt lgkmcnt(3)
    v_mfma_f32_16x16x32_bf16 a[96:99], v[96:99], a[240:243], 0
    ds_read_b64_tr_b16 a[222:223], v4 offset:18688
    v_mfma_f32_16x16x32_bf16 a[96:99], v[112:115], a[244:247], a[96:99]
    v_exp_f32 v144, v144
    v_mfma_f32_16x16x32_bf16 a[100:103], v[116:119], a[244:247], 0
    ds_read_b64_tr_b16 a[224:225], v5 offset:256
    v_add_f32 v40, v40, v144
    v_mfma_f32_16x16x32_bf16 a[100:103], v[100:103], a[240:243], a[100:103]
    v_exp_f32 v145, v145
    v_mfma_f32_16x16x32_bf16 a[104:107], v[104:107], a[240:243], 0
    ds_read_b64_tr_b16 a[226:227], v5 offset:6400
    v_add_f32 v41, v41, v145
    v_mfma_f32_16x16x32_bf16 a[104:107], v[120:123], a[244:247], a[104:107]
    v_exp_f32 v146, v146
    v_mfma_f32_16x16x32_bf16 a[108:111], v[124:127], a[244:247], 0
    ds_read_b64_tr_b16 a[228:229], v5 offset:12544
    v_cvt_pk_bf16_f32 v144, v144, v145
    v_mfma_f32_16x16x32_bf16 a[108:111], v[108:111], a[240:243], a[108:111]
    v_exp_f32 v147, v147
    v_mfma_f32_16x16x32_bf16 a[124:127], v[108:111], a[248:251], 0
    ds_read_b64_tr_b16 a[230:231], v5 offset:18688
    s_add_u32 m0, s58, 8192
    v_mfma_f32_16x16x32_bf16 a[124:127], v[124:127], a[252:255], a[124:127]
    buffer_load_dwordx4 v33, s[40:43], s39 offen nt lds
    v_add_f32 v40, v40, v146
    v_mfma_f32_16x16x32_bf16 a[120:123], v[120:123], a[252:255], 0
    ds_read_b64_tr_b16 a[232:233], v6 offset:256
    v_add_f32 v41, v41, v147
    v_mfma_f32_16x16x32_bf16 a[120:123], v[104:107], a[248:251], a[120:123]
    v_exp_f32 v64, v64
    v_mfma_f32_16x16x32_bf16 a[116:119], v[100:103], a[248:251], 0
    ds_read_b64_tr_b16 a[234:235], v6 offset:6400
    v_cvt_pk_bf16_f32 v145, v146, v147
    v_mfma_f32_16x16x32_bf16 a[116:119], v[116:119], a[252:255], a[116:119]
    v_exp_f32 v65, v65
    v_mfma_f32_16x16x32_bf16 a[112:115], v[112:115], a[252:255], 0
    ds_read_b64_tr_b16 a[236:237], v6 offset:12544
    v_add_f32 v40, v40, v64
    v_mfma_f32_16x16x32_bf16 a[112:115], v[96:99], a[248:251], a[112:115]
    v_add_f32 v41, v41, v65
    s_waitcnt lgkmcnt(3)
    v_mfma_f32_16x16x32_bf16 a[128:131], v[96:99], a[216:219], 0
    ds_read_b64_tr_b16 a[238:239], v6 offset:18688
    v_cvt_pk_bf16_f32 v146, v64, v65
    v_mfma_f32_16x16x32_bf16 a[128:131], v[112:115], a[220:223], a[128:131]
    v_exp_f32 v66, v66
    v_mfma_f32_16x16x32_bf16 a[132:135], v[116:119], a[220:223], 0
    ds_read_b64_tr_b16 a[240:241], v7 offset:256
    v_add_f32 v40, v40, v66
    v_mfma_f32_16x16x32_bf16 a[132:135], v[100:103], a[216:219], a[132:135]
    v_exp_f32 v67, v67
    v_mfma_f32_16x16x32_bf16 a[136:139], v[104:107], a[216:219], 0
    ds_read_b64_tr_b16 a[242:243], v7 offset:6400
    s_add_u32 m0, s58, 9216
    v_mfma_f32_16x16x32_bf16 a[136:139], v[120:123], a[220:223], a[136:139]
    buffer_load_dwordx4 v34, s[40:43], s39 offen nt lds
    v_add_f32 v41, v41, v67
    v_mfma_f32_16x16x32_bf16 a[140:143], v[124:127], a[220:223], 0
    ds_read_b64_tr_b16 a[244:245], v7 offset:12544
    v_cvt_pk_bf16_f32 v147, v66, v67
    v_mfma_f32_16x16x32_bf16 a[140:143], v[108:111], a[216:219], a[140:143]
    v_exp_f32 v148, v148
    v_mfma_f32_16x16x32_bf16 a[156:159], v[108:111], a[224:227], 0
    ds_read_b64_tr_b16 a[246:247], v7 offset:18688
    v_add_f32 v42, v42, v148
    v_mfma_f32_16x16x32_bf16 a[156:159], v[124:127], a[228:231], a[156:159]
    v_exp_f32 v149, v149
    v_mfma_f32_16x16x32_bf16 a[152:155], v[120:123], a[228:231], 0
    v_exp_f32 v150, v150
    v_mfma_f32_16x16x32_bf16 a[152:155], v[104:107], a[224:227], a[152:155]
    v_exp_f32 v151, v151
    v_mfma_f32_16x16x32_bf16 a[148:151], v[100:103], a[224:227], 0
    v_add_f32 v43, v43, v149
    v_cvt_pk_bf16_f32 v148, v148, v149
    v_mfma_f32_16x16x32_bf16 a[148:151], v[116:119], a[228:231], a[148:151]
    v_exp_f32 v68, v68
    v_mfma_f32_16x16x32_bf16 a[144:147], v[112:115], a[228:231], 0
    v_add_f32 v42, v42, v150
    s_add_u32 m0, s29, 86016
    v_mfma_f32_16x16x32_bf16 a[144:147], v[96:99], a[224:227], a[144:147]
    s_waitcnt vmcnt(16) lgkmcnt(0)
    s_barrier
    v_mfma_f32_16x16x32_bf16 a[160:163], v[96:99], a[232:235], 0
    buffer_load_dwordx4 v11, s[20:23], s30 offen offset:0 lds
    v_add_f32 v43, v43, v151
    v_mfma_f32_16x16x32_bf16 a[160:163], v[112:115], a[236:239], a[160:163]
    ds_read_b128 a[192:195], v2 offset:0
    v_cvt_pk_bf16_f32 v149, v150, v151
    v_mfma_f32_16x16x32_bf16 a[164:167], v[116:119], a[236:239], 0
    ds_read_b128 a[196:199], v3 offset:0
    v_add_f32 v42, v42, v68
    v_mfma_f32_16x16x32_bf16 a[164:167], v[100:103], a[232:235], a[164:167]
    ds_read_b128 a[200:203], v2 offset:128
    v_mfma_f32_16x16x32_bf16 a[168:171], v[104:107], a[232:235], 0
    ds_read_b128 a[204:207], v3 offset:128
    v_mfma_f32_16x16x32_bf16 a[168:171], v[120:123], a[236:239], a[168:171]
    ds_read_b128 a[208:211], v2 offset:256
    v_mfma_f32_16x16x32_bf16 a[172:175], v[124:127], a[236:239], 0
    ds_read_b128 a[212:215], v3 offset:256
    v_mfma_f32_16x16x32_bf16 a[172:175], v[108:111], a[232:235], a[172:175]
    v_exp_f32 v69, v69
    v_mfma_f32_16x16x32_bf16 a[188:191], v[108:111], a[240:243], 0
    buffer_load_dwordx4 v12, s[20:23], s30 offen offset:1024 lds
    v_add_f32 v43, v43, v69
    v_mfma_f32_16x16x32_bf16 a[188:191], v[124:127], a[244:247], a[188:191]
    v_exp_f32 v70, v70
    v_mfma_f32_16x16x32_bf16 a[184:187], v[120:123], a[244:247], 0
    v_exp_f32 v71, v71
    v_mfma_f32_16x16x32_bf16 a[184:187], v[104:107], a[240:243], a[184:187]
    v_cvt_pk_bf16_f32 v150, v68, v69
    v_add_f32 v42, v42, v70
    v_mfma_f32_16x16x32_bf16 a[180:183], v[100:103], a[240:243], 0
    v_add_f32 v43, v43, v71
    v_cvt_pk_bf16_f32 v151, v70, v71
    v_mfma_f32_16x16x32_bf16 a[180:183], v[116:119], a[244:247], a[180:183]
    buffer_load_dwordx4 v13, s[20:23], s30 offen offset:2048 lds
    s_add_u32 s30, s30, 12288
    v_mfma_f32_16x16x32_bf16 a[176:179], v[112:115], a[244:247], 0
    v_mfma_f32_16x16x32_bf16 a[176:179], v[96:99], a[240:243], a[176:179]
    s_waitcnt lgkmcnt(0)
    s_branch K1_LOOP2
.p2align 6
K1_LOOP:
    v_mfma_f32_16x16x32_bf16 v[128:131], a[192:195], v[160:163], v[80:83]
    v_exp_f32 v120, v120
    v_mfma_f32_16x16x32_bf16 v[128:131], a[196:199], v[176:179], v[128:131]
    ds_read_b128 a[216:219], v2 offset:30720
    s_add_u32 m0, s29, 122880
    v_mfma_f32_16x16x32_bf16 v[128:131], a[200:203], v[192:195], v[128:131]
    v_exp_f32 v121, v121
    v_mfma_f32_16x16x32_bf16 v[128:131], a[204:207], v[208:211], v[128:131]
    buffer_load_dwordx4 v11, s[20:23], s30 offen offset:0 lds
    v_add_f32 v44, v44, v120
    v_mfma_f32_16x16x32_bf16 v[128:131], a[208:211], v[224:227], v[128:131]
    ds_read_b128 a[220:223], v3 offset:30720
    v_add_f32 v45, v45, v121
    v_mfma_f32_16x16x32_bf16 v[128:131], a[212:215], v[240:243], v[128:131]
    v_exp_f32 v122, v122
    v_mfma_f32_16x16x32_bf16 v[132:135], a[212:215], v[244:247], v[84:87]
    v_exp_f32 v123, v123
    v_mfma_f32_16x16x32_bf16 v[132:135], a[208:211], v[228:231], v[132:135]
    ds_read_b128 a[224:227], v2 offset:30848
    v_cvt_pk_bf16_f32 v120, v120, v121
    v_mfma_f32_16x16x32_bf16 v[132:135], a[204:207], v[212:215], v[132:135]
    buffer_load_dwordx4 v12, s[20:23], s30 offen offset:1024 lds
    v_add_f32 v44, v44, v122
    v_mfma_f32_16x16x32_bf16 v[132:135], a[200:203], v[196:199], v[132:135]
    v_exp_f32 v72, v72
    v_mfma_f32_16x16x32_bf16 v[132:135], a[196:199], v[180:183], v[132:135]
    ds_read_b128 a[228:231], v3 offset:30848
    v_add_f32 v45, v45, v123
    v_mfma_f32_16x16x32_bf16 v[132:135], a[192:195], v[164:167], v[132:135]
    v_exp_f32 v73, v73
    v_mfma_f32_16x16x32_bf16 v[136:139], a[192:195], v[168:171], v[88:91]
    buffer_load_dwordx4 v13, s[20:23], s30 offen offset:2048 lds
    v_cvt_pk_bf16_f32 v121, v122, v123
    v_mfma_f32_16x16x32_bf16 v[136:139], a[196:199], v[184:187], v[136:139]
    ds_read_b128 a[232:235], v2 offset:30976
    s_add_u32 s30, s30, 12288
    v_mfma_f32_16x16x32_bf16 v[136:139], a[200:203], v[200:203], v[136:139]
    v_exp_f32 v74, v74
    v_mfma_f32_16x16x32_bf16 v[136:139], a[204:207], v[216:219], v[136:139]
    v_add_f32 v44, v44, v72
    v_add_f32 v45, v45, v73
    v_mfma_f32_16x16x32_bf16 v[136:139], a[208:211], v[232:235], v[136:139]
    ds_read_b128 a[236:239], v3 offset:30976
    v_cvt_pk_bf16_f32 v122, v72, v73
    v_mfma_f32_16x16x32_bf16 v[136:139], a[212:215], v[248:251], v[136:139]
    v_exp_f32 v75, v75
    v_mfma_f32_16x16x32_bf16 v[140:143], a[212:215], v[252:255], v[92:95]
    v_exp_f32 v124, v124
    v_mfma_f32_16x16x32_bf16 v[140:143], a[208:211], v[236:239], v[140:143]
    v_add_f32 v44, v44, v74
    v_add_f32 v45, v45, v75
    v_mfma_f32_16x16x32_bf16 v[140:143], a[204:207], v[220:223], v[140:143]
    v_exp_f32 v125, v125
    v_mfma_f32_16x16x32_bf16 v[140:143], a[200:203], v[204:207], v[140:143]
    v_cvt_pk_bf16_f32 v123, v74, v75
    v_add_f32 v46, v46, v124
    v_mfma_f32_16x16x32_bf16 v[140:143], a[196:199], v[188:191], v[140:143]
    v_exp_f32 v126, v126
    v_mfma_f32_16x16x32_bf16 v[140:143], a[192:195], v[172:175], v[140:143]
    v_add_f32 v47, v47, v125
    s_waitcnt lgkmcnt(0)
    v_mfma_f32_16x16x32_bf16 v[48:51], a[216:219], v[160:163], v[80:83]
    v_exp_f32 v127, v127
    v_mfma_f32_16x16x32_bf16 v[48:51], a[220:223], v[176:179], v[48:51]
    v_cvt_pk_bf16_f32 v124, v124, v125
    v_add_f32 v46, v46, v126
    v_mfma_f32_16x16x32_bf16 v[48:51], a[224:227], v[192:195], v[48:51]
    ds_read_b64_tr_b16 a[240:241], v4 offset:0
    v_add_f32 v47, v47, v127
    v_mfma_f32_16x16x32_bf16 v[48:51], a[228:231], v[208:211], v[48:51]
    v_exp_f32 v76, v76
    v_mfma_f32_16x16x32_bf16 v[48:51], a[232:235], v[224:227], v[48:51]
    ds_read_b64_tr_b16 a[242:243], v4 offset:6144
    v_cvt_pk_bf16_f32 v125, v126, v127
    v_mfma_f32_16x16x32_bf16 v[48:51], a[236:239], v[240:243], v[48:51]
    v_exp_f32 v77, v77
    v_mfma_f32_16x16x32_bf16 v[52:55], a[236:239], v[244:247], v[84:87]
    ds_read_b64_tr_b16 a[244:245], v4 offset:12288
    v_add_f32 v46, v46, v76
    v_mfma_f32_16x16x32_bf16 v[52:55], a[232:235], v[228:231], v[52:55]
    v_exp_f32 v78, v78
    v_mfma_f32_16x16x32_bf16 v[52:55], a[228:231], v[212:215], v[52:55]
    ds_read_b64_tr_b16 a[246:247], v4 offset:18432
    v_add_f32 v47, v47, v77
    v_mfma_f32_16x16x32_bf16 v[52:55], a[224:227], v[196:199], v[52:55]
    v_exp_f32 v79, v79
    v_mfma_f32_16x16x32_bf16 v[52:55], a[220:223], v[180:183], v[52:55]
    ds_read_b64_tr_b16 a[248:249], v5 offset:0
    v_cvt_pk_bf16_f32 v126, v76, v77
    v_mfma_f32_16x16x32_bf16 v[52:55], a[216:219], v[164:167], v[52:55]
    v_add_f32 v46, v46, v78
    v_add_f32 v47, v47, v79
    v_mfma_f32_16x16x32_bf16 v[56:59], a[216:219], v[168:171], v[88:91]
    ds_read_b64_tr_b16 a[250:251], v5 offset:6144
    v_cvt_pk_bf16_f32 v127, v78, v79
    v_mfma_f32_16x16x32_bf16 v[56:59], a[220:223], v[184:187], v[56:59]
    v_mfma_f32_16x16x32_bf16 v[56:59], a[224:227], v[200:203], v[56:59]
    ds_read_b64_tr_b16 a[252:253], v5 offset:12288
    v_mfma_f32_16x16x32_bf16 v[56:59], a[228:231], v[216:219], v[56:59]
    v_mfma_f32_16x16x32_bf16 v[56:59], a[232:235], v[232:235], v[56:59]
    ds_read_b64_tr_b16 a[254:255], v5 offset:18432
    v_mfma_f32_16x16x32_bf16 v[56:59], a[236:239], v[248:251], v[56:59]
    v_mfma_f32_16x16x32_bf16 v[60:63], a[236:239], v[252:255], v[92:95]
    ds_read_b64_tr_b16 a[192:193], v6 offset:0
    v_mfma_f32_16x16x32_bf16 v[60:63], a[232:235], v[236:239], v[60:63]
    v_mfma_f32_16x16x32_bf16 v[60:63], a[228:231], v[220:223], v[60:63]
    ds_read_b64_tr_b16 a[194:195], v6 offset:6144
    v_mfma_f32_16x16x32_bf16 v[60:63], a[224:227], v[204:207], v[60:63]
    v_mfma_f32_16x16x32_bf16 v[60:63], a[220:223], v[188:191], v[60:63]
    ds_read_b64_tr_b16 a[196:197], v6 offset:12288
    v_mfma_f32_16x16x32_bf16 v[60:63], a[216:219], v[172:175], v[60:63]
    s_waitcnt lgkmcnt(3)
    v_mfma_f32_16x16x32_bf16 a[0:3], v[96:99], a[240:243], a[0:3]
    ds_read_b64_tr_b16 a[198:199], v6 offset:18432
    v_mfma_f32_16x16x32_bf16 a[0:3], v[112:115], a[244:247], a[0:3]
    v_exp_f32 v128, v128
    v_mfma_f32_16x16x32_bf16 a[4:7], v[116:119], a[244:247], a[4:7]
    ds_read_b64_tr_b16 a[200:201], v7 offset:0
    v_add_f32 v40, v40, v128
    v_mfma_f32_16x16x32_bf16 a[4:7], v[100:103], a[240:243], a[4:7]
    v_exp_f32 v129, v129
    v_mfma_f32_16x16x32_bf16 a[8:11], v[104:107], a[240:243], a[8:11]
    ds_read_b64_tr_b16 a[202:203], v7 offset:6144
    v_add_f32 v41, v41, v129
    v_mfma_f32_16x16x32_bf16 a[8:11], v[120:123], a[244:247], a[8:11]
    v_exp_f32 v130, v130
    v_mfma_f32_16x16x32_bf16 a[12:15], v[124:127], a[244:247], a[12:15]
    ds_read_b64_tr_b16 a[204:205], v7 offset:12288
    v_cvt_pk_bf16_f32 v128, v128, v129
    v_mfma_f32_16x16x32_bf16 a[12:15], v[108:111], a[240:243], a[12:15]
    v_exp_f32 v131, v131
    v_mfma_f32_16x16x32_bf16 a[28:31], v[108:111], a[248:251], a[28:31]
    ds_read_b64_tr_b16 a[206:207], v7 offset:18432
    v_add_f32 v40, v40, v130
    v_mfma_f32_16x16x32_bf16 a[28:31], v[124:127], a[252:255], a[28:31]
    v_exp_f32 v48, v48
    v_mfma_f32_16x16x32_bf16 a[24:27], v[120:123], a[252:255], a[24:27]
    ds_read_b64_tr_b16 a[208:209], v4 offset:128
    v_add_f32 v41, v41, v131
    v_mfma_f32_16x16x32_bf16 a[24:27], v[104:107], a[248:251], a[24:27]
    v_exp_f32 v49, v49
    v_mfma_f32_16x16x32_bf16 a[20:23], v[100:103], a[248:251], a[20:23]
    ds_read_b64_tr_b16 a[210:211], v4 offset:6272
    v_cvt_pk_bf16_f32 v129, v130, v131
    v_mfma_f32_16x16x32_bf16 a[20:23], v[116:119], a[252:255], a[20:23]
    v_exp_f32 v50, v50
    v_mfma_f32_16x16x32_bf16 a[16:19], v[112:115], a[252:255], a[16:19]
    ds_read_b64_tr_b16 a[212:213], v4 offset:12416
    v_add_f32 v40, v40, v48
    v_mfma_f32_16x16x32_bf16 a[16:19], v[96:99], a[248:251], a[16:19]
    v_add_f32 v41, v41, v49
    s_waitcnt lgkmcnt(3)
    v_mfma_f32_16x16x32_bf16 a[32:35], v[96:99], a[192:195], a[32:35]
    ds_read_b64_tr_b16 a[214:215], v4 offset:18560
    v_cvt_pk_bf16_f32 v130, v48, v49
    v_mfma_f32_16x16x32_bf16 a[32:35], v[112:115], a[196:199], a[32:35]
    v_exp_f32 v51, v51
    v_mfma_f32_16x16x32_bf16 a[36:39], v[116:119], a[196:199], a[36:39]
    ds_read_b64_tr_b16 a[240:241], v5 offset:128
    v_add_f32 v40, v40, v50
    v_mfma_f32_16x16x32_bf16 a[36:39], v[100:103], a[192:195], a[36:39]
    v_exp_f32 v132, v132
    v_mfma_f32_16x16x32_bf16 a[40:43], v[104:107], a[192:195], a[40:43]
    ds_read_b64_tr_b16 a[242:243], v5 offset:6272
    v_add_f32 v41, v41, v51
    v_mfma_f32_16x16x32_bf16 a[40:43], v[120:123], a[196:199], a[40:43]
    v_exp_f32 v133, v133
    v_mfma_f32_16x16x32_bf16 a[44:47], v[124:127], a[196:199], a[44:47]
    ds_read_b64_tr_b16 a[244:245], v5 offset:12416
    v_cvt_pk_bf16_f32 v131, v50, v51
    v_mfma_f32_16x16x32_bf16 a[44:47], v[108:111], a[192:195], a[44:47]
    v_exp_f32 v134, v134
    v_mfma_f32_16x16x32_bf16 a[60:63], v[108:111], a[200:203], a[60:63]
    ds_read_b64_tr_b16 a[246:247], v5 offset:18560
    v_add_f32 v42, v42, v132
    v_mfma_f32_16x16x32_bf16 a[60:63], v[124:127], a[204:207], a[60:63]
    v_exp_f32 v135, v135
    v_mfma_f32_16x16x32_bf16 a[56:59], v[120:123], a[204:207], a[56:59]
    v_add_f32 v43, v43, v133
    v_cvt_pk_bf16_f32 v132, v132, v133
    v_mfma_f32_16x16x32_bf16 a[56:59], v[104:107], a[200:203], a[56:59]
    v_exp_f32 v52, v52
    v_mfma_f32_16x16x32_bf16 a[52:55], v[100:103], a[200:203], a[52:55]
    v_add_f32 v42, v42, v134
    v_add_f32 v43, v43, v135
    v_mfma_f32_16x16x32_bf16 a[52:55], v[116:119], a[204:207], a[52:55]
    v_exp_f32 v53, v53
    v_mfma_f32_16x16x32_bf16 a[48:51], v[112:115], a[204:207], a[48:51]
    v_cvt_pk_bf16_f32 v133, v134, v135
    s_add_u32 m0, s29, 49152
    v_mfma_f32_16x16x32_bf16 a[48:51], v[96:99], a[200:203], a[48:51]
    s_waitcnt vmcnt(9) lgkmcnt(0)
    s_barrier
    v_mfma_f32_16x16x32_bf16 a[64:67], v[96:99], a[208:211], a[64:67]
    buffer_load_dwordx4 v8, s[16:19], s30 offen offset:0 lds
    v_add_f32 v42, v42, v52
    v_mfma_f32_16x16x32_bf16 a[64:67], v[112:115], a[212:215], a[64:67]
    ds_read_b128 a[216:219], v2 offset:36864
    v_add_f32 v43, v43, v53
    v_mfma_f32_16x16x32_bf16 a[68:71], v[116:119], a[212:215], a[68:71]
    ds_read_b128 a[220:223], v3 offset:36864
    v_cvt_pk_bf16_f32 v134, v52, v53
    v_mfma_f32_16x16x32_bf16 a[68:71], v[100:103], a[208:211], a[68:71]
    ds_read_b128 a[224:227], v2 offset:36992
    v_mfma_f32_16x16x32_bf16 a[72:75], v[104:107], a[208:211], a[72:75]
    ds_read_b128 a[228:231], v3 offset:36992
    v_mfma_f32_16x16x32_bf16 a[72:75], v[120:123], a[212:215], a[72:75]
    ds_read_b128 a[232:235], v2 offset:37120
    v_mfma_f32_16x16x32_bf16 a[76:79], v[124:127], a[212:215], a[76:79]
    ds_read_b128 a[236:239], v3 offset:37120
    v_mfma_f32_16x16x32_bf16 a[76:79], v[108:111], a[208:211], a[76:79]
    v_exp_f32 v54, v54
    v_mfma_f32_16x16x32_bf16 a[92:95], v[108:111], a[240:243], a[92:95]
    buffer_load_dwordx4 v9, s[16:19], s30 offen offset:1024 lds
    v_add_f32 v42, v42, v54
    v_mfma_f32_16x16x32_bf16 a[92:95], v[124:127], a[244:247], a[92:95]
    v_exp_f32 v55, v55
    v_mfma_f32_16x16x32_bf16 a[88:91], v[120:123], a[244:247], a[88:91]
    v_add_f32 v43, v43, v55
    s_sub_u32 s54, s54, 1
    v_mfma_f32_16x16x32_bf16 a[88:91], v[104:107], a[240:243], a[88:91]
    v_cvt_pk_bf16_f32 v135, v54, v55
    v_mfma_f32_16x16x32_bf16 a[84:87], v[100:103], a[240:243], a[84:87]
    v_mfma_f32_16x16x32_bf16 a[84:87], v[116:119], a[244:247], a[84:87]
    buffer_load_dwordx4 v10, s[16:19], s30 offen offset:2048 lds
    s_add_u32 s30, s30, 12288
    v_mfma_f32_16x16x32_bf16 a[80:83], v[112:115], a[244:247], a[80:83]
    v_mfma_f32_16x16x32_bf16 a[80:83], v[96:99], a[240:243], a[80:83]
    s_waitcnt lgkmcnt(0)
    v_mfma_f32_16x16x32_bf16 v[144:147], a[216:219], v[160:163], v[80:83]
    v_exp_f32 v136, v136
    v_mfma_f32_16x16x32_bf16 v[144:147], a[220:223], v[176:179], v[144:147]
    ds_read_b128 a[192:195], v2 offset:43008
    s_add_u32 m0, s29, 61440
    v_mfma_f32_16x16x32_bf16 v[144:147], a[224:227], v[192:195], v[144:147]
    v_exp_f32 v137, v137
    v_mfma_f32_16x16x32_bf16 v[144:147], a[228:231], v[208:211], v[144:147]
    buffer_load_dwordx4 v8, s[16:19], s30 offen offset:0 lds
    v_add_f32 v44, v44, v136
    v_mfma_f32_16x16x32_bf16 v[144:147], a[232:235], v[224:227], v[144:147]
    ds_read_b128 a[196:199], v3 offset:43008
    v_add_f32 v45, v45, v137
    v_mfma_f32_16x16x32_bf16 v[144:147], a[236:239], v[240:243], v[144:147]
    v_exp_f32 v138, v138
    v_mfma_f32_16x16x32_bf16 v[148:151], a[236:239], v[244:247], v[84:87]
    v_exp_f32 v139, v139
    v_mfma_f32_16x16x32_bf16 v[148:151], a[232:235], v[228:231], v[148:151]
    ds_read_b128 a[200:203], v2 offset:43136
    v_cvt_pk_bf16_f32 v136, v136, v137
    v_mfma_f32_16x16x32_bf16 v[148:151], a[228:231], v[212:215], v[148:151]
    buffer_load_dwordx4 v9, s[16:19], s30 offen offset:1024 lds
    v_add_f32 v44, v44, v138
    v_mfma_f32_16x16x32_bf16 v[148:151], a[224:227], v[196:199], v[148:151]
    v_exp_f32 v56, v56
    v_mfma_f32_16x16x32_bf16 v[148:151], a[220:223], v[180:183], v[148:151]
    ds_read_b128 a[204:207], v3 offset:43136
    v_add_f32 v45, v45, v139
    v_mfma_f32_16x16x32_bf16 v[148:151], a[216:219], v[164:167], v[148:151]
    v_exp_f32 v57, v57
    v_mfma_f32_16x16x32_bf16 v[152:155], a[216:219], v[168:171], v[88:91]
    buffer_load_dwordx4 v10, s[16:19], s30 offen offset:2048 lds
    v_cvt_pk_bf16_f32 v137, v138, v139
    v_mfma_f32_16x16x32_bf16 v[152:155], a[220:223], v[184:187], v[152:155]
    ds_read_b128 a[208:211], v2 offset:43264
    s_sub_u32 s30, s30, 12288
    v_mfma_f32_16x16x32_bf16 v[152:155], a[224:227], v[200:203], v[152:155]
    v_exp_f32 v58, v58
    v_mfma_f32_16x16x32_bf16 v[152:155], a[228:231], v[216:219], v[152:155]
    v_add_f32 v44, v44, v56
    v_add_f32 v45, v45, v57
    v_mfma_f32_16x16x32_bf16 v[152:155], a[232:235], v[232:235], v[152:155]
    ds_read_b128 a[212:215], v3 offset:43264
    v_cvt_pk_bf16_f32 v138, v56, v57
    v_mfma_f32_16x16x32_bf16 v[152:155], a[236:239], v[248:251], v[152:155]
    v_exp_f32 v59, v59
    v_mfma_f32_16x16x32_bf16 v[156:159], a[236:239], v[252:255], v[92:95]
    ds_read_b64_tr_b16 v[14:15], v35
    v_add_f32 v44, v44, v58
    v_mfma_f32_16x16x32_bf16 v[156:159], a[232:235], v[236:239], v[156:159]
    ds_read_b64_tr_b16 v[16:17], v35 offset:5120
    v_add_f32 v45, v45, v59
    v_mfma_f32_16x16x32_bf16 v[156:159], a[228:231], v[220:223], v[156:159]
    v_exp_f32 v140, v140
    v_mfma_f32_16x16x32_bf16 v[156:159], a[224:227], v[204:207], v[156:159]
    v_exp_f32 v141, v141
    v_mfma_f32_16x16x32_bf16 v[156:159], a[220:223], v[188:191], v[156:159]
    v_cvt_pk_bf16_f32 v139, v58, v59
    v_add_f32 v46, v46, v140
    v_mfma_f32_16x16x32_bf16 v[156:159], a[216:219], v[172:175], v[156:159]
    v_add_f32 v47, v47, v141
    s_waitcnt lgkmcnt(0)
    v_mfma_f32_16x16x32_bf16 v[64:67], a[192:195], v[160:163], v[80:83]
    v_exp_f32 v142, v142
    v_mfma_f32_16x16x32_bf16 v[64:67], a[196:199], v[176:179], v[64:67]
    v_exp_f32 v143, v143
    v_mfma_f32_16x16x32_bf16 v[64:67], a[200:203], v[192:195], v[64:67]
    ds_read_b64_tr_b16 a[240:241], v6 offset:128
    v_cvt_pk_bf16_f32 v140, v140, v141
    v_mfma_f32_16x16x32_bf16 v[64:67], a[204:207], v[208:211], v[64:67]
    v_exp_f32 v60, v60
    v_mfma_f32_16x16x32_bf16 v[64:67], a[208:211], v[224:227], v[64:67]
    ds_read_b64_tr_b16 a[242:243], v6 offset:6272
    v_add_f32 v46, v46, v142
    v_mfma_f32_16x16x32_bf16 v[64:67], a[212:215], v[240:243], v[64:67]
    v_exp_f32 v61, v61
    v_mfma_f32_16x16x32_bf16 v[68:71], a[212:215], v[244:247], v[84:87]
    ds_read_b64_tr_b16 a[244:245], v6 offset:12416
    v_add_f32 v47, v47, v143
    v_mfma_f32_16x16x32_bf16 v[68:71], a[208:211], v[228:231], v[68:71]
    v_cvt_pk_bf16_f32 v141, v142, v143
    v_add_f32 v46, v46, v60
    v_mfma_f32_16x16x32_bf16 v[68:71], a[204:207], v[212:215], v[68:71]
    ds_read_b64_tr_b16 a[246:247], v6 offset:18560
    v_add_f32 v47, v47, v61
    v_mfma_f32_16x16x32_bf16 v[68:71], a[200:203], v[196:199], v[68:71]
    v_exp_f32 v62, v62
    v_mfma_f32_16x16x32_bf16 v[68:71], a[196:199], v[180:183], v[68:71]
    ds_read_b64_tr_b16 a[248:249], v7 offset:128
    v_cvt_pk_bf16_f32 v142, v60, v61
    v_mfma_f32_16x16x32_bf16 v[68:71], a[192:195], v[164:167], v[68:71]
    v_exp_f32 v63, v63
    v_mfma_f32_16x16x32_bf16 v[72:75], a[192:195], v[168:171], v[88:91]
    ds_read_b64_tr_b16 a[250:251], v7 offset:6272
    v_add_f32 v46, v46, v62
    v_mfma_f32_16x16x32_bf16 v[72:75], a[196:199], v[184:187], v[72:75]
    v_add_f32 v47, v47, v63
    v_cvt_pk_bf16_f32 v143, v62, v63
    v_mfma_f32_16x16x32_bf16 v[72:75], a[200:203], v[200:203], v[72:75]
    ds_read_b64_tr_b16 a[252:253], v7 offset:12416
    v_mfma_f32_16x16x32_bf16 v[72:75], a[204:207], v[216:219], v[72:75]
    buffer_store_dwordx4 v[14:17], v39, s[48:51], s56 offen sc1
    v_mfma_f32_16x16x32_bf16 v[72:75], a[208:211], v[232:235], v[72:75]
    ds_read_b64_tr_b16 a[254:255], v7 offset:18560
    v_mfma_f32_16x16x32_bf16 v[72:75], a[212:215], v[248:251], v[72:75]
    v_mfma_f32_16x16x32_bf16 v[76:79], a[212:215], v[252:255], v[92:95]
    ds_read_b64_tr_b16 a[216:217], v4 offset:256
    v_mfma_f32_16x16x32_bf16 v[76:79], a[208:211], v[236:239], v[76:79]
    v_mfma_f32_16x16x32_bf16 v[76:79], a[204:207], v[220:223], v[76:79]
    ds_read_b64_tr_b16 a[218:219], v4 offset:6400
    v_mfma_f32_16x16x32_bf16 v[76:79], a[200:203], v[204:207], v[76:79]
    v_mfma_f32_16x16x32_bf16 v[76:79], a[196:199], v[188:191], v[76:79]
    ds_read_b64_tr_b16 a[220:221], v4 offset:12544
    v_mfma_f32_16x16x32_bf16 v[76:79], a[192:195], v[172:175], v[76:79]
    s_waitcnt lgkmcnt(3)
    v_mfma_f32_16x16x32_bf16 a[96:99], v[96:99], a[240:243], a[96:99]
    ds_read_b64_tr_b16 a[222:223], v4 offset:18688
    v_mfma_f32_16x16x32_bf16 a[96:99], v[112:115], a[244:247], a[96:99]
    v_exp_f32 v144, v144
    v_mfma_f32_16x16x32_bf16 a[100:103], v[116:119], a[244:247], a[100:103]
    ds_read_b64_tr_b16 a[224:225], v5 offset:256
    v_add_f32 v40, v40, v144
    v_mfma_f32_16x16x32_bf16 a[100:103], v[100:103], a[240:243], a[100:103]
    v_exp_f32 v145, v145
    v_mfma_f32_16x16x32_bf16 a[104:107], v[104:107], a[240:243], a[104:107]
    ds_read_b64_tr_b16 a[226:227], v5 offset:6400
    v_add_f32 v41, v41, v145
    v_mfma_f32_16x16x32_bf16 a[104:107], v[120:123], a[244:247], a[104:107]
    v_exp_f32 v146, v146
    v_mfma_f32_16x16x32_bf16 a[108:111], v[124:127], a[244:247], a[108:111]
    ds_read_b64_tr_b16 a[228:229], v5 offset:12544
    v_cvt_pk_bf16_f32 v144, v144, v145
    v_mfma_f32_16x16x32_bf16 a[108:111], v[108:111], a[240:243], a[108:111]
    v_exp_f32 v147, v147
    v_mfma_f32_16x16x32_bf16 a[124:127], v[108:111], a[248:251], a[124:127]
    ds_read_b64_tr_b16 a[230:231], v5 offset:18688
    v_add_f32 v40, v40, v146
    v_mfma_f32_16x16x32_bf16 a[124:127], v[124:127], a[252:255], a[124:127]
    v_exp_f32 v64, v64
    v_mfma_f32_16x16x32_bf16 a[120:123], v[120:123], a[252:255], a[120:123]
    ds_read_b64_tr_b16 a[232:233], v6 offset:256
    v_add_f32 v41, v41, v147
    v_mfma_f32_16x16x32_bf16 a[120:123], v[104:107], a[248:251], a[120:123]
    v_exp_f32 v65, v65
    v_mfma_f32_16x16x32_bf16 a[116:119], v[100:103], a[248:251], a[116:119]
    ds_read_b64_tr_b16 a[234:235], v6 offset:6400
    v_cvt_pk_bf16_f32 v145, v146, v147
    v_mfma_f32_16x16x32_bf16 a[116:119], v[116:119], a[252:255], a[116:119]
    v_exp_f32 v66, v66
    v_mfma_f32_16x16x32_bf16 a[112:115], v[112:115], a[252:255], a[112:115]
    ds_read_b64_tr_b16 a[236:237], v6 offset:12544
    v_add_f32 v40, v40, v64
    v_mfma_f32_16x16x32_bf16 a[112:115], v[96:99], a[248:251], a[112:115]
    v_add_f32 v41, v41, v65
    s_waitcnt lgkmcnt(3)
    v_mfma_f32_16x16x32_bf16 a[128:131], v[96:99], a[216:219], a[128:131]
    ds_read_b64_tr_b16 a[238:239], v6 offset:18688
    v_cvt_pk_bf16_f32 v146, v64, v65
    v_mfma_f32_16x16x32_bf16 a[128:131], v[112:115], a[220:223], a[128:131]
    v_exp_f32 v67, v67
    v_mfma_f32_16x16x32_bf16 a[132:135], v[116:119], a[220:223], a[132:135]
    ds_read_b64_tr_b16 a[240:241], v7 offset:256
    v_add_f32 v40, v40, v66
    v_mfma_f32_16x16x32_bf16 a[132:135], v[100:103], a[216:219], a[132:135]
    v_exp_f32 v148, v148
    v_mfma_f32_16x16x32_bf16 a[136:139], v[104:107], a[216:219], a[136:139]
    ds_read_b64_tr_b16 a[242:243], v7 offset:6400
    v_add_f32 v41, v41, v67
    v_mfma_f32_16x16x32_bf16 a[136:139], v[120:123], a[220:223], a[136:139]
    v_exp_f32 v149, v149
    v_mfma_f32_16x16x32_bf16 a[140:143], v[124:127], a[220:223], a[140:143]
    ds_read_b64_tr_b16 a[244:245], v7 offset:12544
    v_cvt_pk_bf16_f32 v147, v66, v67
    v_mfma_f32_16x16x32_bf16 a[140:143], v[108:111], a[216:219], a[140:143]
    v_exp_f32 v150, v150
    v_mfma_f32_16x16x32_bf16 a[156:159], v[108:111], a[224:227], a[156:159]
    ds_read_b64_tr_b16 a[246:247], v7 offset:18688
    v_add_f32 v42, v42, v148
    v_mfma_f32_16x16x32_bf16 a[156:159], v[124:127], a[228:231], a[156:159]
    v_exp_f32 v151, v151
    v_mfma_f32_16x16x32_bf16 a[152:155], v[120:123], a[228:231], a[152:155]
    v_add_f32 v43, v43, v149
    v_cvt_pk_bf16_f32 v148, v148, v149
    v_mfma_f32_16x16x32_bf16 a[152:155], v[104:107], a[224:227], a[152:155]
    v_add_u32 v35, 32, v35
    s_add_u32 s56, s56, 1024
    v_mfma_f32_16x16x32_bf16 a[148:151], v[100:103], a[224:227], a[148:151]
    v_exp_f32 v68, v68
    v_mfma_f32_16x16x32_bf16 a[148:151], v[116:119], a[228:231], a[148:151]
    v_add_f32 v42, v42, v150
    v_add_f32 v43, v43, v151
    v_mfma_f32_16x16x32_bf16 a[144:147], v[112:115], a[228:231], a[144:147]
    v_cvt_pk_bf16_f32 v149, v150, v151
    s_add_u32 m0, s29, 86016
    v_mfma_f32_16x16x32_bf16 a[144:147], v[96:99], a[224:227], a[144:147]
    s_waitcnt vmcnt(7) lgkmcnt(0)
    s_barrier
    v_mfma_f32_16x16x32_bf16 a[160:163], v[96:99], a[232:235], a[160:163]
    buffer_load_dwordx4 v11, s[20:23], s30 offen offset:0 lds
    v_add_f32 v42, v42, v68
    v_mfma_f32_16x16x32_bf16 a[160:163], v[112:115], a[236:239], a[160:163]
    ds_read_b128 a[192:195], v2 offset:0
    v_mfma_f32_16x16x32_bf16 a[164:167], v[116:119], a[236:239], a[164:167]
    ds_read_b128 a[196:199], v3 offset:0
    v_mfma_f32_16x16x32_bf16 a[164:167], v[100:103], a[232:235], a[164:167]
    ds_read_b128 a[200:203], v2 offset:128
    v_mfma_f32_16x16x32_bf16 a[168:171], v[104:107], a[232:235], a[168:171]
    ds_read_b128 a[204:207], v3 offset:128
    v_mfma_f32_16x16x32_bf16 a[168:171], v[120:123], a[236:239], a[168:171]
    ds_read_b128 a[208:211], v2 offset:256
    v_mfma_f32_16x16x32_bf16 a[172:175], v[124:127], a[236:239], a[172:175]
    ds_read_b128 a[212:215], v3 offset:256
    v_mfma_f32_16x16x32_bf16 a[172:175], v[108:111], a[232:235], a[172:175]
    v_exp_f32 v69, v69
    v_mfma_f32_16x16x32_bf16 a[188:191], v[108:111], a[240:243], a[188:191]
    buffer_load_dwordx4 v12, s[20:23], s30 offen offset:1024 lds
    v_add_f32 v43, v43, v69
    v_mfma_f32_16x16x32_bf16 a[188:191], v[124:127], a[244:247], a[188:191]
    v_exp_f32 v70, v70
    v_mfma_f32_16x16x32_bf16 a[184:187], v[120:123], a[244:247], a[184:187]
    v_exp_f32 v71, v71
    v_mfma_f32_16x16x32_bf16 a[184:187], v[104:107], a[240:243], a[184:187]
    v_cvt_pk_bf16_f32 v150, v68, v69
    v_add_f32 v42, v42, v70
    v_mfma_f32_16x16x32_bf16 a[180:183], v[100:103], a[240:243], a[180:183]
    v_add_f32 v43, v43, v71
    v_cvt_pk_bf16_f32 v151, v70, v71
    v_mfma_f32_16x16x32_bf16 a[180:183], v[116:119], a[244:247], a[180:183]
    buffer_load_dwordx4 v13, s[20:23], s30 offen offset:2048 lds
    s_add_u32 s30, s30, 12288
    v_mfma_f32_16x16x32_bf16 a[176:179], v[112:115], a[244:247], a[176:179]
    s_cmp_eq_u32 s54, 0
    v_mfma_f32_16x16x32_bf16 a[176:179], v[96:99], a[240:243], a[176:179]
    s_waitcnt lgkmcnt(0)
    s_cbranch_scc1 K1_TAIL
K1_LOOP2:
    v_mfma_f32_16x16x32_bf16 v[96:99], a[192:195], v[160:163], v[80:83]
    v_exp_f32 v152, v152
    v_mfma_f32_16x16x32_bf16 v[96:99], a[196:199], v[176:179], v[96:99]
    ds_read_b128 a[216:219], v2 offset:6144
    s_add_u32 m0, s29, 98304
    v_mfma_f32_16x16x32_bf16 v[96:99], a[200:203], v[192:195], v[96:99]
    v_exp_f32 v153, v153
    v_mfma_f32_16x16x32_bf16 v[96:99], a[204:207], v[208:211], v[96:99]
    buffer_load_dwordx4 v11, s[20:23], s30 offen offset:0 lds
    v_add_f32 v44, v44, v152
    v_mfma_f32_16x16x32_bf16 v[96:99], a[208:211], v[224:227], v[96:99]
    ds_read_b128 a[220:223], v3 offset:6144
    v_add_f32 v45, v45, v153
    v_mfma_f32_16x16x32_bf16 v[96:99], a[212:215], v[240:243], v[96:99]
    v_exp_f32 v154, v154
    v_mfma_f32_16x16x32_bf16 v[100:103], a[212:215], v[244:247], v[84:87]
    v_exp_f32 v155, v155
    v_mfma_f32_16x16x32_bf16 v[100:103], a[208:211], v[228:231], v[100:103]
    ds_read_b128 a[224:227], v2 offset:6272
    v_cvt_pk_bf16_f32 v152, v152, v153
    v_mfma_f32_16x16x32_bf16 v[100:103], a[204:207], v[212:215], v[100:103]
    buffer_load_dwordx4 v12, s[20:23], s30 offen offset:1024 lds
    v_add_f32 v44, v44, v154
    v_mfma_f32_16x16x32_bf16 v[100:103], a[200:203], v[196:199], v[100:103]
    v_exp_f32 v72, v72
    v_mfma_f32_16x16x32_bf16 v[100:103], a[196:199], v[180:183], v[100:103]
    ds_read_b128 a[228:231], v3 offset:6272
    v_add_f32 v45, v45, v155
    v_mfma_f32_16x16x32_bf16 v[100:103], a[192:195], v[164:167], v[100:103]
    v_exp_f32 v73, v73
    v_mfma_f32_16x16x32_bf16 v[104:107], a[192:195], v[168:171], v[88:91]
    buffer_load_dwordx4 v13, s[20:23], s30 offen offset:2048 lds
    v_cvt_pk_bf16_f32 v153, v154, v155
    v_mfma_f32_16x16x32_bf16 v[104:107], a[196:199], v[184:187], v[104:107]
    ds_read_b128 a[232:235], v2 offset:6400
    s_add_u32 s30, s30, 12288
    v_mfma_f32_16x16x32_bf16 v[104:107], a[200:203], v[200:203], v[104:107]
    v_exp_f32 v74, v74
    v_mfma_f32_16x16x32_bf16 v[104:107], a[204:207], v[216:219], v[104:107]
    v_add_f32 v44, v44, v72
    v_add_f32 v45, v45, v73
    v_mfma_f32_16x16x32_bf16 v[104:107], a[208:211], v[232:235], v[104:107]
    ds_read_b128 a[236:239], v3 offset:6400
    v_cvt_pk_bf16_f32 v154, v72, v73
    v_mfma_f32_16x16x32_bf16 v[104:107], a[212:215], v[248:251], v[104:107]
    v_exp_f32 v75, v75
    v_mfma_f32_16x16x32_bf16 v[108:111], a[212:215], v[252:255], v[92:95]
    v_exp_f32 v156, v156
    v_mfma_f32_16x16x32_bf16 v[108:111], a[208:211], v[236:239], v[108:111]
    v_add_f32 v44, v44, v74
    v_add_f32 v45, v45, v75
    v_mfma_f32_16x16x32_bf16 v[108:111], a[204:207], v[220:223], v[108:111]
    v_exp_f32 v157, v157
    v_mfma_f32_16x16x32_bf16 v[108:111], a[200:203], v[204:207], v[108:111]
    v_cvt_pk_bf16_f32 v155, v74, v75
    v_add_f32 v46, v46, v156
    v_mfma_f32_16x16x32_bf16 v[108:111], a[196:199], v[188:191], v[108:111]
    v_exp_f32 v158, v158
    v_mfma_f32_16x16x32_bf16 v[108:111], a[192:195], v[172:175], v[108:111]
    v_add_f32 v47, v47, v157
    s_waitcnt lgkmcnt(0)
    v_mfma_f32_16x16x32_bf16 v[48:51], a[216:219], v[160:163], v[80:83]
    v_exp_f32 v159, v159
    v_mfma_f32_16x16x32_bf16 v[48:51], a[220:223], v[176:179], v[48:51]
    v_cvt_pk_bf16_f32 v156, v156, v157
    v_add_f32 v46, v46, v158
    v_mfma_f32_16x16x32_bf16 v[48:51], a[224:227], v[192:195], v[48:51]
    ds_read_b64_tr_b16 a[240:241], v4 offset:24576
    v_add_f32 v47, v47, v159
    v_mfma_f32_16x16x32_bf16 v[48:51], a[228:231], v[208:211], v[48:51]
    v_exp_f32 v76, v76
    v_mfma_f32_16x16x32_bf16 v[48:51], a[232:235], v[224:227], v[48:51]
    ds_read_b64_tr_b16 a[242:243], v4 offset:30720
    v_cvt_pk_bf16_f32 v157, v158, v159
    v_mfma_f32_16x16x32_bf16 v[48:51], a[236:239], v[240:243], v[48:51]
    v_exp_f32 v77, v77
    v_mfma_f32_16x16x32_bf16 v[52:55], a[236:239], v[244:247], v[84:87]
    ds_read_b64_tr_b16 a[244:245], v4 offset:36864
    v_add_f32 v46, v46, v76
    v_mfma_f32_16x16x32_bf16 v[52:55], a[232:235], v[228:231], v[52:55]
    v_exp_f32 v78, v78
    v_mfma_f32_16x16x32_bf16 v[52:55], a[228:231], v[212:215], v[52:55]
    ds_read_b64_tr_b16 a[246:247], v4 offset:43008
    v_add_f32 v47, v47, v77
    v_mfma_f32_16x16x32_bf16 v[52:55], a[224:227], v[196:199], v[52:55]
    v_exp_f32 v79, v79
    v_mfma_f32_16x16x32_bf16 v[52:55], a[220:223], v[180:183], v[52:55]
    ds_read_b64_tr_b16 a[248:249], v5 offset:24576
    v_cvt_pk_bf16_f32 v158, v76, v77
    v_mfma_f32_16x16x32_bf16 v[52:55], a[216:219], v[164:167], v[52:55]
    v_add_f32 v46, v46, v78
    v_add_f32 v47, v47, v79
    v_mfma_f32_16x16x32_bf16 v[56:59], a[216:219], v[168:171], v[88:91]
    ds_read_b64_tr_b16 a[250:251], v5 offset:30720
    v_cvt_pk_bf16_f32 v159, v78, v79
    v_mfma_f32_16x16x32_bf16 v[56:59], a[220:223], v[184:187], v[56:59]
    v_mfma_f32_16x16x32_bf16 v[56:59], a[224:227], v[200:203], v[56:59]
    ds_read_b64_tr_b16 a[252:253], v5 offset:36864
    v_mfma_f32_16x16x32_bf16 v[56:59], a[228:231], v[216:219], v[56:59]
    buffer_store_dwordx4 v[18:21], v39, s[44:47], s57 offen sc1
    v_mfma_f32_16x16x32_bf16 v[56:59], a[232:235], v[232:235], v[56:59]
    ds_read_b64_tr_b16 a[254:255], v5 offset:43008
    v_mfma_f32_16x16x32_bf16 v[56:59], a[236:239], v[248:251], v[56:59]
    v_mfma_f32_16x16x32_bf16 v[60:63], a[236:239], v[252:255], v[92:95]
    ds_read_b64_tr_b16 a[192:193], v6 offset:24576
    v_mfma_f32_16x16x32_bf16 v[60:63], a[232:235], v[236:239], v[60:63]
    v_mfma_f32_16x16x32_bf16 v[60:63], a[228:231], v[220:223], v[60:63]
    ds_read_b64_tr_b16 a[194:195], v6 offset:30720
    v_mfma_f32_16x16x32_bf16 v[60:63], a[224:227], v[204:207], v[60:63]
    v_mfma_f32_16x16x32_bf16 v[60:63], a[220:223], v[188:191], v[60:63]
    ds_read_b64_tr_b16 a[196:197], v6 offset:36864
    v_mfma_f32_16x16x32_bf16 v[60:63], a[216:219], v[172:175], v[60:63]
    s_waitcnt lgkmcnt(3)
    v_mfma_f32_16x16x32_bf16 a[0:3], v[128:131], a[240:243], a[0:3]
    ds_read_b64_tr_b16 a[198:199], v6 offset:43008
    v_mfma_f32_16x16x32_bf16 a[0:3], v[144:147], a[244:247], a[0:3]
    v_exp_f32 v96, v96
    v_mfma_f32_16x16x32_bf16 a[4:7], v[148:151], a[244:247], a[4:7]
    ds_read_b64_tr_b16 a[200:201], v7 offset:24576
    v_add_f32 v40, v40, v96
    v_mfma_f32_16x16x32_bf16 a[4:7], v[132:135], a[240:243], a[4:7]
    v_exp_f32 v97, v97
    v_mfma_f32_16x16x32_bf16 a[8:11], v[136:139], a[240:243], a[8:11]
    ds_read_b64_tr_b16 a[202:203], v7 offset:30720
    v_add_f32 v41, v41, v97
    v_mfma_f32_16x16x32_bf16 a[8:11], v[152:155], a[244:247], a[8:11]
    v_exp_f32 v98, v98
    v_mfma_f32_16x16x32_bf16 a[12:15], v[156:159], a[244:247], a[12:15]
    ds_read_b64_tr_b16 a[204:205], v7 offset:36864
    v_cvt_pk_bf16_f32 v96, v96, v97
    v_mfma_f32_16x16x32_bf16 a[12:15], v[140:143], a[240:243], a[12:15]
    v_exp_f32 v99, v99
    v_mfma_f32_16x16x32_bf16 a[28:31], v[140:143], a[248:251], a[28:31]
    ds_read_b64_tr_b16 a[206:207], v7 offset:43008
    v_add_f32 v40, v40, v98
    v_mfma_f32_16x16x32_bf16 a[28:31], v[156:159], a[252:255], a[28:31]
    v_exp_f32 v48, v48
    v_mfma_f32_16x16x32_bf16 a[24:27], v[152:155], a[252:255], a[24:27]
    ds_read_b64_tr_b16 a[208:209], v4 offset:24704
    v_add_f32 v41, v41, v99
    v_mfma_f32_16x16x32_bf16 a[24:27], v[136:139], a[248:251], a[24:27]
    v_exp_f32 v49, v49
    v_mfma_f32_16x16x32_bf16 a[20:23], v[132:135], a[248:251], a[20:23]
    ds_read_b64_tr_b16 a[210:211], v4 offset:30848
    v_cvt_pk_bf16_f32 v97, v98, v99
    v_mfma_f32_16x16x32_bf16 a[20:23], v[148:151], a[252:255], a[20:23]
    v_exp_f32 v50, v50
    v_mfma_f32_16x16x32_bf16 a[16:19], v[144:147], a[252:255], a[16:19]
    ds_read_b64_tr_b16 a[212:213], v4 offset:36992
    v_add_f32 v40, v40, v48
    v_mfma_f32_16x16x32_bf16 a[16:19], v[128:131], a[248:251], a[16:19]
    v_add_f32 v41, v41, v49
    s_waitcnt lgkmcnt(3)
    v_mfma_f32_16x16x32_bf16 a[32:35], v[128:131], a[192:195], a[32:35]
    ds_read_b64_tr_b16 a[214:215], v4 offset:43136
    v_cvt_pk_bf16_f32 v98, v48, v49
    v_mfma_f32_16x16x32_bf16 a[32:35], v[144:147], a[196:199], a[32:35]
    v_exp_f32 v51, v51
    v_mfma_f32_16x16x32_bf16 a[36:39], v[148:151], a[196:199], a[36:39]
    ds_read_b64_tr_b16 a[240:241], v5 offset:24704
    v_add_f32 v40, v40, v50
    v_mfma_f32_16x16x32_bf16 a[36:39], v[132:135], a[192:195], a[36:39]
    v_exp_f32 v100, v100
    v_mfma_f32_16x16x32_bf16 a[40:43], v[136:139], a[192:195], a[40:43]
    ds_read_b64_tr_b16 a[242:243], v5 offset:30848
    v_add_f32 v41, v41, v51
    v_mfma_f32_16x16x32_bf16 a[40:43], v[152:155], a[196:199], a[40:43]
    v_exp_f32 v101, v101
    v_mfma_f32_16x16x32_bf16 a[44:47], v[156:159], a[196:199], a[44:47]
    ds_read_b64_tr_b16 a[244:245], v5 offset:36992
    v_cvt_pk_bf16_f32 v99, v50, v51
    v_mfma_f32_16x16x32_bf16 a[44:47], v[140:143], a[192:195], a[44:47]
    v_exp_f32 v102, v102
    v_mfma_f32_16x16x32_bf16 a[60:63], v[140:143], a[200:203], a[60:63]
    ds_read_b64_tr_b16 a[246:247], v5 offset:43136
    v_add_f32 v42, v42, v100
    v_mfma_f32_16x16x32_bf16 a[60:63], v[156:159], a[204:207], a[60:63]
    v_exp_f32 v103, v103
    v_mfma_f32_16x16x32_bf16 a[56:59], v[152:155], a[204:207], a[56:59]
    v_add_f32 v43, v43, v101
    v_cvt_pk_bf16_f32 v100, v100, v101
    v_mfma_f32_16x16x32_bf16 a[56:59], v[136:139], a[200:203], a[56:59]
    v_add_f32 v42, v42, v102
    s_add_u32 s57, s57, 1024
    v_mfma_f32_16x16x32_bf16 a[52:55], v[132:135], a[200:203], a[52:55]
    v_exp_f32 v52, v52
    v_mfma_f32_16x16x32_bf16 a[52:55], v[148:151], a[204:207], a[52:55]
    v_exp_f32 v53, v53
    v_mfma_f32_16x16x32_bf16 a[48:51], v[144:147], a[204:207], a[48:51]
    v_add_f32 v43, v43, v103
    s_add_u32 m0, s29, 73728
    v_mfma_f32_16x16x32_bf16 a[48:51], v[128:131], a[200:203], a[48:51]
    s_waitcnt vmcnt(11) lgkmcnt(0)
    s_barrier
    v_mfma_f32_16x16x32_bf16 a[64:67], v[128:131], a[208:211], a[64:67]
    buffer_load_dwordx4 v8, s[16:19], s30 offen offset:0 lds
    v_cvt_pk_bf16_f32 v101, v102, v103
    v_mfma_f32_16x16x32_bf16 a[64:67], v[144:147], a[212:215], a[64:67]
    ds_read_b128 a[216:219], v2 offset:12288
    v_add_f32 v42, v42, v52
    v_mfma_f32_16x16x32_bf16 a[68:71], v[148:151], a[212:215], a[68:71]
    ds_read_b128 a[220:223], v3 offset:12288
    v_add_f32 v43, v43, v53
    v_mfma_f32_16x16x32_bf16 a[68:71], v[132:135], a[208:211], a[68:71]
    ds_read_b128 a[224:227], v2 offset:12416
    v_cvt_pk_bf16_f32 v102, v52, v53
    v_mfma_f32_16x16x32_bf16 a[72:75], v[136:139], a[208:211], a[72:75]
    ds_read_b128 a[228:231], v3 offset:12416
    v_mfma_f32_16x16x32_bf16 a[72:75], v[152:155], a[212:215], a[72:75]
    ds_read_b128 a[232:235], v2 offset:12544
    v_mfma_f32_16x16x32_bf16 a[76:79], v[156:159], a[212:215], a[76:79]
    ds_read_b128 a[236:239], v3 offset:12544
    v_mfma_f32_16x16x32_bf16 a[76:79], v[140:143], a[208:211], a[76:79]
    v_exp_f32 v54, v54
    v_mfma_f32_16x16x32_bf16 a[92:95], v[140:143], a[240:243], a[92:95]
    buffer_load_dwordx4 v9, s[16:19], s30 offen offset:1024 lds
    v_add_f32 v42, v42, v54
    v_mfma_f32_16x16x32_bf16 a[92:95], v[156:159], a[244:247], a[92:95]
    v_exp_f32 v55, v55
    v_mfma_f32_16x16x32_bf16 a[88:91], v[152:155], a[244:247], a[88:91]
    v_add_f32 v43, v43, v55
    v_cvt_pk_bf16_f32 v103, v54, v55
    v_mfma_f32_16x16x32_bf16 a[88:91], v[136:139], a[240:243], a[88:91]
    v_mfma_f32_16x16x32_bf16 a[84:87], v[132:135], a[240:243], a[84:87]
    v_mfma_f32_16x16x32_bf16 a[84:87], v[148:151], a[244:247], a[84:87]
    buffer_load_dwordx4 v10, s[16:19], s30 offen offset:2048 lds
    s_add_u32 s30, s30, 12288
    v_mfma_f32_16x16x32_bf16 a[80:83], v[144:147], a[244:247], a[80:83]
    v_mfma_f32_16x16x32_bf16 a[80:83], v[128:131], a[240:243], a[80:83]
    s_waitcnt lgkmcnt(0)
    v_mfma_f32_16x16x32_bf16 v[112:115], a[216:219], v[160:163], v[80:83]
    v_exp_f32 v104, v104
    v_mfma_f32_16x16x32_bf16 v[112:115], a[220:223], v[176:179], v[112:115]
    ds_read_b128 a[192:195], v2 offset:18432
    s_add_u32 m0, s29, 36864
    v_mfma_f32_16x16x32_bf16 v[112:115], a[224:227], v[192:195], v[112:115]
    v_exp_f32 v105, v105
    v_mfma_f32_16x16x32_bf16 v[112:115], a[228:231], v[208:211], v[112:115]
    buffer_load_dwordx4 v8, s[16:19], s30 offen offset:0 lds
    v_add_f32 v44, v44, v104
    v_mfma_f32_16x16x32_bf16 v[112:115], a[232:235], v[224:227], v[112:115]
    ds_read_b128 a[196:199], v3 offset:18432
    v_add_f32 v45, v45, v105
    v_mfma_f32_16x16x32_bf16 v[112:115], a[236:239], v[240:243], v[112:115]
    v_exp_f32 v106, v106
    v_mfma_f32_16x16x32_bf16 v[116:119], a[236:239], v[244:247], v[84:87]
    v_exp_f32 v107, v107
    v_mfma_f32_16x16x32_bf16 v[116:119], a[232:235], v[228:231], v[116:119]
    ds_read_b128 a[200:203], v2 offset:18560
    v_cvt_pk_bf16_f32 v104, v104, v105
    v_mfma_f32_16x16x32_bf16 v[116:119], a[228:231], v[212:215], v[116:119]
    buffer_load_dwordx4 v9, s[16:19], s30 offen offset:1024 lds
    v_add_f32 v44, v44, v106
    v_mfma_f32_16x16x32_bf16 v[116:119], a[224:227], v[196:199], v[116:119]
    v_exp_f32 v56, v56
    v_mfma_f32_16x16x32_bf16 v[116:119], a[220:223], v[180:183], v[116:119]
    ds_read_b128 a[204:207], v3 offset:18560
    v_add_f32 v45, v45, v107
    v_mfma_f32_16x16x32_bf16 v[116:119], a[216:219], v[164:167], v[116:119]
    v_exp_f32 v57, v57
    v_mfma_f32_16x16x32_bf16 v[120:123], a[216:219], v[168:171], v[88:91]
    buffer_load_dwordx4 v10, s[16:19], s30 offen offset:2048 lds
    v_cvt_pk_bf16_f32 v105, v106, v107
    v_mfma_f32_16x16x32_bf16 v[120:123], a[220:223], v[184:187], v[120:123]
    ds_read_b128 a[208:211], v2 offset:18688
    s_sub_u32 s30, s30, 12288
    v_mfma_f32_16x16x32_bf16 v[120:123], a[224:227], v[200:203], v[120:123]
    v_exp_f32 v58, v58
    v_mfma_f32_16x16x32_bf16 v[120:123], a[228:231], v[216:219], v[120:123]
    v_add_f32 v44, v44, v56
    v_add_f32 v45, v45, v57
    v_mfma_f32_16x16x32_bf16 v[120:123], a[232:235], v[232:235], v[120:123]
    ds_read_b128 a[212:215], v3 offset:18688
    v_cvt_pk_bf16_f32 v106, v56, v57
    v_mfma_f32_16x16x32_bf16 v[120:123], a[236:239], v[248:251], v[120:123]
    v_exp_f32 v59, v59
    v_mfma_f32_16x16x32_bf16 v[124:127], a[236:239], v[252:255], v[92:95]
    v_exp_f32 v108, v108
    v_mfma_f32_16x16x32_bf16 v[124:127], a[232:235], v[236:239], v[124:127]
    v_add_f32 v44, v44, v58
    v_add_f32 v45, v45, v59
    v_mfma_f32_16x16x32_bf16 v[124:127], a[228:231], v[220:223], v[124:127]
    v_exp_f32 v109, v109
    v_mfma_f32_16x16x32_bf16 v[124:127], a[224:227], v[204:207], v[124:127]
    v_cvt_pk_bf16_f32 v107, v58, v59
    v_add_f32 v46, v46, v108
    v_mfma_f32_16x16x32_bf16 v[124:127], a[220:223], v[188:191], v[124:127]
    v_exp_f32 v110, v110
    v_mfma_f32_16x16x32_bf16 v[124:127], a[216:219], v[172:175], v[124:127]
    v_add_f32 v47, v47, v109
    s_waitcnt lgkmcnt(0)
    v_mfma_f32_16x16x32_bf16 v[64:67], a[192:195], v[160:163], v[80:83]
    v_exp_f32 v111, v111
    v_mfma_f32_16x16x32_bf16 v[64:67], a[196:199], v[176:179], v[64:67]
    v_cvt_pk_bf16_f32 v108, v108, v109
    v_add_f32 v46, v46, v110
    v_mfma_f32_16x16x32_bf16 v[64:67], a[200:203], v[192:195], v[64:67]
    ds_read_b64_tr_b16 a[240:241], v6 offset:24704
    v_add_f32 v47, v47, v111
    v_mfma_f32_16x16x32_bf16 v[64:67], a[204:207], v[208:211], v[64:67]
    v_exp_f32 v60, v60
    v_mfma_f32_16x16x32_bf16 v[64:67], a[208:211], v[224:227], v[64:67]
    ds_read_b64_tr_b16 a[242:243], v6 offset:30848
    v_cvt_pk_bf16_f32 v109, v110, v111
    v_mfma_f32_16x16x32_bf16 v[64:67], a[212:215], v[240:243], v[64:67]
    v_exp_f32 v61, v61
    v_mfma_f32_16x16x32_bf16 v[68:71], a[212:215], v[244:247], v[84:87]
    ds_read_b64_tr_b16 a[244:245], v6 offset:36992
    v_add_f32 v46, v46, v60
    v_mfma_f32_16x16x32_bf16 v[68:71], a[208:211], v[228:231], v[68:71]
    v_exp_f32 v62, v62
    v_mfma_f32_16x16x32_bf16 v[68:71], a[204:207], v[212:215], v[68:71]
    ds_read_b64_tr_b16 a[246:247], v6 offset:43136
    v_add_f32 v47, v47, v61
    v_mfma_f32_16x16x32_bf16 v[68:71], a[200:203], v[196:199], v[68:71]
    v_exp_f32 v63, v63
    v_mfma_f32_16x16x32_bf16 v[68:71], a[196:199], v[180:183], v[68:71]
    ds_read_b64_tr_b16 a[248:249], v7 offset:24704
    v_cvt_pk_bf16_f32 v110, v60, v61
    v_mfma_f32_16x16x32_bf16 v[68:71], a[192:195], v[164:167], v[68:71]
    v_add_f32 v46, v46, v62
    v_add_f32 v47, v47, v63
    v_mfma_f32_16x16x32_bf16 v[72:75], a[192:195], v[168:171], v[88:91]
    ds_read_b64_tr_b16 a[250:251], v7 offset:30848
    v_cvt_pk_bf16_f32 v111, v62, v63
    v_mfma_f32_16x16x32_bf16 v[72:75], a[196:199], v[184:187], v[72:75]
    v_mfma_f32_16x16x32_bf16 v[72:75], a[200:203], v[200:203], v[72:75]
    ds_read_b64_tr_b16 a[252:253], v7 offset:36992
    v_mfma_f32_16x16x32_bf16 v[72:75], a[204:207], v[216:219], v[72:75]
    v_mfma_f32_16x16x32_bf16 v[72:75], a[208:211], v[232:235], v[72:75]
    ds_read_b64_tr_b16 a[254:255], v7 offset:43136
    v_mfma_f32_16x16x32_bf16 v[72:75], a[212:215], v[248:251], v[72:75]
    v_mfma_f32_16x16x32_bf16 v[76:79], a[212:215], v[252:255], v[92:95]
    ds_read_b64_tr_b16 a[216:217], v4 offset:24832
    v_mfma_f32_16x16x32_bf16 v[76:79], a[208:211], v[236:239], v[76:79]
    v_mfma_f32_16x16x32_bf16 v[76:79], a[204:207], v[220:223], v[76:79]
    ds_read_b64_tr_b16 a[218:219], v4 offset:30976
    v_mfma_f32_16x16x32_bf16 v[76:79], a[200:203], v[204:207], v[76:79]
    v_mfma_f32_16x16x32_bf16 v[76:79], a[196:199], v[188:191], v[76:79]
    ds_read_b64_tr_b16 a[220:221], v4 offset:37120
    v_mfma_f32_16x16x32_bf16 v[76:79], a[192:195], v[172:175], v[76:79]
    s_waitcnt lgkmcnt(3)
    v_mfma_f32_16x16x32_bf16 a[96:99], v[128:131], a[240:243], a[96:99]
    ds_read_b64_tr_b16 a[222:223], v4 offset:43264
    v_mfma_f32_16x16x32_bf16 a[96:99], v[144:147], a[244:247], a[96:99]
    v_exp_f32 v112, v112
    v_mfma_f32_16x16x32_bf16 a[100:103], v[148:151], a[244:247], a[100:103]
    ds_read_b64_tr_b16 a[224:225], v5 offset:24832
    v_add_f32 v40, v40, v112
    v_mfma_f32_16x16x32_bf16 a[100:103], v[132:135], a[240:243], a[100:103]
    v_exp_f32 v113, v113
    v_mfma_f32_16x16x32_bf16 a[104:107], v[136:139], a[240:243], a[104:107]
    ds_read_b64_tr_b16 a[226:227], v5 offset:30976
    v_add_f32 v41, v41, v113
    v_mfma_f32_16x16x32_bf16 a[104:107], v[152:155], a[244:247], a[104:107]
    v_exp_f32 v114, v114
    v_mfma_f32_16x16x32_bf16 a[108:111], v[156:159], a[244:247], a[108:111]
    ds_read_b64_tr_b16 a[228:229], v5 offset:37120
    v_cvt_pk_bf16_f32 v112, v112, v113
    v_mfma_f32_16x16x32_bf16 a[108:111], v[140:143], a[240:243], a[108:111]
    v_exp_f32 v115, v115
    v_mfma_f32_16x16x32_bf16 a[124:127], v[140:143], a[248:251], a[124:127]
    ds_read_b64_tr_b16 a[230:231], v5 offset:43264
    v_add_f32 v40, v40, v114
    v_mfma_f32_16x16x32_bf16 a[124:127], v[156:159], a[252:255], a[124:127]
    v_exp_f32 v64, v64
    v_mfma_f32_16x16x32_bf16 a[120:123], v[152:155], a[252:255], a[120:123]
    ds_read_b64_tr_b16 a[232:233], v6 offset:24832
    v_add_f32 v41, v41, v115
    v_mfma_f32_16x16x32_bf16 a[120:123], v[136:139], a[248:251], a[120:123]
    v_exp_f32 v65, v65
    v_mfma_f32_16x16x32_bf16 a[116:119], v[132:135], a[248:251], a[116:119]
    ds_read_b64_tr_b16 a[234:235], v6 offset:30976
    v_cvt_pk_bf16_f32 v113, v114, v115
    v_mfma_f32_16x16x32_bf16 a[116:119], v[148:151], a[252:255], a[116:119]
    v_exp_f32 v66, v66
    v_mfma_f32_16x16x32_bf16 a[112:115], v[144:147], a[252:255], a[112:115]
    ds_read_b64_tr_b16 a[236:237], v6 offset:37120
    v_add_f32 v40, v40, v64
    v_mfma_f32_16x16x32_bf16 a[112:115], v[128:131], a[248:251], a[112:115]
    v_add_f32 v41, v41, v65
    s_waitcnt lgkmcnt(3)
    v_mfma_f32_16x16x32_bf16 a[128:131], v[128:131], a[216:219], a[128:131]
    ds_read_b64_tr_b16 a[238:239], v6 offset:43264
    v_cvt_pk_bf16_f32 v114, v64, v65
    v_mfma_f32_16x16x32_bf16 a[128:131], v[144:147], a[220:223], a[128:131]
    v_exp_f32 v67, v67
    v_mfma_f32_16x16x32_bf16 a[132:135], v[148:151], a[220:223], a[132:135]
    ds_read_b64_tr_b16 a[240:241], v7 offset:24832
    v_add_f32 v40, v40, v66
    v_mfma_f32_16x16x32_bf16 a[132:135], v[132:135], a[216:219], a[132:135]
    v_exp_f32 v116, v116
    v_mfma_f32_16x16x32_bf16 a[136:139], v[136:139], a[216:219], a[136:139]
    ds_read_b64_tr_b16 a[242:243], v7 offset:30976
    v_add_f32 v41, v41, v67
    v_mfma_f32_16x16x32_bf16 a[136:139], v[152:155], a[220:223], a[136:139]
    v_exp_f32 v117, v117
    v_mfma_f32_16x16x32_bf16 a[140:143], v[156:159], a[220:223], a[140:143]
    ds_read_b64_tr_b16 a[244:245], v7 offset:37120
    v_cvt_pk_bf16_f32 v115, v66, v67
    v_mfma_f32_16x16x32_bf16 a[140:143], v[140:143], a[216:219], a[140:143]
    v_exp_f32 v118, v118
    v_mfma_f32_16x16x32_bf16 a[156:159], v[140:143], a[224:227], a[156:159]
    ds_read_b64_tr_b16 a[246:247], v7 offset:43264
    v_add_f32 v42, v42, v116
    v_mfma_f32_16x16x32_bf16 a[156:159], v[156:159], a[228:231], a[156:159]
    v_exp_f32 v119, v119
    v_mfma_f32_16x16x32_bf16 a[152:155], v[152:155], a[228:231], a[152:155]
    v_add_f32 v43, v43, v117
    v_cvt_pk_bf16_f32 v116, v116, v117
    v_mfma_f32_16x16x32_bf16 a[152:155], v[136:139], a[224:227], a[152:155]
    v_exp_f32 v68, v68
    v_mfma_f32_16x16x32_bf16 a[148:151], v[132:135], a[224:227], a[148:151]
    v_add_f32 v42, v42, v118
    v_add_f32 v43, v43, v119
    v_mfma_f32_16x16x32_bf16 a[148:151], v[148:151], a[228:231], a[148:151]
    v_exp_f32 v69, v69
    v_mfma_f32_16x16x32_bf16 a[144:147], v[144:147], a[228:231], a[144:147]
    v_cvt_pk_bf16_f32 v117, v118, v119
    s_add_u32 m0, s29, 110592
    v_mfma_f32_16x16x32_bf16 a[144:147], v[128:131], a[224:227], a[144:147]
    s_waitcnt vmcnt(7) lgkmcnt(0)
    s_barrier
    v_mfma_f32_16x16x32_bf16 a[160:163], v[128:131], a[232:235], a[160:163]
    buffer_load_dwordx4 v11, s[20:23], s30 offen offset:0 lds
    v_add_f32 v42, v42, v68
    v_mfma_f32_16x16x32_bf16 a[160:163], v[144:147], a[236:239], a[160:163]
    ds_read_b128 a[192:195], v2 offset:24576
    v_add_f32 v43, v43, v69
    v_mfma_f32_16x16x32_bf16 a[164:167], v[148:151], a[236:239], a[164:167]
    ds_read_b128 a[196:199], v3 offset:24576
    v_cvt_pk_bf16_f32 v118, v68, v69
    v_mfma_f32_16x16x32_bf16 a[164:167], v[132:135], a[232:235], a[164:167]
    ds_read_b128 a[200:203], v2 offset:24704
    v_mfma_f32_16x16x32_bf16 a[168:171], v[136:139], a[232:235], a[168:171]
    ds_read_b128 a[204:207], v3 offset:24704
    v_mfma_f32_16x16x32_bf16 a[168:171], v[152:155], a[236:239], a[168:171]
    ds_read_b128 a[208:211], v2 offset:24832
    v_mfma_f32_16x16x32_bf16 a[172:175], v[156:159], a[236:239], a[172:175]
    ds_read_b128 a[212:215], v3 offset:24832
    v_mfma_f32_16x16x32_bf16 a[172:175], v[140:143], a[232:235], a[172:175]
    v_exp_f32 v70, v70
    v_mfma_f32_16x16x32_bf16 a[188:191], v[140:143], a[240:243], a[188:191]
    buffer_load_dwordx4 v12, s[20:23], s30 offen offset:1024 lds
    v_add_f32 v42, v42, v70
    v_mfma_f32_16x16x32_bf16 a[188:191], v[156:159], a[244:247], a[188:191]
    v_exp_f32 v71, v71
    v_mfma_f32_16x16x32_bf16 a[184:187], v[152:155], a[244:247], a[184:187]
    v_add_f32 v43, v43, v71
    v_cvt_pk_bf16_f32 v119, v70, v71
    v_mfma_f32_16x16x32_bf16 a[184:187], v[136:139], a[240:243], a[184:187]
    v_mfma_f32_16x16x32_bf16 a[180:183], v[132:135], a[240:243], a[180:183]
    v_mfma_f32_16x16x32_bf16 a[180:183], v[148:151], a[244:247], a[180:183]
    buffer_load_dwordx4 v13, s[20:23], s30 offen offset:2048 lds
    s_add_u32 s30, s30, 12288
    v_mfma_f32_16x16x32_bf16 a[176:179], v[144:147], a[244:247], a[176:179]
    s_cmp_lg_u32 s54, s59
    v_mfma_f32_16x16x32_bf16 a[176:179], v[128:131], a[240:243], a[176:179]
    s_waitcnt lgkmcnt(0)
    s_cbranch_scc1 K1_LOOP
    s_cmp_eq_u32 s54, 1
    s_cbranch_scc0 K1_REPORT
    global_load_dwordx2 v[22:23], v25, s[64:65] sc1
    s_branch K1_LOOP
K1_REPORT:
    s_mov_b32 s59, 1
    s_memrealtime s[34:35]
    s_and_b32 s33, s2, 7
    s_lshl_b32 s33, s33, 3
    v_mov_b32 v15, 0x01000000
    v_mov_b32 v16, s33
    s_waitcnt lgkmcnt(0)
    s_sub_u32 s35, s34, s3
    s_mul_i32 s35, s35, 6
    s_lshr_b32 s35, s35, 4
    s_add_u32 s34, s34, s35
    v_mov_b32 v14, s34
    s_mov_b64 exec, 1
    global_atomic_add_x2 v16, v[14:15], s[64:65] sc1
    s_mov_b64 exec, -1
    s_branch K1_LOOP
K1_TAIL:
    ds_read_b64_tr_b16 a[192:193], v4 offset:24576
    ds_read_b64_tr_b16 a[194:195], v4 offset:30720
    ds_read_b64_tr_b16 a[196:197], v4 offset:36864
    ds_read_b64_tr_b16 a[198:199], v4 offset:43008
    ds_read_b64_tr_b16 a[200:201], v5 offset:24576
    ds_read_b64_tr_b16 a[202:203], v5 offset:30720
    ds_read_b64_tr_b16 a[204:205], v5 offset:36864
    ds_read_b64_tr_b16 a[206:207], v5 offset:43008
    ds_read_b64_tr_b16 a[208:209], v6 offset:24576
    ds_read_b64_tr_b16 a[210:211], v6 offset:30720
    ds_read_b64_tr_b16 a[212:213], v6 offset:36864
    ds_read_b64_tr_b16 a[214:215], v6 offset:43008
    s_waitcnt vmcnt(0)
    s_barrier
    s_bfe_u32 s33, s2, 0x20001
    s_mul_i32 s40, s33, 12
    s_add_u32 s40, s40, 192
    s_mul_i32 s43, s33, 48
    s_lshl_b32 s41, s28, 12
    s_mul_i32 s42, s28, 5120
    s_add_u32 s42, s42, 16384
    s_mov_b32 s33, 65536
K2_PP:
    v_cmp_le_u32 vcc, 0x20000000, v23
    s_cmp_eq_u64 vcc, exec
    s_cbranch_scc1 K2_PP_OK
    s_sleep 1
    global_load_dwordx2 v[22:23], v25, s[64:65] sc1
    s_waitcnt vmcnt(0)
    s_sub_u32 s33, s33, 1
    s_cmp_lg_u32 s33, 0
    s_cbranch_scc1 K2_PP
K2_PP_OK:
    s_add_u32 s36, s40, 0
    s_mov_b32 s39, 0
    s_lshl_b32 s37, s36, 10
    s_add_u32 m0, s39, s41
    s_nop 0
    buffer_load_dwordx4 v26, s[12:15], s37 offen offset:0 sc1 lds
    v_exp_f32 v152, v152
    v_exp_f32 v153, v153
    v_exp_f32 v154, v154
    v_exp_f32 v155, v155
    v_exp_f32 v72, v72
    v_exp_f32 v73, v73
    buffer_load_dwordx4 v26, s[12:15], s37 offen offset:1024 sc1 lds
    v_exp_f32 v74, v74
    v_exp_f32 v75, v75
    v_exp_f32 v156, v156
    v_exp_f32 v157, v157
    v_exp_f32 v158, v158
    v_exp_f32 v159, v159
    buffer_load_dwordx4 v27, s[12:15], s37 offen offset:2048 sc1 lds
    v_exp_f32 v76, v76
    v_exp_f32 v77, v77
    v_exp_f32 v78, v78
    v_exp_f32 v79, v79
    s_waitcnt lgkmcnt(8)
    v_mfma_f32_16x16x32_bf16 a[0:3], v[128:131], a[192:195], a[0:3]
    ds_read_b64_tr_b16 a[216:217], v7 offset:24576
    v_add_f32 v44, v44, v152
    v_mfma_f32_16x16x32_bf16 a[0:3], v[144:147], a[196:199], a[0:3]
    ds_read_b64_tr_b16 a[218:219], v7 offset:30720
    v_add_f32 v45, v45, v153
    v_mfma_f32_16x16x32_bf16 a[4:7], v[148:151], a[196:199], a[4:7]
    ds_read_b64_tr_b16 a[220:221], v7 offset:36864
    v_cvt_pk_bf16_f32 v152, v152, v153
    v_mfma_f32_16x16x32_bf16 a[4:7], v[132:135], a[192:195], a[4:7]
    buffer_load_dwordx4 v27, s[12:15], s37 offen offset:3072 sc1 lds
    s_mul_i32 s38, s36, 40960
    s_add_u32 m0, s39, s42
    v_add_f32 v44, v44, v154
    s_waitcnt lgkmcnt(7)
    v_mfma_f32_16x16x32_bf16 a[20:23], v[132:135], a[200:203], a[20:23]
    ds_read_b64_tr_b16 a[222:223], v7 offset:43008
    v_add_f32 v45, v45, v155
    v_mfma_f32_16x16x32_bf16 a[20:23], v[148:151], a[204:207], a[20:23]
    ds_read_b64_tr_b16 a[224:225], v4 offset:24704
    v_cvt_pk_bf16_f32 v153, v154, v155
    v_mfma_f32_16x16x32_bf16 a[16:19], v[144:147], a[204:207], a[16:19]
    ds_read_b64_tr_b16 a[226:227], v4 offset:30848
    v_add_f32 v44, v44, v72
    v_mfma_f32_16x16x32_bf16 a[16:19], v[128:131], a[200:203], a[16:19]
    buffer_load_dwordx4 v28, s[8:11], s38 offen offset:0 sc1 lds
    v_add_f32 v45, v45, v73
    s_waitcnt lgkmcnt(6)
    v_mfma_f32_16x16x32_bf16 a[32:35], v[128:131], a[208:211], a[32:35]
    ds_read_b64_tr_b16 a[228:229], v4 offset:36992
    v_cvt_pk_bf16_f32 v154, v72, v73
    v_mfma_f32_16x16x32_bf16 a[32:35], v[144:147], a[212:215], a[32:35]
    ds_read_b64_tr_b16 a[230:231], v4 offset:43136
    v_add_f32 v44, v44, v74
    v_mfma_f32_16x16x32_bf16 a[36:39], v[148:151], a[212:215], a[36:39]
    ds_read_b64_tr_b16 a[232:233], v5 offset:24704
    v_add_f32 v45, v45, v75
    v_mfma_f32_16x16x32_bf16 a[36:39], v[132:135], a[208:211], a[36:39]
    buffer_load_dwordx4 v28, s[8:11], s38 offen offset:1024 sc1 lds
    v_cvt_pk_bf16_f32 v155, v74, v75
    s_waitcnt lgkmcnt(5)
    v_mfma_f32_16x16x32_bf16 a[52:55], v[132:135], a[216:219], a[52:55]
    ds_read_b64_tr_b16 a[234:235], v5 offset:30848
    v_add_f32 v46, v46, v156
    v_mfma_f32_16x16x32_bf16 a[52:55], v[148:151], a[220:223], a[52:55]
    ds_read_b64_tr_b16 a[236:237], v5 offset:36992
    v_add_f32 v47, v47, v157
    v_mfma_f32_16x16x32_bf16 a[48:51], v[144:147], a[220:223], a[48:51]
    ds_read_b64_tr_b16 a[238:239], v5 offset:43136
    v_cvt_pk_bf16_f32 v156, v156, v157
    v_mfma_f32_16x16x32_bf16 a[48:51], v[128:131], a[216:219], a[48:51]
    buffer_load_dwordx4 v28, s[8:11], s38 offen offset:2048 sc1 lds
    v_add_f32 v46, v46, v158
    s_waitcnt lgkmcnt(4)
    v_mfma_f32_16x16x32_bf16 a[64:67], v[128:131], a[224:227], a[64:67]
    ds_read_b64_tr_b16 a[240:241], v6 offset:24704
    v_add_f32 v47, v47, v159
    v_mfma_f32_16x16x32_bf16 a[64:67], v[144:147], a[228:231], a[64:67]
    ds_read_b64_tr_b16 a[242:243], v6 offset:30848
    v_cvt_pk_bf16_f32 v157, v158, v159
    v_mfma_f32_16x16x32_bf16 a[68:71], v[148:151], a[228:231], a[68:71]
    ds_read_b64_tr_b16 a[244:245], v6 offset:36992
    v_add_f32 v46, v46, v76
    v_mfma_f32_16x16x32_bf16 a[68:71], v[132:135], a[224:227], a[68:71]
    buffer_load_dwordx4 v28, s[8:11], s38 offen offset:3072 sc1 lds
    s_add_u32 m0, m0, 4096
    v_add_f32 v47, v47, v77
    s_waitcnt lgkmcnt(3)
    v_mfma_f32_16x16x32_bf16 a[84:87], v[132:135], a[232:235], a[84:87]
    ds_read_b64_tr_b16 a[246:247], v6 offset:43136
    v_cvt_pk_bf16_f32 v158, v76, v77
    v_mfma_f32_16x16x32_bf16 a[84:87], v[148:151], a[236:239], a[84:87]
    ds_read_b64_tr_b16 a[248:249], v7 offset:24704
    v_add_f32 v46, v46, v78
    v_mfma_f32_16x16x32_bf16 a[80:83], v[144:147], a[236:239], a[80:83]
    ds_read_b64_tr_b16 a[250:251], v7 offset:30848
    v_add_f32 v47, v47, v79
    v_mfma_f32_16x16x32_bf16 a[80:83], v[128:131], a[232:235], a[80:83]
    buffer_load_dwordx4 v29, s[8:11], s38 offen sc1 lds
    s_add_u32 s36, s40, 2
    s_mov_b32 s39, 36864
    s_lshl_b32 s37, s36, 10
    s_add_u32 m0, s39, s41
    v_cvt_pk_bf16_f32 v159, v78, v79
    s_nop 1
    v_mfma_f32_16x16x32_bf16 a[8:11], v[136:139], a[192:195], a[8:11]
    ds_read_b64_tr_b16 a[252:253], v7 offset:36992
    v_add_f32 v30, v40, v41
    v_mfma_f32_16x16x32_bf16 a[8:11], v[152:155], a[196:199], a[8:11]
    ds_read_b64_tr_b16 a[254:255], v7 offset:43136
    v_add_f32 v31, v42, v43
    v_mfma_f32_16x16x32_bf16 a[12:15], v[156:159], a[196:199], a[12:15]
    v_add_f32 v32, v44, v45
    v_add_f32 v33, v46, v47
    v_mfma_f32_16x16x32_bf16 a[12:15], v[140:143], a[192:195], a[12:15]
    buffer_load_dwordx4 v26, s[12:15], s37 offen offset:0 sc1 lds
    v_mov_b32 v14, 1.0
    v_mfma_f32_16x16x32_bf16 a[28:31], v[140:143], a[200:203], a[28:31]
    ds_read_b64_tr_b16 a[192:193], v4 offset:24832
    v_bfe_u32 v16, v0, 2, 2
    v_mfma_f32_16x16x32_bf16 a[28:31], v[156:159], a[204:207], a[28:31]
    ds_read_b64_tr_b16 a[194:195], v4 offset:30976
    v_lshrrev_b32 v15, 4, v0
    v_mfma_f32_16x16x32_bf16 a[24:27], v[152:155], a[204:207], a[24:27]
    ds_read_b64_tr_b16 a[196:197], v4 offset:37120
    v_mfma_f32_16x16x4_f32 v[80:83], v30, v14, 0
    v_mfma_f32_16x16x32_bf16 a[24:27], v[136:139], a[200:203], a[24:27]
    buffer_load_dwordx4 v26, s[12:15], s37 offen offset:1024 sc1 lds
    v_mfma_f32_16x16x4_f32 v[84:87], v31, v14, 0
    v_mfma_f32_16x16x32_bf16 a[40:43], v[136:139], a[208:211], a[40:43]
    ds_read_b64_tr_b16 a[198:199], v4 offset:43264
    v_mfma_f32_16x16x4_f32 v[88:91], v32, v14, 0
    v_mfma_f32_16x16x32_bf16 a[40:43], v[152:155], a[212:215], a[40:43]
    ds_read_b64_tr_b16 a[200:201], v5 offset:24832
    v_mfma_f32_16x16x4_f32 v[92:95], v33, v14, 0
    v_mfma_f32_16x16x32_bf16 a[44:47], v[156:159], a[212:215], a[44:47]
    ds_read_b64_tr_b16 a[202:203], v5 offset:30976
    v_cmp_eq_u32 vcc, v16, v15
    v_mfma_f32_16x16x32_bf16 a[44:47], v[140:143], a[208:211], a[44:47]
    buffer_load_dwordx4 v27, s[12:15], s37 offen offset:2048 sc1 lds
    v_and_b32 v16, 1, v0
    v_mfma_f32_16x16x32_bf16 a[60:63], v[140:143], a[216:219], a[60:63]
    ds_read_b64_tr_b16 a[204:205], v5 offset:37120
    v_lshlrev_b32 v16, 4, v16
    v_mfma_f32_16x16x32_bf16 a[60:63], v[156:159], a[220:223], a[60:63]
    ds_read_b64_tr_b16 a[206:207], v5 offset:43264
    v_mov_b32 v15, 0x3f80
    v_mfma_f32_16x16x32_bf16 a[56:59], v[152:155], a[220:223], a[56:59]
    ds_read_b64_tr_b16 a[208:209], v6 offset:24832
    v_lshlrev_b32 v15, v16, v15
    v_mfma_f32_16x16x32_bf16 a[56:59], v[136:139], a[216:219], a[56:59]
    buffer_load_dwordx4 v27, s[12:15], s37 offen offset:3072 sc1 lds
    s_mul_i32 s38, s36, 40960
    s_add_u32 m0, s39, s42
    v_cndmask_b32 v15, 0, v15, vcc
    v_mfma_f32_16x16x32_bf16 a[72:75], v[136:139], a[224:227], a[72:75]
    ds_read_b64_tr_b16 a[210:211], v6 offset:30976
    v_and_b32 v16, 2, v0
    v_mfma_f32_16x16x32_bf16 a[72:75], v[152:155], a[228:231], a[72:75]
    ds_read_b64_tr_b16 a[212:213], v6 offset:37120
    v_cmp_eq_u32 vcc, 0, v16
    v_mfma_f32_16x16x32_bf16 a[76:79], v[156:159], a[228:231], a[76:79]
    ds_read_b64_tr_b16 a[214:215], v6 offset:43264
    v_mov_b32 v104, 0
    v_mfma_f32_16x16x32_bf16 a[76:79], v[140:143], a[224:227], a[76:79]
    buffer_load_dwordx4 v28, s[8:11], s38 offen offset:0 sc1 lds
    v_mov_b32 v105, 0
    v_mfma_f32_16x16x32_bf16 a[92:95], v[140:143], a[232:235], a[92:95]
    ds_read_b64_tr_b16 a[216:217], v7 offset:24832
    v_mov_b32 v108, 0
    v_mfma_f32_16x16x32_bf16 a[92:95], v[156:159], a[236:239], a[92:95]
    ds_read_b64_tr_b16 a[218:219], v7 offset:30976
    v_mov_b32 v109, 0
    v_mfma_f32_16x16x32_bf16 a[88:91], v[152:155], a[236:239], a[88:91]
    ds_read_b64_tr_b16 a[220:221], v7 offset:37120
    v_cndmask_b32 v106, 0, v15, vcc
    v_mfma_f32_16x16x32_bf16 a[88:91], v[136:139], a[232:235], a[88:91]
    buffer_load_dwordx4 v28, s[8:11], s38 offen offset:1024 sc1 lds
    v_cndmask_b32 v107, v15, v104, vcc
    s_waitcnt lgkmcnt(15)
    v_mfma_f32_16x16x32_bf16 a[96:99], v[128:131], a[240:243], a[96:99]
    ds_read_b64_tr_b16 a[222:223], v7 offset:43264
    v_add_f32 v14, v80, v81
    v_mfma_f32_16x16x32_bf16 a[96:99], v[144:147], a[244:247], a[96:99]
    v_add_f32 v15, v82, v83
    v_add_f32 v14, v14, v84
    v_mfma_f32_16x16x32_bf16 a[100:103], v[148:151], a[244:247], a[100:103]
    v_add_f32 v15, v15, v85
    v_add_f32 v14, v14, v86
    v_mfma_f32_16x16x32_bf16 a[100:103], v[132:135], a[240:243], a[100:103]
    buffer_load_dwordx4 v28, s[8:11], s38 offen offset:2048 sc1 lds
    v_add_f32 v15, v15, v87
    v_mfma_f32_16x16x32_bf16 a[104:107], v[136:139], a[240:243], a[104:107]
    v_add_f32 v14, v14, v88
    v_add_f32 v15, v15, v89
    v_mfma_f32_16x16x32_bf16 a[104:107], v[152:155], a[244:247], a[104:107]
    v_add_f32 v14, v14, v90
    v_add_f32 v15, v15, v91
    v_mfma_f32_16x16x32_bf16 a[108:111], v[156:159], a[244:247], a[108:111]
    v_add_f32 v14, v14, v92
    v_add_f32 v15, v15, v93
    v_mfma_f32_16x16x32_bf16 a[108:111], v[140:143], a[240:243], a[108:111]
    buffer_load_dwordx4 v28, s[8:11], s38 offen offset:3072 sc1 lds
    s_add_u32 m0, m0, 4096
    v_add_f32 v14, v14, v94
    s_waitcnt lgkmcnt(15)
    v_mfma_f32_16x16x32_bf16 a[124:127], v[140:143], a[248:251], a[124:127]
    v_add_f32 v15, v15, v95
    v_add_f32 v14, v14, v15
    v_mfma_f32_16x16x32_bf16 a[124:127], v[156:159], a[252:255], a[124:127]
    s_lshl_b32 s35, s28, 2
    s_add_u32 s35, s35, 148608
    v_cmp_ngt_f32 vcc, 0x5d800000, v14
    v_mfma_f32_16x16x32_bf16 a[120:123], v[152:155], a[252:255], a[120:123]
    v_mov_b32 v15, s35
    s_cmp_lg_u64 vcc, 0
    s_cselect_b32 s34, 1, 0
    v_mfma_f32_16x16x32_bf16 a[120:123], v[136:139], a[248:251], a[120:123]
    buffer_load_dwordx4 v29, s[8:11], s38 offen sc1 lds
    s_add_u32 s36, s40, 4
    s_mov_b32 s39, 73728
    s_lshl_b32 s37, s36, 10
    s_add_u32 m0, s39, s41
    v_mov_b32 v14, s34
    v_mfma_f32_16x16x32_bf16 a[116:119], v[132:135], a[248:251], a[116:119]
    ds_write_b32 v15, v14
    v_mov_b32 v16, 148608
    v_mfma_f32_16x16x32_bf16 a[116:119], v[148:151], a[252:255], a[116:119]
    v_mfma_f32_16x16x32_bf16 a[112:115], v[144:147], a[252:255], a[112:115]
    v_mfma_f32_16x16x32_bf16 a[112:115], v[128:131], a[248:251], a[112:115]
    buffer_load_dwordx4 v26, s[12:15], s37 offen offset:0 sc1 lds
    s_waitcnt lgkmcnt(13)
    v_mfma_f32_16x16x32_bf16 a[128:131], v[128:131], a[192:195], a[128:131]
    v_mfma_f32_16x16x32_bf16 a[128:131], v[144:147], a[196:199], a[128:131]
    v_mfma_f32_16x16x32_bf16 a[132:135], v[148:151], a[196:199], a[132:135]
    v_mfma_f32_16x16x32_bf16 a[132:135], v[132:135], a[192:195], a[132:135]
    buffer_load_dwordx4 v26, s[12:15], s37 offen offset:1024 sc1 lds
    v_mfma_f32_16x16x32_bf16 a[136:139], v[136:139], a[192:195], a[136:139]
    v_mfma_f32_16x16x32_bf16 a[136:139], v[152:155], a[196:199], a[136:139]
    v_mfma_f32_16x16x32_bf16 a[140:143], v[156:159], a[196:199], a[140:143]
    v_mfma_f32_16x16x32_bf16 a[140:143], v[140:143], a[192:195], a[140:143]
    buffer_load_dwordx4 v27, s[12:15], s37 offen offset:2048 sc1 lds
    s_waitcnt lgkmcnt(9)
    v_mfma_f32_16x16x32_bf16 a[156:159], v[140:143], a[200:203], a[156:159]
    v_mfma_f32_16x16x32_bf16 a[156:159], v[156:159], a[204:207], a[156:159]
    v_mfma_f32_16x16x32_bf16 a[152:155], v[152:155], a[204:207], a[152:155]
    v_mfma_f32_16x16x32_bf16 a[152:155], v[136:139], a[200:203], a[152:155]
    buffer_load_dwordx4 v27, s[12:15], s37 offen offset:3072 sc1 lds
    s_mul_i32 s38, s36, 40960
    s_add_u32 m0, s39, s42
    s_waitcnt lgkmcnt(0)
    s_barrier
    v_mfma_f32_16x16x32_bf16 a[148:151], v[132:135], a[200:203], a[148:151]
    ds_read_b128 v[40:43], v16
    v_mfma_f32_16x16x32_bf16 a[148:151], v[148:151], a[204:207], a[148:151]
    v_rcp_f32 v80, v80
    v_mfma_f32_16x16x32_bf16 a[144:147], v[144:147], a[204:207], a[144:147]
    v_rcp_f32 v81, v81
    v_mfma_f32_16x16x32_bf16 a[144:147], v[128:131], a[200:203], a[144:147]
    buffer_load_dwordx4 v28, s[8:11], s38 offen offset:0 sc1 lds
    v_rcp_f32 v82, v82
    v_mfma_f32_16x16x32_bf16 a[160:163], v[128:131], a[208:211], a[160:163]
    v_rcp_f32 v83, v83
    v_mfma_f32_16x16x32_bf16 a[160:163], v[144:147], a[212:215], a[160:163]
    v_rcp_f32 v84, v84
    v_mfma_f32_16x16x32_bf16 a[164:167], v[148:151], a[212:215], a[164:167]
    v_rcp_f32 v85, v85
    v_mfma_f32_16x16x32_bf16 a[164:167], v[132:135], a[208:211], a[164:167]
    buffer_load_dwordx4 v28, s[8:11], s38 offen offset:1024 sc1 lds
    v_rcp_f32 v86, v86
    v_mfma_f32_16x16x32_bf16 a[168:171], v[136:139], a[208:211], a[168:171]
    v_rcp_f32 v87, v87
    v_mfma_f32_16x16x32_bf16 a[168:171], v[152:155], a[212:215], a[168:171]
    v_rcp_f32 v88, v88
    v_mfma_f32_16x16x32_bf16 a[172:175], v[156:159], a[212:215], a[172:175]
    v_rcp_f32 v89, v89
    v_mfma_f32_16x16x32_bf16 a[172:175], v[140:143], a[208:211], a[172:175]
    buffer_load_dwordx4 v28, s[8:11], s38 offen offset:2048 sc1 lds
    s_waitcnt lgkmcnt(0)
    v_or_b32 v40, v40, v41
    v_mfma_f32_16x16x32_bf16 a[188:191], v[140:143], a[216:219], a[188:191]
    v_or3_b32 v40, v40, v42, v43
    v_lshlrev_b32 v16, 4, v0
    v_mfma_f32_16x16x32_bf16 a[188:191], v[156:159], a[220:223], a[188:191]
    v_readfirstlane_b32 s34, v40
    v_lshlrev_b32 v17, 3, v0
    v_mfma_f32_16x16x32_bf16 a[184:187], v[152:155], a[220:223], a[184:187]
    v_rcp_f32 v90, v90
    v_mfma_f32_16x16x32_bf16 a[184:187], v[136:139], a[216:219], a[184:187]
    buffer_load_dwordx4 v28, s[8:11], s38 offen offset:3072 sc1 lds
    s_add_u32 m0, m0, 4096
    v_rcp_f32 v91, v91
    v_mfma_f32_16x16x32_bf16 a[180:183], v[132:135], a[216:219], a[180:183]
    v_rcp_f32 v92, v92
    v_mfma_f32_16x16x32_bf16 a[180:183], v[148:151], a[220:223], a[180:183]
    v_rcp_f32 v93, v93
    v_mfma_f32_16x16x32_bf16 a[176:179], v[144:147], a[220:223], a[176:179]
    v_rcp_f32 v94, v94
    v_mfma_f32_16x16x32_bf16 a[176:179], v[128:131], a[216:219], a[176:179]
    buffer_load_dwordx4 v29, s[8:11], s38 offen sc1 lds
    v_rcp_f32 v95, v95
    s_andn2_b32 s34, s34, s55
    s_cbranch_scc0 K1_EPI
    s_mov_b32 s55, 1
    v_and_b32 v34, 15, v0
    v_mul_u32_u24 v34, 384, v34
    v_lshrrev_b32 v35, 4, v0
    v_lshl_add_u32 v34, v35, 4, v34
    v_mov_b32 v30, 0xff800000
    v_mov_b32 v31, 0xff800000
    v_mov_b32 v32, 0xff800000
    v_mov_b32 v33, 0xff800000
    s_mov_b32 s34, 0
K1_MAXLOOP:
    buffer_load_dwordx4 a[192:195], v34, s[16:19], s34 offen offset:0
    buffer_load_dwordx4 a[196:199], v34, s[16:19], s34 offen offset:64
    buffer_load_dwordx4 a[200:203], v34, s[16:19], s34 offen offset:128
    buffer_load_dwordx4 a[204:207], v34, s[16:19], s34 offen offset:192
    buffer_load_dwordx4 a[208:211], v34, s[16:19], s34 offen offset:256
    buffer_load_dwordx4 a[212:215], v34, s[16:19], s34 offen offset:320
    s_waitcnt vmcnt(0)
    v_mfma_f32_16x16x32_bf16 v[96:99], a[192:195], v[160:163], 0
    v_mfma_f32_16x16x32_bf16 v[96:99], a[196:199], v[176:179], v[96:99]
    v_mfma_f32_16x16x32_bf16 v[96:99], a[200:203], v[192:195], v[96:99]
    v_mfma_f32_16x16x32_bf16 v[96:99], a[204:207], v[208:211], v[96:99]
    v_mfma_f32_16x16x32_bf16 v[96:99], a[208:211], v[224:227], v[96:99]
    v_mfma_f32_16x16x32_bf16 v[96:99], a[212:215], v[240:243], v[96:99]
    v_mfma_f32_16x16x32_bf16 v[100:103], a[192:195], v[164:167], 0
    v_mfma_f32_16x16x32_bf16 v[100:103], a[196:199], v[180:183], v[100:103]
    v_mfma_f32_16x16x32_bf16 v[100:103], a[200:203], v[196:199], v[100:103]
    v_mfma_f32_16x16x32_bf16 v[100:103], a[204:207], v[212:215], v[100:103]
    v_mfma_f32_16x16x32_bf16 v[100:103], a[208:211], v[228:231], v[100:103]
    v_mfma_f32_16x16x32_bf16 v[100:103], a[212:215], v[244:247], v[100:103]
    v_mfma_f32_16x16x32_bf16 v[104:107], a[192:195], v[168:171], 0
    v_mfma_f32_16x16x32_bf16 v[104:107], a[196:199], v[184:187], v[104:107]
    v_mfma_f32_16x16x32_bf16 v[104:107], a[200:203], v[200:203], v[104:107]
    v_mfma_f32_16x16x32_bf16 v[104:107], a[204:207], v[216:219], v[104:107]
    v_mfma_f32_16x16x32_bf16 v[104:107], a[208:211], v[232:235], v[104:107]
    v_mfma_f32_16x16x32_bf16 v[104:107], a[212:215], v[248:251], v[104:107]
    v_mfma_f32_16x16x32_bf16 v[108:111], a[192:195], v[172:175], 0
    v_mfma_f32_16x16x32_bf16 v[108:111], a[196:199], v[188:191], v[108:111]
    v_mfma_f32_16x16x32_bf16 v[108:111], a[200:203], v[204:207], v[108:111]
    v_mfma_f32_16x16x32_bf16 v[108:111], a[204:207], v[220:223], v[108:111]
    v_mfma_f32_16x16x32_bf16 v[108:111], a[208:211], v[236:239], v[108:111]
    v_mfma_f32_16x16x32_bf16 v[108:111], a[212:215], v[252:255], v[108:111]
    s_nop 15
    v_max3_f32 v30, v30, v96, v97
    v_max3_f32 v30, v30, v98, v99
    v_max3_f32 v31, v31, v100, v101
    v_max3_f32 v31, v31, v102, v103
    v_max3_f32 v32, v32, v104, v105
    v_max3_f32 v32, v32, v106, v107
    v_max3_f32 v33, v33, v108, v109
    v_max3_f32 v33, v33, v110, v111
    s_add_u32 s34, s34, 6144
    s_cmp_lt_u32 s34, 786432
    s_cbranch_scc1 K1_MAXLOOP
    v_mov_b32 v34, v30
    v_mov_b32 v35, v31
    v_mov_b32 v36, v32
    v_mov_b32 v37, v33
    s_nop 1
    v_permlane32_swap_b32 v34, v30
    v_permlane32_swap_b32 v35, v31
    v_permlane32_swap_b32 v36, v32
    v_permlane32_swap_b32 v37, v33
    s_nop 1
    v_max_f32 v30, v30, v34
    v_max_f32 v31, v31, v35
    v_max_f32 v32, v32, v36
    v_max_f32 v33, v33, v37
    v_mov_b32 v34, v30
    v_mov_b32 v35, v31
    v_mov_b32 v36, v32
    v_mov_b32 v37, v33
    s_nop 1
    v_permlane16_swap_b32 v34, v30
    v_permlane16_swap_b32 v35, v31
    v_permlane16_swap_b32 v36, v32
    v_permlane16_swap_b32 v37, v33
    s_nop 1
    v_max_f32 v30, v30, v34
    v_max_f32 v31, v31, v35
    v_max_f32 v32, v32, v36
    v_max_f32 v33, v33, v37
    v_sub_f32 v80, 0, v30
    v_sub_f32 v81, 0, v30
    v_sub_f32 v82, 0, v30
    v_sub_f32 v83, 0, v30
    v_sub_f32 v84, 0, v31
    v_sub_f32 v85, 0, v31
    v_sub_f32 v86, 0, v31
    v_sub_f32 v87, 0, v31
    v_sub_f32 v88, 0, v32
    v_sub_f32 v89, 0, v32
    v_sub_f32 v90, 0, v32
    v_sub_f32 v91, 0, v32
    v_sub_f32 v92, 0, v33
    v_sub_f32 v93, 0, v33
    v_sub_f32 v94, 0, v33
    v_sub_f32 v95, 0, v33
    s_mov_b32 s40, s52
    s_mov_b32 s41, s53
    s_mov_b32 s42, 0
    s_mov_b32 s43, 0x00020000
    s_mov_b32 s39, 0
    s_mov_b32 s46, 0
    s_mov_b32 s50, 0
    v_mov_b32 v35, 0
    s_barrier
    s_add_u32 m0, s29, 36864
    v_subrev_u32 v60, 12288, v8
    v_subrev_u32 v61, 12288, v9
    v_subrev_u32 v62, 12288, v10
    buffer_load_dwordx4 v60, s[16:19], 0 offen offset:0 lds
    buffer_load_dwordx4 v61, s[16:19], 0 offen offset:1024 lds
    buffer_load_dwordx4 v62, s[16:19], 0 offen offset:2048 lds
    s_add_u32 m0, s29, 49152
    s_mov_b32 s30, 0
    buffer_load_dwordx4 v8, s[16:19], s30 offen offset:0 lds
    buffer_load_dwordx4 v9, s[16:19], s30 offen offset:1024 lds
    buffer_load_dwordx4 v10, s[16:19], s30 offen offset:2048 lds
    s_add_u32 m0, s29, 86016
    s_mov_b32 s30, 0
    buffer_load_dwordx4 v11, s[20:23], s30 offen offset:0 lds
    buffer_load_dwordx4 v12, s[20:23], s30 offen offset:1024 lds
    buffer_load_dwordx4 v13, s[20:23], s30 offen offset:2048 lds
    s_add_u32 m0, s29, 61440
    s_mov_b32 s30, 12288
    buffer_load_dwordx4 v8, s[16:19], s30 offen offset:0 lds
    buffer_load_dwordx4 v9, s[16:19], s30 offen offset:1024 lds
    buffer_load_dwordx4 v10, s[16:19], s30 offen offset:2048 lds
    s_add_u32 m0, s29, 98304
    s_mov_b32 s30, 12288
    buffer_load_dwordx4 v11, s[20:23], s30 offen offset:0 lds
    buffer_load_dwordx4 v12, s[20:23], s30 offen offset:1024 lds
    buffer_load_dwordx4 v13, s[20:23], s30 offen offset:2048 lds
    s_add_u32 m0, s29, 73728
    s_mov_b32 s30, 24576
    buffer_load_dwordx4 v8, s[16:19], s30 offen offset:0 lds
    buffer_load_dwordx4 v9, s[16:19], s30 offen offset:1024 lds
    buffer_load_dwordx4 v10, s[16:19], s30 offen offset:2048 lds
    s_mov_b32 s30, 36864
    v_mov_b32 v40, 0
    v_mov_b32 v41, 0
    v_mov_b32 v42, 0
    v_mov_b32 v43, 0
    v_mov_b32 v44, 0
    v_mov_b32 v45, 0
    v_mov_b32 v46, 0
    v_mov_b32 v47, 0
    s_waitcnt vmcnt(0)
    s_barrier
    ds_read_b128 a[192:195], v2 offset:0
    ds_read_b128 a[196:199], v3 offset:0
    ds_read_b128 a[200:203], v2 offset:128
    ds_read_b128 a[204:207], v3 offset:128
    ds_read_b128 a[208:211], v2 offset:256
    ds_read_b128 a[212:215], v3 offset:256
    ds_read_b128 a[216:219], v2 offset:6144
    ds_read_b128 a[220:223], v3 offset:6144
    ds_read_b128 a[224:227], v2 offset:6272
    ds_read_b128 a[228:231], v3 offset:6272
    ds_read_b128 a[232:235], v2 offset:6400
    ds_read_b128 a[236:239], v3 offset:6400
    s_waitcnt lgkmcnt(0)
    v_mfma_f32_16x16x32_bf16 v[96:99], a[192:195], v[160:163], v[80:83]
    v_mfma_f32_16x16x32_bf16 v[96:99], a[196:199], v[176:179], v[96:99]
    v_mfma_f32_16x16x32_bf16 v[96:99], a[200:203], v[192:195], v[96:99]
    v_mfma_f32_16x16x32_bf16 v[96:99], a[204:207], v[208:211], v[96:99]
    v_mfma_f32_16x16x32_bf16 v[96:99], a[208:211], v[224:227], v[96:99]
    v_mfma_f32_16x16x32_bf16 v[96:99], a[212:215], v[240:243], v[96:99]
    v_mfma_f32_16x16x32_bf16 v[100:103], a[212:215], v[244:247], v[84:87]
    v_mfma_f32_16x16x32_bf16 v[100:103], a[208:211], v[228:231], v[100:103]
    v_mfma_f32_16x16x32_bf16 v[100:103], a[204:207], v[212:215], v[100:103]
    v_mfma_f32_16x16x32_bf16 v[100:103], a[200:203], v[196:199], v[100:103]
    v_mfma_f32_16x16x32_bf16 v[100:103], a[196:199], v[180:183], v[100:103]
    v_mfma_f32_16x16x32_bf16 v[100:103], a[192:195], v[164:167], v[100:103]
    v_mfma_f32_16x16x32_bf16 v[104:107], a[192:195], v[168:171], v[88:91]
    v_mfma_f32_16x16x32_bf16 v[104:107], a[196:199], v[184:187], v[104:107]
    v_mfma_f32_16x16x32_bf16 v[104:107], a[200:203], v[200:203], v[104:107]
    v_mfma_f32_16x16x32_bf16 v[104:107], a[204:207], v[216:219], v[104:107]
    v_mfma_f32_16x16x32_bf16 v[104:107], a[208:211], v[232:235], v[104:107]
    v_mfma_f32_16x16x32_bf16 v[104:107], a[212:215], v[248:251], v[104:107]
    v_mfma_f32_16x16x32_bf16 v[108:111], a[212:215], v[252:255], v[92:95]
    v_mfma_f32_16x16x32_bf16 v[108:111], a[208:211], v[236:239], v[108:111]
    v_mfma_f32_16x16x32_bf16 v[108:111], a[204:207], v[220:223], v[108:111]
    v_mfma_f32_16x16x32_bf16 v[108:111], a[200:203], v[204:207], v[108:111]
    v_mfma_f32_16x16x32_bf16 v[108:111], a[196:199], v[188:191], v[108:111]
    v_mfma_f32_16x16x32_bf16 v[108:111], a[192:195], v[172:175], v[108:111]
    v_mfma_f32_16x16x32_bf16 v[48:51], a[216:219], v[160:163], v[80:83]
    v_mfma_f32_16x16x32_bf16 v[48:51], a[220:223], v[176:179], v[48:51]
    v_mfma_f32_16x16x32_bf16 v[48:51], a[224:227], v[192:195], v[48:51]
    v_mfma_f32_16x16x32_bf16 v[48:51], a[228:231], v[208:211], v[48:51]
    v_mfma_f32_16x16x32_bf16 v[48:51], a[232:235], v[224:227], v[48:51]
    v_mfma_f32_16x16x32_bf16 v[48:51], a[236:239], v[240:243], v[48:51]
    v_mfma_f32_16x16x32_bf16 v[52:55], a[236:239], v[244:247], v[84:87]
    v_mfma_f32_16x16x32_bf16 v[52:55], a[232:235], v[228:231], v[52:55]
    v_mfma_f32_16x16x32_bf16 v[52:55], a[228:231], v[212:215], v[52:55]
    v_mfma_f32_16x16x32_bf16 v[52:55], a[224:227], v[196:199], v[52:55]
    v_mfma_f32_16x16x32_bf16 v[52:55], a[220:223], v[180:183], v[52:55]
    v_mfma_f32_16x16x32_bf16 v[52:55], a[216:219], v[164:167], v[52:55]
    v_mfma_f32_16x16x32_bf16 v[56:59], a[216:219], v[168:171], v[88:91]
    v_mfma_f32_16x16x32_bf16 v[56:59], a[220:223], v[184:187], v[56:59]
    v_mfma_f32_16x16x32_bf16 v[56:59], a[224:227], v[200:203], v[56:59]
    v_mfma_f32_16x16x32_bf16 v[56:59], a[228:231], v[216:219], v[56:59]
    v_mfma_f32_16x16x32_bf16 v[56:59], a[232:235], v[232:235], v[56:59]
    v_mfma_f32_16x16x32_bf16 v[56:59], a[236:239], v[248:251], v[56:59]
    v_mfma_f32_16x16x32_bf16 v[60:63], a[236:239], v[252:255], v[92:95]
    v_mfma_f32_16x16x32_bf16 v[60:63], a[232:235], v[236:239], v[60:63]
    v_mfma_f32_16x16x32_bf16 v[60:63], a[228:231], v[220:223], v[60:63]
    v_mfma_f32_16x16x32_bf16 v[60:63], a[224:227], v[204:207], v[60:63]
    v_mfma_f32_16x16x32_bf16 v[60:63], a[220:223], v[188:191], v[60:63]
    v_mfma_f32_16x16x32_bf16 v[60:63], a[216:219], v[172:175], v[60:63]
    s_barrier
    ds_read_b128 a[216:219], v2 offset:12288
    ds_read_b128 a[220:223], v3 offset:12288
    ds_read_b128 a[224:227], v2 offset:12416
    ds_read_b128 a[228:231], v3 offset:12416
    ds_read_b128 a[232:235], v2 offset:12544
    ds_read_b128 a[236:239], v3 offset:12544
    ds_read_b128 a[192:195], v2 offset:18432
    ds_read_b128 a[196:199], v3 offset:18432
    ds_read_b128 a[200:203], v2 offset:18560
    ds_read_b128 a[204:207], v3 offset:18560
    ds_read_b128 a[208:211], v2 offset:18688
    ds_read_b128 a[212:215], v3 offset:18688
    s_nop 7
    s_branch K1_SKIPMAX
K1_EPI:
    s_mul_i32 s33, s31, 6144
    s_add_u32 s16, s33, 0
    s_add_u32 s17, s33, 4096
    s_add_u32 s18, s33, 245760
    s_add_u32 s19, s33, 249856
    s_add_u32 s20, s33, 491520
    s_add_u32 s21, s33, 495616
    s_add_u32 s22, s33, 737280
    s_add_u32 s23, s33, 741376
    v_accvgpr_read_b32 v48, a0
    v_accvgpr_read_b32 v49, a1
    v_accvgpr_read_b32 v50, a2
    v_accvgpr_read_b32 v51, a3
    v_accvgpr_read_b32 v52, a4
    v_accvgpr_read_b32 v53, a5
    v_accvgpr_read_b32 v54, a6
    v_accvgpr_read_b32 v55, a7
    v_pk_mul_f32 v[48:49], v[80:81], v[48:49]
    v_pk_mul_f32 v[50:51], v[82:83], v[50:51]
    v_pk_mul_f32 v[52:53], v[84:85], v[52:53]
    v_pk_mul_f32 v[54:55], v[86:87], v[54:55]
    v_cvt_pk_bf16_f32 v96, v48, v49
    v_cvt_pk_bf16_f32 v97, v50, v51
    v_cvt_pk_bf16_f32 v98, v52, v53
    v_cvt_pk_bf16_f32 v99, v54, v55
    s_nop 1
    v_mfma_f32_16x16x32_bf16 v[112:115], v[96:99], v[106:109], 0
    v_mfma_f32_16x16x32_bf16 v[116:119], v[96:99], v[104:107], 0
    v_accvgpr_read_b32 v56, a16
    v_accvgpr_read_b32 v57, a17
    v_accvgpr_read_b32 v58, a18
    v_accvgpr_read_b32 v59, a19
    v_accvgpr_read_b32 v60, a20
    v_accvgpr_read_b32 v61, a21
    v_accvgpr_read_b32 v62, a22
    v_accvgpr_read_b32 v63, a23
    v_pk_mul_f32 v[56:57], v[80:81], v[56:57]
    v_pk_mul_f32 v[58:59], v[82:83], v[58:59]
    v_pk_mul_f32 v[60:61], v[84:85], v[60:61]
    v_pk_mul_f32 v[62:63], v[86:87], v[62:63]
    v_cvt_pk_bf16_f32 v100, v56, v57
    v_cvt_pk_bf16_f32 v101, v58, v59
    v_cvt_pk_bf16_f32 v102, v60, v61
    v_cvt_pk_bf16_f32 v103, v62, v63
    v_cvt_pk_bf16_f32 v160, v112, v113
    v_cvt_pk_bf16_f32 v161, v114, v115
    v_cvt_pk_bf16_f32 v184, v116, v117
    v_cvt_pk_bf16_f32 v185, v118, v119
    v_mfma_f32_16x16x32_bf16 v[120:123], v[100:103], v[106:109], 0
    v_mfma_f32_16x16x32_bf16 v[124:127], v[100:103], v[104:107], 0
    v_accvgpr_read_b32 v48, a8
    v_accvgpr_read_b32 v49, a9
    v_accvgpr_read_b32 v50, a10
    v_accvgpr_read_b32 v51, a11
    v_accvgpr_read_b32 v52, a12
    v_accvgpr_read_b32 v53, a13
    v_accvgpr_read_b32 v54, a14
    v_accvgpr_read_b32 v55, a15
    v_pk_mul_f32 v[48:49], v[88:89], v[48:49]
    v_pk_mul_f32 v[50:51], v[90:91], v[50:51]
    v_pk_mul_f32 v[52:53], v[92:93], v[52:53]
    v_pk_mul_f32 v[54:55], v[94:95], v[54:55]
    v_cvt_pk_bf16_f32 v96, v48, v49
    v_cvt_pk_bf16_f32 v97, v50, v51
    v_cvt_pk_bf16_f32 v98, v52, v53
    v_cvt_pk_bf16_f32 v99, v54, v55
    v_cvt_pk_bf16_f32 v162, v120, v121
    v_cvt_pk_bf16_f32 v163, v122, v123
    buffer_store_dwordx4 v[160:163], v16, s[24:27], s16 offen offset:0 sc1
    v_cvt_pk_bf16_f32 v186, v124, v125
    v_cvt_pk_bf16_f32 v187, v126, v127
    buffer_store_dwordx4 v[184:187], v16, s[24:27], s18 offen offset:0 sc1
    v_mfma_f32_16x16x32_bf16 v[112:115], v[96:99], v[106:109], 0
    v_mfma_f32_16x16x32_bf16 v[116:119], v[96:99], v[104:107], 0
    v_accvgpr_read_b32 v56, a24
    v_accvgpr_read_b32 v57, a25
    v_accvgpr_read_b32 v58, a26
    v_accvgpr_read_b32 v59, a27
    v_accvgpr_read_b32 v60, a28
    v_accvgpr_read_b32 v61, a29
    v_accvgpr_read_b32 v62, a30
    v_accvgpr_read_b32 v63, a31
    v_pk_mul_f32 v[56:57], v[88:89], v[56:57]
    v_pk_mul_f32 v[58:59], v[90:91], v[58:59]
    v_pk_mul_f32 v[60:61], v[92:93], v[60:61]
    v_pk_mul_f32 v[62:63], v[94:95], v[62:63]
    v_cvt_pk_bf16_f32 v100, v56, v57
    v_cvt_pk_bf16_f32 v101, v58, v59
    v_cvt_pk_bf16_f32 v102, v60, v61
    v_cvt_pk_bf16_f32 v103, v62, v63
    v_cvt_pk_bf16_f32 v208, v112, v113
    v_cvt_pk_bf16_f32 v209, v114, v115
    v_cvt_pk_bf16_f32 v232, v116, v117
    v_cvt_pk_bf16_f32 v233, v118, v119
    v_mfma_f32_16x16x32_bf16 v[120:123], v[100:103], v[106:109], 0
    v_mfma_f32_16x16x32_bf16 v[124:127], v[100:103], v[104:107], 0
    v_accvgpr_read_b32 v48, a32
    v_accvgpr_read_b32 v49, a33
    v_accvgpr_read_b32 v50, a34
    v_accvgpr_read_b32 v51, a35
    v_accvgpr_read_b32 v52, a36
    v_accvgpr_read_b32 v53, a37
    v_accvgpr_read_b32 v54, a38
    v_accvgpr_read_b32 v55, a39
    v_pk_mul_f32 v[48:49], v[80:81], v[48:49]
    v_pk_mul_f32 v[50:51], v[82:83], v[50:51]
    v_pk_mul_f32 v[52:53], v[84:85], v[52:53]
    v_pk_mul_f32 v[54:55], v[86:87], v[54:55]
    v_cvt_pk_bf16_f32 v96, v48, v49
    v_cvt_pk_bf16_f32 v97, v50, v51
    v_cvt_pk_bf16_f32 v98, v52, v53
    v_cvt_pk_bf16_f32 v99, v54, v55
    v_cvt_pk_bf16_f32 v210, v120, v121
    v_cvt_pk_bf16_f32 v211, v122, v123
    buffer_store_dwordx4 v[208:211], v16, s[24:27], s20 offen offset:0 sc1
    v_cvt_pk_bf16_f32 v234, v124, v125
    v_cvt_pk_bf16_f32 v235, v126, v127
    buffer_store_dwordx4 v[232:235], v16, s[24:27], s22 offen offset:0 sc1
    v_mfma_f32_16x16x32_bf16 v[112:115], v[96:99], v[106:109], 0
    v_mfma_f32_16x16x32_bf16 v[116:119], v[96:99], v[104:107], 0
    v_accvgpr_read_b32 v56, a48
    v_accvgpr_read_b32 v57, a49
    v_accvgpr_read_b32 v58, a50
    v_accvgpr_read_b32 v59, a51
    v_accvgpr_read_b32 v60, a52
    v_accvgpr_read_b32 v61, a53
    v_accvgpr_read_b32 v62, a54
    v_accvgpr_read_b32 v63, a55
    v_pk_mul_f32 v[56:57], v[80:81], v[56:57]
    v_pk_mul_f32 v[58:59], v[82:83], v[58:59]
    v_pk_mul_f32 v[60:61], v[84:85], v[60:61]
    v_pk_mul_f32 v[62:63], v[86:87], v[62:63]
    v_cvt_pk_bf16_f32 v100, v56, v57
    v_cvt_pk_bf16_f32 v101, v58, v59
    v_cvt_pk_bf16_f32 v102, v60, v61
    v_cvt_pk_bf16_f32 v103, v62, v63
    v_cvt_pk_bf16_f32 v164, v112, v113
    v_cvt_pk_bf16_f32 v165, v114, v115
    v_cvt_pk_bf16_f32 v188, v116, v117
    v_cvt_pk_bf16_f32 v189, v118, v119
    v_mfma_f32_16x16x32_bf16 v[120:123], v[100:103], v[106:109], 0
    v_mfma_f32_16x16x32_bf16 v[124:127], v[100:103], v[104:107], 0
    v_accvgpr_read_b32 v48, a40
    v_accvgpr_read_b32 v49, a41
    v_accvgpr_read_b32 v50, a42
    v_accvgpr_read_b32 v51, a43
    v_accvgpr_read_b32 v52, a44
    v_accvgpr_read_b32 v53, a45
    v_accvgpr_read_b32 v54, a46
    v_accvgpr_read_b32 v55, a47
    v_pk_mul_f32 v[48:49], v[88:89], v[48:49]
    v_pk_mul_f32 v[50:51], v[90:91], v[50:51]
    v_pk_mul_f32 v[52:53], v[92:93], v[52:53]
    v_pk_mul_f32 v[54:55], v[94:95], v[54:55]
    v_cvt_pk_bf16_f32 v96, v48, v49
    v_cvt_pk_bf16_f32 v97, v50, v51
    v_cvt_pk_bf16_f32 v98, v52, v53
    v_cvt_pk_bf16_f32 v99, v54, v55
    v_cvt_pk_bf16_f32 v166, v120, v121
    v_cvt_pk_bf16_f32 v167, v122, v123
    buffer_store_dwordx4 v[164:167], v16, s[24:27], s16 offen offset:1024 sc1
    v_cvt_pk_bf16_f32 v190, v124, v125
    v_cvt_pk_bf16_f32 v191, v126, v127
    buffer_store_dwordx4 v[188:191], v16, s[24:27], s18 offen offset:1024 sc1
    v_mfma_f32_16x16x32_bf16 v[112:115], v[96:99], v[106:109], 0
    v_mfma_f32_16x16x32_bf16 v[116:119], v[96:99], v[104:107], 0
    v_accvgpr_read_b32 v56, a56
    v_accvgpr_read_b32 v57, a57
    v_accvgpr_read_b32 v58, a58
    v_accvgpr_read_b32 v59, a59
    v_accvgpr_read_b32 v60, a60
    v_accvgpr_read_b32 v61, a61
    v_accvgpr_read_b32 v62, a62
    v_accvgpr_read_b32 v63, a63
    v_pk_mul_f32 v[56:57], v[88:89], v[56:57]
    v_pk_mul_f32 v[58:59], v[90:91], v[58:59]
    v_pk_mul_f32 v[60:61], v[92:93], v[60:61]
    v_pk_mul_f32 v[62:63], v[94:95], v[62:63]
    v_cvt_pk_bf16_f32 v100, v56, v57
    v_cvt_pk_bf16_f32 v101, v58, v59
    v_cvt_pk_bf16_f32 v102, v60, v61
    v_cvt_pk_bf16_f32 v103, v62, v63
    v_cvt_pk_bf16_f32 v212, v112, v113
    v_cvt_pk_bf16_f32 v213, v114, v115
    v_cvt_pk_bf16_f32 v236, v116, v117
    v_cvt_pk_bf16_f32 v237, v118, v119
    v_mfma_f32_16x16x32_bf16 v[120:123], v[100:103], v[106:109], 0
    v_mfma_f32_16x16x32_bf16 v[124:127], v[100:103], v[104:107], 0
    v_accvgpr_read_b32 v48, a64
    v_accvgpr_read_b32 v49, a65
    v_accvgpr_read_b32 v50, a66
    v_accvgpr_read_b32 v51, a67
    v_accvgpr_read_b32 v52, a68
    v_accvgpr_read_b32 v53, a69
    v_accvgpr_read_b32 v54, a70
    v_accvgpr_read_b32 v55, a71
    v_pk_mul_f32 v[48:49], v[80:81], v[48:49]
    v_pk_mul_f32 v[50:51], v[82:83], v[50:51]
    v_pk_mul_f32 v[52:53], v[84:85], v[52:53]
    v_pk_mul_f32 v[54:55], v[86:87], v[54:55]
    v_cvt_pk_bf16_f32 v96, v48, v49
    v_cvt_pk_bf16_f32 v97, v50, v51
    v_cvt_pk_bf16_f32 v98, v52, v53
    v_cvt_pk_bf16_f32 v99, v54, v55
    v_cvt_pk_bf16_f32 v214, v120, v121
    v_cvt_pk_bf16_f32 v215, v122, v123
    buffer_store_dwordx4 v[212:215], v16, s[24:27], s20 offen offset:1024 sc1
    v_cvt_pk_bf16_f32 v238, v124, v125
    v_cvt_pk_bf16_f32 v239, v126, v127
    buffer_store_dwordx4 v[236:239], v16, s[24:27], s22 offen offset:1024 sc1
    v_mfma_f32_16x16x32_bf16 v[112:115], v[96:99], v[106:109], 0
    v_mfma_f32_16x16x32_bf16 v[116:119], v[96:99], v[104:107], 0
    v_accvgpr_read_b32 v56, a80
    v_accvgpr_read_b32 v57, a81
    v_accvgpr_read_b32 v58, a82
    v_accvgpr_read_b32 v59, a83
    v_accvgpr_read_b32 v60, a84
    v_accvgpr_read_b32 v61, a85
    v_accvgpr_read_b32 v62, a86
    v_accvgpr_read_b32 v63, a87
    v_pk_mul_f32 v[56:57], v[80:81], v[56:57]
    v_pk_mul_f32 v[58:59], v[82:83], v[58:59]
    v_pk_mul_f32 v[60:61], v[84:85], v[60:61]
    v_pk_mul_f32 v[62:63], v[86:87], v[62:63]
    v_cvt_pk_bf16_f32 v100, v56, v57
    v_cvt_pk_bf16_f32 v101, v58, v59
    v_cvt_pk_bf16_f32 v102, v60, v61
    v_cvt_pk_bf16_f32 v103, v62, v63
    v_cvt_pk_bf16_f32 v168, v112, v113
    v_cvt_pk_bf16_f32 v169, v114, v115
    v_cvt_pk_bf16_f32 v192, v116, v117
    v_cvt_pk_bf16_f32 v193, v118, v119
    v_mfma_f32_16x16x32_bf16 v[120:123], v[100:103], v[106:109], 0
    v_mfma_f32_16x16x32_bf16 v[124:127], v[100:103], v[104:107], 0
    v_accvgpr_read_b32 v48, a72
    v_accvgpr_read_b32 v49, a73
    v_accvgpr_read_b32 v50, a74
    v_accvgpr_read_b32 v51, a75
    v_accvgpr_read_b32 v52, a76
    v_accvgpr_read_b32 v53, a77
    v_accvgpr_read_b32 v54, a78
    v_accvgpr_read_b32 v55, a79
    v_pk_mul_f32 v[48:49], v[88:89], v[48:49]
    v_pk_mul_f32 v[50:51], v[90:91], v[50:51]
    v_pk_mul_f32 v[52:53], v[92:93], v[52:53]
    v_pk_mul_f32 v[54:55], v[94:95], v[54:55]
    v_cvt_pk_bf16_f32 v96, v48, v49
    v_cvt_pk_bf16_f32 v97, v50, v51
    v_cvt_pk_bf16_f32 v98, v52, v53
    v_cvt_pk_bf16_f32 v99, v54, v55
    v_cvt_pk_bf16_f32 v170, v120, v121
    v_cvt_pk_bf16_f32 v171, v122, v123
    buffer_store_dwordx4 v[168:171], v16, s[24:27], s16 offen offset:2048 sc1
    v_cvt_pk_bf16_f32 v194, v124, v125
    v_cvt_pk_bf16_f32 v195, v126, v127
    buffer_store_dwordx4 v[192:195], v16, s[24:27], s18 offen offset:2048 sc1
    v_mfma_f32_16x16x32_bf16 v[112:115], v[96:99], v[106:109], 0
    v_mfma_f32_16x16x32_bf16 v[116:119], v[96:99], v[104:107], 0
    v_accvgpr_read_b32 v56, a88
    v_accvgpr_read_b32 v57, a89
    v_accvgpr_read_b32 v58, a90
    v_accvgpr_read_b32 v59, a91
    v_accvgpr_read_b32 v60, a92
    v_accvgpr_read_b32 v61, a93
    v_accvgpr_read_b32 v62, a94
    v_accvgpr_read_b32 v63, a95
    v_pk_mul_f32 v[56:57], v[88:89], v[56:57]
    v_pk_mul_f32 v[58:59], v[90:91], v[58:59]
    v_pk_mul_f32 v[60:61], v[92:93], v[60:61]
    v_pk_mul_f32 v[62:63], v[94:95], v[62:63]
    v_cvt_pk_bf16_f32 v100, v56, v57
    v_cvt_pk_bf16_f32 v101, v58, v59
    v_cvt_pk_bf16_f32 v102, v60, v61
    v_cvt_pk_bf16_f32 v103, v62, v63
    v_cvt_pk_bf16_f32 v216, v112, v113
    v_cvt_pk_bf16_f32 v217, v114, v115
    v_cvt_pk_bf16_f32 v240, v116, v117
    v_cvt_pk_bf16_f32 v241, v118, v119
    v_mfma_f32_16x16x32_bf16 v[120:123], v[100:103], v[106:109], 0
    v_mfma_f32_16x16x32_bf16 v[124:127], v[100:103], v[104:107], 0
    v_accvgpr_read_b32 v48, a96
    v_accvgpr_read_b32 v49, a97
    v_accvgpr_read_b32 v50, a98
    v_accvgpr_read_b32 v51, a99
    v_accvgpr_read_b32 v52, a100
    v_accvgpr_read_b32 v53, a101
    v_accvgpr_read_b32 v54, a102
    v_accvgpr_read_b32 v55, a103
    v_pk_mul_f32 v[48:49], v[80:81], v[48:49]
    v_pk_mul_f32 v[50:51], v[82:83], v[50:51]
    v_pk_mul_f32 v[52:53], v[84:85], v[52:53]
    v_pk_mul_f32 v[54:55], v[86:87], v[54:55]
    v_cvt_pk_bf16_f32 v96, v48, v49
    v_cvt_pk_bf16_f32 v97, v50, v51
    v_cvt_pk_bf16_f32 v98, v52, v53
    v_cvt_pk_bf16_f32 v99, v54, v55
    v_cvt_pk_bf16_f32 v218, v120, v121
    v_cvt_pk_bf16_f32 v219, v122, v123
    buffer_store_dwordx4 v[216:219], v16, s[24:27], s20 offen offset:2048 sc1
    v_cvt_pk_bf16_f32 v242, v124, v125
    v_cvt_pk_bf16_f32 v243, v126, v127
    buffer_store_dwordx4 v[240:243], v16, s[24:27], s22 offen offset:2048 sc1
    v_mfma_f32_16x16x32_bf16 v[112:115], v[96:99], v[106:109], 0
    v_mfma_f32_16x16x32_bf16 v[116:119], v[96:99], v[104:107], 0
    v_accvgpr_read_b32 v56, a112
    v_accvgpr_read_b32 v57, a113
    v_accvgpr_read_b32 v58, a114
    v_accvgpr_read_b32 v59, a115
    v_accvgpr_read_b32 v60, a116
    v_accvgpr_read_b32 v61, a117
    v_accvgpr_read_b32 v62, a118
    v_accvgpr_read_b32 v63, a119
    v_pk_mul_f32 v[56:57], v[80:81], v[56:57]
    v_pk_mul_f32 v[58:59], v[82:83], v[58:59]
    v_pk_mul_f32 v[60:61], v[84:85], v[60:61]
    v_pk_mul_f32 v[62:63], v[86:87], v[62:63]
    v_cvt_pk_bf16_f32 v100, v56, v57
    v_cvt_pk_bf16_f32 v101, v58, v59
    v_cvt_pk_bf16_f32 v102, v60, v61
    v_cvt_pk_bf16_f32 v103, v62, v63
    v_cvt_pk_bf16_f32 v172, v112, v113
    v_cvt_pk_bf16_f32 v173, v114, v115
    v_cvt_pk_bf16_f32 v196, v116, v117
    v_cvt_pk_bf16_f32 v197, v118, v119
    v_mfma_f32_16x16x32_bf16 v[120:123], v[100:103], v[106:109], 0
    v_mfma_f32_16x16x32_bf16 v[124:127], v[100:103], v[104:107], 0
    v_accvgpr_read_b32 v48, a104
    v_accvgpr_read_b32 v49, a105
    v_accvgpr_read_b32 v50, a106
    v_accvgpr_read_b32 v51, a107
    v_accvgpr_read_b32 v52, a108
    v_accvgpr_read_b32 v53, a109
    v_accvgpr_read_b32 v54, a110
    v_accvgpr_read_b32 v55, a111
    v_pk_mul_f32 v[48:49], v[88:89], v[48:49]
    v_pk_mul_f32 v[50:51], v[90:91], v[50:51]
    v_pk_mul_f32 v[52:53], v[92:93], v[52:53]
    v_pk_mul_f32 v[54:55], v[94:95], v[54:55]
    v_cvt_pk_bf16_f32 v96, v48, v49
    v_cvt_pk_bf16_f32 v97, v50, v51
    v_cvt_pk_bf16_f32 v98, v52, v53
    v_cvt_pk_bf16_f32 v99, v54, v55
    v_cvt_pk_bf16_f32 v174, v120, v121
    v_cvt_pk_bf16_f32 v175, v122, v123
    buffer_store_dwordx4 v[172:175], v16, s[24:27], s16 offen offset:3072 sc1
    v_cvt_pk_bf16_f32 v198, v124, v125
    v_cvt_pk_bf16_f32 v199, v126, v127
    buffer_store_dwordx4 v[196:199], v16, s[24:27], s18 offen offset:3072 sc1
    v_mfma_f32_16x16x32_bf16 v[112:115], v[96:99], v[106:109], 0
    v_mfma_f32_16x16x32_bf16 v[116:119], v[96:99], v[104:107], 0
    v_accvgpr_read_b32 v56, a120
    v_accvgpr_read_b32 v57, a121
    v_accvgpr_read_b32 v58, a122
    v_accvgpr_read_b32 v59, a123
    v_accvgpr_read_b32 v60, a124
    v_accvgpr_read_b32 v61, a125
    v_accvgpr_read_b32 v62, a126
    v_accvgpr_read_b32 v63, a127
    v_pk_mul_f32 v[56:57], v[88:89], v[56:57]
    v_pk_mul_f32 v[58:59], v[90:91], v[58:59]
    v_pk_mul_f32 v[60:61], v[92:93], v[60:61]
    v_pk_mul_f32 v[62:63], v[94:95], v[62:63]
    v_cvt_pk_bf16_f32 v100, v56, v57
    v_cvt_pk_bf16_f32 v101, v58, v59
    v_cvt_pk_bf16_f32 v102, v60, v61
    v_cvt_pk_bf16_f32 v103, v62, v63
    v_cvt_pk_bf16_f32 v220, v112, v113
    v_cvt_pk_bf16_f32 v221, v114, v115
    v_cvt_pk_bf16_f32 v244, v116, v117
    v_cvt_pk_bf16_f32 v245, v118, v119
    v_mfma_f32_16x16x32_bf16 v[120:123], v[100:103], v[106:109], 0
    v_mfma_f32_16x16x32_bf16 v[124:127], v[100:103], v[104:107], 0
    v_accvgpr_read_b32 v48, a128
    v_accvgpr_read_b32 v49, a129
    v_accvgpr_read_b32 v50, a130
    v_accvgpr_read_b32 v51, a131
    v_accvgpr_read_b32 v52, a132
    v_accvgpr_read_b32 v53, a133
    v_accvgpr_read_b32 v54, a134
    v_accvgpr_read_b32 v55, a135
    v_pk_mul_f32 v[48:49], v[80:81], v[48:49]
    v_pk_mul_f32 v[50:51], v[82:83], v[50:51]
    v_pk_mul_f32 v[52:53], v[84:85], v[52:53]
    v_pk_mul_f32 v[54:55], v[86:87], v[54:55]
    v_cvt_pk_bf16_f32 v96, v48, v49
    v_cvt_pk_bf16_f32 v97, v50, v51
    v_cvt_pk_bf16_f32 v98, v52, v53
    v_cvt_pk_bf16_f32 v99, v54, v55
    v_cvt_pk_bf16_f32 v222, v120, v121
    v_cvt_pk_bf16_f32 v223, v122, v123
    buffer_store_dwordx4 v[220:223], v16, s[24:27], s20 offen offset:3072 sc1
    v_cvt_pk_bf16_f32 v246, v124, v125
    v_cvt_pk_bf16_f32 v247, v126, v127
    buffer_store_dwordx4 v[244:247], v16, s[24:27], s22 offen offset:3072 sc1
    v_mfma_f32_16x16x32_bf16 v[112:115], v[96:99], v[106:109], 0
    v_mfma_f32_16x16x32_bf16 v[116:119], v[96:99], v[104:107], 0
    v_accvgpr_read_b32 v56, a144
    v_accvgpr_read_b32 v57, a145
    v_accvgpr_read_b32 v58, a146
    v_accvgpr_read_b32 v59, a147
    v_accvgpr_read_b32 v60, a148
    v_accvgpr_read_b32 v61, a149
    v_accvgpr_read_b32 v62, a150
    v_accvgpr_read_b32 v63, a151
    v_pk_mul_f32 v[56:57], v[80:81], v[56:57]
    v_pk_mul_f32 v[58:59], v[82:83], v[58:59]
    v_pk_mul_f32 v[60:61], v[84:85], v[60:61]
    v_pk_mul_f32 v[62:63], v[86:87], v[62:63]
    v_cvt_pk_bf16_f32 v100, v56, v57
    v_cvt_pk_bf16_f32 v101, v58, v59
    v_cvt_pk_bf16_f32 v102, v60, v61
    v_cvt_pk_bf16_f32 v103, v62, v63
    v_cvt_pk_bf16_f32 v176, v112, v113
    v_cvt_pk_bf16_f32 v177, v114, v115
    v_cvt_pk_bf16_f32 v200, v116, v117
    v_cvt_pk_bf16_f32 v201, v118, v119
    v_mfma_f32_16x16x32_bf16 v[120:123], v[100:103], v[106:109], 0
    v_mfma_f32_16x16x32_bf16 v[124:127], v[100:103], v[104:107], 0
    v_accvgpr_read_b32 v48, a136
    v_accvgpr_read_b32 v49, a137
    v_accvgpr_read_b32 v50, a138
    v_accvgpr_read_b32 v51, a139
    v_accvgpr_read_b32 v52, a140
    v_accvgpr_read_b32 v53, a141
    v_accvgpr_read_b32 v54, a142
    v_accvgpr_read_b32 v55, a143
    v_pk_mul_f32 v[48:49], v[88:89], v[48:49]
    v_pk_mul_f32 v[50:51], v[90:91], v[50:51]
    v_pk_mul_f32 v[52:53], v[92:93], v[52:53]
    v_pk_mul_f32 v[54:55], v[94:95], v[54:55]
    v_cvt_pk_bf16_f32 v96, v48, v49
    v_cvt_pk_bf16_f32 v97, v50, v51
    v_cvt_pk_bf16_f32 v98, v52, v53
    v_cvt_pk_bf16_f32 v99, v54, v55
    v_cvt_pk_bf16_f32 v178, v120, v121
    v_cvt_pk_bf16_f32 v179, v122, v123
    buffer_store_dwordx4 v[176:179], v16, s[24:27], s17 offen offset:0 sc1
    v_cvt_pk_bf16_f32 v202, v124, v125
    v_cvt_pk_bf16_f32 v203, v126, v127
    buffer_store_dwordx4 v[200:203], v16, s[24:27], s19 offen offset:0 sc1
    v_mfma_f32_16x16x32_bf16 v[112:115], v[96:99], v[106:109], 0
    v_mfma_f32_16x16x32_bf16 v[116:119], v[96:99], v[104:107], 0
    v_accvgpr_read_b32 v56, a152
    v_accvgpr_read_b32 v57, a153
    v_accvgpr_read_b32 v58, a154
    v_accvgpr_read_b32 v59, a155
    v_accvgpr_read_b32 v60, a156
    v_accvgpr_read_b32 v61, a157
    v_accvgpr_read_b32 v62, a158
    v_accvgpr_read_b32 v63, a159
    v_pk_mul_f32 v[56:57], v[88:89], v[56:57]
    v_pk_mul_f32 v[58:59], v[90:91], v[58:59]
    v_pk_mul_f32 v[60:61], v[92:93], v[60:61]
    v_pk_mul_f32 v[62:63], v[94:95], v[62:63]
    v_cvt_pk_bf16_f32 v100, v56, v57
    v_cvt_pk_bf16_f32 v101, v58, v59
    v_cvt_pk_bf16_f32 v102, v60, v61
    v_cvt_pk_bf16_f32 v103, v62, v63
    v_cvt_pk_bf16_f32 v224, v112, v113
    v_cvt_pk_bf16_f32 v225, v114, v115
    v_cvt_pk_bf16_f32 v248, v116, v117
    v_cvt_pk_bf16_f32 v249, v118, v119
    v_mfma_f32_16x16x32_bf16 v[120:123], v[100:103], v[106:109], 0
    v_mfma_f32_16x16x32_bf16 v[124:127], v[100:103], v[104:107], 0
    v_accvgpr_read_b32 v48, a160
    v_accvgpr_read_b32 v49, a161
    v_accvgpr_read_b32 v50, a162
    v_accvgpr_read_b32 v51, a163
    v_accvgpr_read_b32 v52, a164
    v_accvgpr_read_b32 v53, a165
    v_accvgpr_read_b32 v54, a166
    v_accvgpr_read_b32 v55, a167
    v_pk_mul_f32 v[48:49], v[80:81], v[48:49]
    v_pk_mul_f32 v[50:51], v[82:83], v[50:51]
    v_pk_mul_f32 v[52:53], v[84:85], v[52:53]
    v_pk_mul_f32 v[54:55], v[86:87], v[54:55]
    v_cvt_pk_bf16_f32 v96, v48, v49
    v_cvt_pk_bf16_f32 v97, v50, v51
    v_cvt_pk_bf16_f32 v98, v52, v53
    v_cvt_pk_bf16_f32 v99, v54, v55
    v_cvt_pk_bf16_f32 v226, v120, v121
    v_cvt_pk_bf16_f32 v227, v122, v123
    buffer_store_dwordx4 v[224:227], v16, s[24:27], s21 offen offset:0 sc1
    v_cvt_pk_bf16_f32 v250, v124, v125
    v_cvt_pk_bf16_f32 v251, v126, v127
    buffer_store_dwordx4 v[248:251], v16, s[24:27], s23 offen offset:0 sc1
    v_mfma_f32_16x16x32_bf16 v[112:115], v[96:99], v[106:109], 0
    v_mfma_f32_16x16x32_bf16 v[116:119], v[96:99], v[104:107], 0
    v_accvgpr_read_b32 v56, a176
    v_accvgpr_read_b32 v57, a177
    v_accvgpr_read_b32 v58, a178
    v_accvgpr_read_b32 v59, a179
    v_accvgpr_read_b32 v60, a180
    v_accvgpr_read_b32 v61, a181
    v_accvgpr_read_b32 v62, a182
    v_accvgpr_read_b32 v63, a183
    v_pk_mul_f32 v[56:57], v[80:81], v[56:57]
    v_pk_mul_f32 v[58:59], v[82:83], v[58:59]
    v_pk_mul_f32 v[60:61], v[84:85], v[60:61]
    v_pk_mul_f32 v[62:63], v[86:87], v[62:63]
    v_cvt_pk_bf16_f32 v100, v56, v57
    v_cvt_pk_bf16_f32 v101, v58, v59
    v_cvt_pk_bf16_f32 v102, v60, v61
    v_cvt_pk_bf16_f32 v103, v62, v63
    v_cvt_pk_bf16_f32 v180, v112, v113
    v_cvt_pk_bf16_f32 v181, v114, v115
    v_cvt_pk_bf16_f32 v204, v116, v117
    v_cvt_pk_bf16_f32 v205, v118, v119
    v_mfma_f32_16x16x32_bf16 v[120:123], v[100:103], v[106:109], 0
    v_mfma_f32_16x16x32_bf16 v[124:127], v[100:103], v[104:107], 0
    v_accvgpr_read_b32 v48, a168
    v_accvgpr_read_b32 v49, a169
    v_accvgpr_read_b32 v50, a170
    v_accvgpr_read_b32 v51, a171
    v_accvgpr_read_b32 v52, a172
    v_accvgpr_read_b32 v53, a173
    v_accvgpr_read_b32 v54, a174
    v_accvgpr_read_b32 v55, a175
    v_pk_mul_f32 v[48:49], v[88:89], v[48:49]
    v_pk_mul_f32 v[50:51], v[90:91], v[50:51]
    v_pk_mul_f32 v[52:53], v[92:93], v[52:53]
    v_pk_mul_f32 v[54:55], v[94:95], v[54:55]
    v_cvt_pk_bf16_f32 v96, v48, v49
    v_cvt_pk_bf16_f32 v97, v50, v51
    v_cvt_pk_bf16_f32 v98, v52, v53
    v_cvt_pk_bf16_f32 v99, v54, v55
    v_cvt_pk_bf16_f32 v182, v120, v121
    v_cvt_pk_bf16_f32 v183, v122, v123
    buffer_store_dwordx4 v[180:183], v16, s[24:27], s17 offen offset:1024 sc1
    v_cvt_pk_bf16_f32 v206, v124, v125
    v_cvt_pk_bf16_f32 v207, v126, v127
    buffer_store_dwordx4 v[204:207], v16, s[24:27], s19 offen offset:1024 sc1
    v_mfma_f32_16x16x32_bf16 v[112:115], v[96:99], v[106:109], 0
    v_mfma_f32_16x16x32_bf16 v[116:119], v[96:99], v[104:107], 0
    v_accvgpr_read_b32 v56, a184
    v_accvgpr_read_b32 v57, a185
    v_accvgpr_read_b32 v58, a186
    v_accvgpr_read_b32 v59, a187
    v_accvgpr_read_b32 v60, a188
    v_accvgpr_read_b32 v61, a189
    v_accvgpr_read_b32 v62, a190
    v_accvgpr_read_b32 v63, a191
    v_pk_mul_f32 v[56:57], v[88:89], v[56:57]
    v_pk_mul_f32 v[58:59], v[90:91], v[58:59]
    v_pk_mul_f32 v[60:61], v[92:93], v[60:61]
    v_pk_mul_f32 v[62:63], v[94:95], v[62:63]
    v_cvt_pk_bf16_f32 v100, v56, v57
    v_cvt_pk_bf16_f32 v101, v58, v59
    v_cvt_pk_bf16_f32 v102, v60, v61
    v_cvt_pk_bf16_f32 v103, v62, v63
    v_cvt_pk_bf16_f32 v228, v112, v113
    v_cvt_pk_bf16_f32 v229, v114, v115
    v_cvt_pk_bf16_f32 v252, v116, v117
    v_cvt_pk_bf16_f32 v253, v118, v119
    v_mfma_f32_16x16x32_bf16 v[120:123], v[100:103], v[106:109], 0
    v_mfma_f32_16x16x32_bf16 v[124:127], v[100:103], v[104:107], 0
    s_nop 7
    v_cvt_pk_bf16_f32 v230, v120, v121
    v_cvt_pk_bf16_f32 v231, v122, v123
    buffer_store_dwordx4 v[228:231], v16, s[24:27], s21 offen offset:1024 sc1
    v_cvt_pk_bf16_f32 v254, v124, v125
    v_cvt_pk_bf16_f32 v255, v126, v127
    buffer_store_dwordx4 v[252:255], v16, s[24:27], s23 offen offset:1024 sc1
    s_bfe_u32 s29, s2, 0x20001
    s_and_b32 s30, s2, 1
    s_lshl_b32 s30, s30, 3
    s_lshr_b32 s33, s2, 5
    s_add_u32 s30, s30, s33
    s_lshr_b32 s33, s28, 1
    s_lshl_b32 s33, s33, 2
    s_mul_i32 s35, s28, 15360
    s_add_u32 s34, s29, 0
    s_and_b32 s34, s34, 3
    s_mul_i32 s44, s34, 61440
    s_add_u32 s44, s44, s35
    s_add_u32 s34, s34, s33
    s_lshl_b32 s34, s34, 11
    v_add_u32 v4, s34, v16
    v_add_u32 v9, s34, v17
    s_add_u32 s34, s29, 1
    s_and_b32 s34, s34, 3
    s_mul_i32 s45, s34, 61440
    s_add_u32 s45, s45, s35
    s_add_u32 s34, s34, s33
    s_lshl_b32 s34, s34, 11
    v_add_u32 v5, s34, v16
    v_add_u32 v10, s34, v17
    s_add_u32 s34, s29, 2
    s_and_b32 s34, s34, 3
    s_mul_i32 s46, s34, 61440
    s_add_u32 s46, s46, s35
    s_add_u32 s34, s34, s33
    s_lshl_b32 s34, s34, 11
    v_add_u32 v6, s34, v16
    v_add_u32 v11, s34, v17
    s_add_u32 s34, s29, 3
    s_and_b32 s34, s34, 3
    s_mul_i32 s47, s34, 61440
    s_add_u32 s47, s47, s35
    s_add_u32 s34, s34, s33
    s_lshl_b32 s34, s34, 11
    v_add_u32 v7, s34, v16
    v_add_u32 v12, s34, v17
    s_and_b32 s34, s28, 1
    s_mul_i32 s34, s34, 5120
    s_add_u32 s34, s34, 16384
    v_add_u32 v8, s34, v16
    s_lshl_b32 s34, s30, 3
    s_add_u32 s34, s34, s33
    s_add_u32 s34, s34, s29
    s_lshl_b32 s34, s34, 4
    v_and_b32 v3, 15, v0
    v_add_u32 v3, s34, v3
    v_mul_u32_u24 v3, 1280, v3
    v_lshrrev_b32 v2, 4, v0
    v_lshl_add_u32 v3, v2, 3, v3
    s_bfe_u32 s34, s2, 0x20003
    s_lshl_b32 s34, s34, 1
    s_and_b32 s35, s28, 1
    s_add_u32 s34, s34, s35
    s_mul_i32 s34, s34, 160
    v_add_u32 v3, s34, v3
    s_lshl_b32 s34, s30, 1
    s_lshr_b32 s35, s28, 1
    s_add_u32 s34, s34, s35
    s_lshl_b32 s34, s34, 7
    s_lshl_b32 s35, s29, 5
    s_add_u32 s34, s34, s35
    s_add_u32 s34, s34, 117440512
    v_and_b32 v2, 7, v0
    v_lshl_add_u32 v2, v2, 2, s34
    s_mov_b32 s48, 36864
    s_mov_b32 s49, 4294856704
    s_and_b32 s33, s2, 1
    v_readlane_b32 s16, v22, s33
    s_add_u32 s33, s33, 2
    v_readlane_b32 s17, v22, s33
    s_add_u32 s33, s33, 2
    v_readlane_b32 s18, v22, s33
    s_add_u32 s33, s33, 2
    v_readlane_b32 s19, v22, s33
    s_add_u32 s33, s33, 2
    s_sub_u32 s19, s19, s16
    s_lshl_b32 s19, s19, 2
    s_or_b32 s19, s19, 3
    s_sub_u32 s18, s18, s16
    s_lshl_b32 s18, s18, 2
    s_or_b32 s18, s18, 2
    s_sub_u32 s17, s17, s16
    s_lshl_b32 s17, s17, 2
    s_or_b32 s17, s17, 1
    s_sub_u32 s16, s16, s16
    s_lshl_b32 s16, s16, 2
    s_or_b32 s16, s16, 0
    s_min_i32 s33, s16, s17
    s_max_i32 s17, s16, s17
    s_mov_b32 s16, s33
    s_min_i32 s33, s18, s19
    s_max_i32 s19, s18, s19
    s_mov_b32 s18, s33
    s_min_i32 s33, s16, s18
    s_max_i32 s18, s16, s18
    s_mov_b32 s16, s33
    s_min_i32 s33, s17, s19
    s_max_i32 s19, s17, s19
    s_mov_b32 s17, s33
    s_min_i32 s33, s17, s18
    s_max_i32 s18, s17, s18
    s_mov_b32 s17, s33
    s_mov_b32 s54, 7
    s_mov_b32 s56, s29
    s_mov_b32 s57, 0
    s_sub_i32 s33, s19, s16
    s_mov_b32 s34, 0
    s_cmp_gt_i32 s33, 14080
    s_cselect_b32 s34, 1, s34
    s_cmp_gt_i32 s33, 34560
    s_cselect_b32 s34, 2, s34
    s_cmp_gt_i32 s33, 55040
    s_cselect_b32 s34, 3, s34
    s_cmp_gt_i32 s33, 75520
    s_cselect_b32 s34, 4, s34
    s_cmp_gt_i32 s33, 96000
    s_cselect_b32 s34, 5, s34
    s_cmp_gt_i32 s33, 116480
    s_cselect_b32 s34, 6, s34
    s_and_b32 s19, s19, 3
    s_and_b32 s16, s16, 3
    s_cmp_eq_u32 s19, s29
    s_cselect_b32 s33, s34, 0
    s_sub_u32 s54, s54, s33
    s_mul_i32 s35, s19, 48
    s_add_u32 s35, s35, 48
    s_lshl_b32 s33, s34, 2
    s_sub_u32 s35, s35, s33
    s_cmp_eq_u32 s16, s29
    s_cselect_b32 s33, s34, 0
    s_cselect_b32 s57, s35, s57
    s_add_u32 s54, s54, s33
    s_cmp_lg_u32 s33, 0
    s_cselect_b32 s56, s19, s56
    s_sub_i32 s33, s18, s17
    s_mov_b32 s34, 0
    s_cmp_gt_i32 s33, 14080
    s_cselect_b32 s34, 1, s34
    s_cmp_gt_i32 s33, 34560
    s_cselect_b32 s34, 2, s34
    s_cmp_gt_i32 s33, 55040
    s_cselect_b32 s34, 3, s34
    s_cmp_gt_i32 s33, 75520
    s_cselect_b32 s34, 4, s34
    s_cmp_gt_i32 s33, 96000
    s_cselect_b32 s34, 5, s34
    s_cmp_gt_i32 s33, 116480
    s_cselect_b32 s34, 6, s34
    s_and_b32 s18, s18, 3
    s_and_b32 s17, s17, 3
    s_cmp_eq_u32 s18, s29
    s_cselect_b32 s33, s34, 0
    s_sub_u32 s54, s54, s33
    s_mul_i32 s35, s18, 48
    s_add_u32 s35, s35, 48
    s_lshl_b32 s33, s34, 2
    s_sub_u32 s35, s35, s33
    s_cmp_eq_u32 s17, s29
    s_cselect_b32 s33, s34, 0
    s_cselect_b32 s57, s35, s57
    s_add_u32 s54, s54, s33
    s_cmp_lg_u32 s33, 0
    s_cselect_b32 s56, s18, s56
    s_sub_u32 s56, s56, s29
    s_lshl_b32 s56, s56, 5
    v_add_u32 v13, s56, v2
    s_add_u32 s56, s43, 48
    s_min_u32 s33, s54, 7
    s_lshl_b32 s33, s33, 2
    s_add_u32 s33, s33, 20
    s_and_b32 s33, s33, 0xfffffff8
    s_add_u32 s23, s33, s43
    s_bfe_u32 s58, s2, 0x20003
    s_add_u32 s58, s58, s30
    s_and_b32 s58, s58, 3
    s_lshl_b32 s58, s58, 1
    s_and_b32 s22, s58, 2
    s_waitcnt vmcnt(42)
    s_barrier
    ds_read_b128 a[16:19], v8 offset:0
    ds_read_b128 a[0:3], v4 offset:0
    ds_read_b128 a[4:7], v5 offset:0
    ds_read_b128 a[8:11], v6 offset:0
    ds_read_b128 a[12:15], v7 offset:0
    ds_read_b128 a[20:23], v8 offset:1024
    ds_read_b128 a[24:27], v8 offset:2048
    ds_read_b128 a[28:31], v8 offset:3072
    ds_read_b128 a[32:35], v8 offset:4096
    ds_read_b128 a[52:55], v8 offset:10240
    ds_read2_b64 a[36:39], v9 offset0:128 offset1:192
    ds_read2_b64 a[40:43], v10 offset0:128 offset1:192
    ds_read2_b64 a[44:47], v11 offset0:128 offset1:192
    ds_read2_b64 a[48:51], v12 offset0:128 offset1:192
    ds_read_b128 a[56:59], v8 offset:11264
    ds_read_b128 a[60:63], v8 offset:12288
    ds_read_b128 a[64:67], v8 offset:13312
    ds_read_b128 a[68:71], v8 offset:14336
    s_add_u32 s36, s40, 6
    s_mov_b32 s39, 110592
    s_mul_i32 s38, s36, 40960
    s_add_u32 m0, s39, s42
    s_nop 0
    buffer_load_dwordx4 v28, s[8:11], s38 offen offset:0 sc1 lds
    buffer_load_dwordx4 v28, s[8:11], s38 offen offset:1024 sc1 lds
    buffer_load_dwordx4 v28, s[8:11], s38 offen offset:2048 sc1 lds
    buffer_load_dwordx4 v28, s[8:11], s38 offen offset:3072 sc1 lds
    s_add_u32 m0, m0, 4096
    s_nop 0
    buffer_load_dwordx4 v29, s[8:11], s38 offen sc1 lds
    v_add_u32 v4, s48, v4
    v_add_u32 v5, s48, v5
    v_add_u32 v6, s48, v6
    v_add_u32 v7, s48, v7
    v_add_u32 v8, s48, v8
    v_add_u32 v9, s48, v9
    v_add_u32 v10, s48, v10
    v_add_u32 v11, s48, v11
    v_add_u32 v12, s48, v12
    s_waitcnt lgkmcnt(0) vmcnt(38)
    s_barrier
    v_mfma_f32_16x16x32_bf16 v[92:95], a[16:19], a[12:15], 0
    ds_read_b128 a[88:91], v8 offset:0
    s_add_u32 s36, s40, 6
    s_mov_b32 s39, 110592
    v_mfma_f32_16x16x32_bf16 v[92:95], a[52:55], a[48:51], v[92:95]
    ds_read_b128 a[72:75], v4 offset:0
    s_lshl_b32 s37, s36, 10
    s_add_u32 m0, s39, s41
    v_mfma_f32_16x16x32_bf16 v[96:99], a[56:59], a[48:51], 0
    buffer_load_dwordx4 v26, s[12:15], s37 offen offset:0 sc1 lds
    v_mfma_f32_16x16x32_bf16 v[96:99], a[20:23], a[12:15], v[96:99]
    ds_read_b128 a[76:79], v5 offset:0
    v_mfma_f32_16x16x32_bf16 v[100:103], a[24:27], a[12:15], 0
    ds_read_b128 a[80:83], v6 offset:0
    v_mfma_f32_16x16x32_bf16 v[100:103], a[60:63], a[48:51], v[100:103]
    ds_read_b128 a[84:87], v7 offset:0
    v_mfma_f32_16x16x32_bf16 v[104:107], a[64:67], a[48:51], 0
    buffer_load_dwordx4 v26, s[12:15], s37 offen offset:1024 sc1 lds
    v_mfma_f32_16x16x32_bf16 v[104:107], a[28:31], a[12:15], v[104:107]
    ds_read_b128 a[92:95], v8 offset:1024
    v_mfma_f32_16x16x32_bf16 v[108:111], a[32:35], a[12:15], 0
    ds_read_b128 a[96:99], v8 offset:2048
    v_mfma_f32_16x16x32_bf16 v[108:111], a[68:71], a[48:51], v[108:111]
    ds_read_b128 a[100:103], v8 offset:3072
    v_mfma_f32_16x16x32_bf16 v[88:91], a[68:71], a[44:47], 0
    v_mfma_f32_16x16x32_bf16 v[88:91], a[32:35], a[8:11], v[88:91]
    ds_read_b128 a[104:107], v8 offset:4096
    v_mfma_f32_16x16x32_bf16 v[84:87], a[28:31], a[8:11], 0
    buffer_load_dwordx4 v27, s[12:15], s37 offen offset:2048 sc1 lds
    v_mfma_f32_16x16x32_bf16 v[84:87], a[64:67], a[44:47], v[84:87]
    buffer_load_dwordx4 v27, s[12:15], s37 offen offset:3072 sc1 lds
    s_add_u32 s36, s40, 8
    s_mov_b32 s39, 0
    v_mfma_f32_16x16x32_bf16 v[80:83], a[60:63], a[44:47], 0
    s_lshl_b32 s37, s36, 10
    s_add_u32 m0, s39, s41
    v_mfma_f32_16x16x32_bf16 v[80:83], a[24:27], a[8:11], v[80:83]
    buffer_load_dwordx4 v26, s[12:15], s37 offen offset:0 sc1 lds
    v_mfma_f32_16x16x32_bf16 v[76:79], a[20:23], a[8:11], 0
    v_mfma_f32_16x16x32_bf16 v[76:79], a[56:59], a[44:47], v[76:79]
    buffer_load_dwordx4 v26, s[12:15], s37 offen offset:1024 sc1 lds
    v_mfma_f32_16x16x32_bf16 v[72:75], a[52:55], a[44:47], 0
    buffer_load_dwordx4 v27, s[12:15], s37 offen offset:2048 sc1 lds
    v_mfma_f32_16x16x32_bf16 v[72:75], a[16:19], a[8:11], v[72:75]
    s_waitcnt vmcnt(12)
    v_mov_b32 v14, 1
    s_mov_b64 exec, 1
    global_store_dword v1, v14, s[52:53] sc1
    s_mov_b64 exec, -1
    v_mfma_f32_16x16x32_bf16 v[52:55], a[16:19], a[4:7], 0
    ds_read_b128 a[124:127], v8 offset:10240
    v_mfma_f32_16x16x32_bf16 v[52:55], a[52:55], a[40:43], v[52:55]
    ds_read_b128 a[108:111], v4 offset:1024
    v_mfma_f32_16x16x32_bf16 v[56:59], a[56:59], a[40:43], 0
    buffer_load_dwordx4 v27, s[12:15], s37 offen offset:3072 sc1 lds
    v_mfma_f32_16x16x32_bf16 v[56:59], a[20:23], a[4:7], v[56:59]
    ds_read_b128 a[112:115], v5 offset:1024
    v_mfma_f32_16x16x32_bf16 v[60:63], a[24:27], a[4:7], 0
    ds_read_b128 a[116:119], v6 offset:1024
    v_mfma_f32_16x16x32_bf16 v[60:63], a[60:63], a[40:43], v[60:63]
    ds_read_b128 a[120:123], v7 offset:1024
    s_mul_i32 s38, s36, 40960
    s_add_u32 m0, s39, s42
    v_mfma_f32_16x16x32_bf16 v[64:67], a[64:67], a[40:43], 0
    buffer_load_dwordx4 v28, s[8:11], s38 offen offset:0 sc1 lds
    v_mfma_f32_16x16x32_bf16 v[64:67], a[28:31], a[4:7], v[64:67]
    ds_read_b128 a[128:131], v8 offset:11264
    v_mfma_f32_16x16x32_bf16 v[68:71], a[32:35], a[4:7], 0
    ds_read_b128 a[132:135], v8 offset:12288
    v_mfma_f32_16x16x32_bf16 v[68:71], a[68:71], a[40:43], v[68:71]
    ds_read_b128 a[136:139], v8 offset:13312
    v_mfma_f32_16x16x32_bf16 v[48:51], a[68:71], a[36:39], 0
    v_mfma_f32_16x16x32_bf16 v[48:51], a[32:35], a[0:3], v[48:51]
    ds_read_b128 a[140:143], v8 offset:14336
    v_mfma_f32_16x16x32_bf16 v[44:47], a[28:31], a[0:3], 0
    buffer_load_dwordx4 v28, s[8:11], s38 offen offset:1024 sc1 lds
    v_add_u32 v4, s48, v4
    v_add_u32 v5, s48, v5
    v_mfma_f32_16x16x32_bf16 v[44:47], a[64:67], a[36:39], v[44:47]
    v_add_u32 v6, s48, v6
    v_mfma_f32_16x16x32_bf16 v[40:43], a[60:63], a[36:39], 0
    buffer_load_dwordx4 v28, s[8:11], s38 offen offset:2048 sc1 lds
    v_add_u32 v7, s48, v7
    v_mfma_f32_16x16x32_bf16 v[40:43], a[24:27], a[0:3], v[40:43]
    buffer_load_dwordx4 v28, s[8:11], s38 offen offset:3072 sc1 lds
    v_add_u32 v8, s48, v8
    v_add_u32 v9, s48, v9
    v_mfma_f32_16x16x32_bf16 v[36:39], a[20:23], a[0:3], 0
    s_add_u32 m0, m0, 4096
    v_add_u32 v10, s48, v10
    v_mfma_f32_16x16x32_bf16 v[36:39], a[56:59], a[36:39], v[36:39]
    buffer_load_dwordx4 v29, s[8:11], s38 offen sc1 lds
    v_add_u32 v11, s48, v11
    v_mfma_f32_16x16x32_bf16 v[32:35], a[52:55], a[36:39], 0
    v_add_u32 v12, s48, v12
    v_mfma_f32_16x16x32_bf16 v[32:35], a[16:19], a[0:3], v[32:35]
    s_waitcnt lgkmcnt(0)
    s_barrier
    v_mfma_f32_16x16x32_bf16 v[92:95], a[88:91], a[84:87], v[92:95]
    ds_read_b128 a[16:19], v8 offset:0
    s_add_u32 s36, s40, 10
    s_mov_b32 s39, 36864
    v_mfma_f32_16x16x32_bf16 v[92:95], a[124:127], a[120:123], v[92:95]
    ds_read2_b64 a[0:3], v9 offset0:0 offset1:64
    s_lshl_b32 s37, s36, 10
    s_add_u32 m0, s39, s41
    v_mfma_f32_16x16x32_bf16 v[96:99], a[128:131], a[120:123], v[96:99]
    buffer_load_dwordx4 v26, s[12:15], s37 offen offset:0 sc1 lds
    v_mfma_f32_16x16x32_bf16 v[96:99], a[92:95], a[84:87], v[96:99]
    ds_read2_b64 a[4:7], v10 offset0:0 offset1:64
    v_mfma_f32_16x16x32_bf16 v[100:103], a[96:99], a[84:87], v[100:103]
    ds_read2_b64 a[8:11], v11 offset0:0 offset1:64
    v_mfma_f32_16x16x32_bf16 v[100:103], a[132:135], a[120:123], v[100:103]
    ds_read2_b64 a[12:15], v12 offset0:0 offset1:64
    v_mfma_f32_16x16x32_bf16 v[104:107], a[136:139], a[120:123], v[104:107]
    v_mfma_f32_16x16x32_bf16 v[104:107], a[100:103], a[84:87], v[104:107]
    ds_read_b128 a[20:23], v8 offset:1024
    v_mfma_f32_16x16x32_bf16 v[108:111], a[104:107], a[84:87], v[108:111]
    ds_read_b128 a[24:27], v8 offset:2048
    v_mfma_f32_16x16x32_bf16 v[108:111], a[140:143], a[120:123], v[108:111]
    ds_read_b128 a[28:31], v8 offset:3072
    v_mfma_f32_16x16x32_bf16 v[88:91], a[140:143], a[116:119], v[88:91]
    buffer_load_dwordx4 v26, s[12:15], s37 offen offset:1024 sc1 lds
    v_mfma_f32_16x16x32_bf16 v[88:91], a[104:107], a[80:83], v[88:91]
    ds_read_b128 a[32:35], v8 offset:4096
    v_mfma_f32_16x16x32_bf16 v[84:87], a[100:103], a[80:83], v[84:87]
    v_mfma_f32_16x16x32_bf16 v[84:87], a[136:139], a[116:119], v[84:87]
    buffer_load_dwordx4 v27, s[12:15], s37 offen offset:2048 sc1 lds
    v_mfma_f32_16x16x32_bf16 v[80:83], a[132:135], a[116:119], v[80:83]
    v_mfma_f32_16x16x32_bf16 v[80:83], a[96:99], a[80:83], v[80:83]
    v_mfma_f32_16x16x32_bf16 v[76:79], a[92:95], a[80:83], v[76:79]
    buffer_load_dwordx4 v27, s[12:15], s37 offen offset:3072 sc1 lds
    v_mfma_f32_16x16x32_bf16 v[76:79], a[128:131], a[116:119], v[76:79]
    s_mul_i32 s38, s36, 40960
    s_add_u32 m0, s39, s42
    v_mfma_f32_16x16x32_bf16 v[72:75], a[124:127], a[116:119], v[72:75]
    buffer_load_dwordx4 v28, s[8:11], s38 offen offset:0 sc1 lds
    v_mfma_f32_16x16x32_bf16 v[72:75], a[88:91], a[80:83], v[72:75]
    v_mfma_f32_16x16x32_bf16 v[52:55], a[88:91], a[76:79], v[52:55]
    ds_read_b128 a[52:55], v8 offset:10240
    v_mfma_f32_16x16x32_bf16 v[52:55], a[124:127], a[112:115], v[52:55]
    ds_read_b128 a[36:39], v4 offset:1024
    v_mfma_f32_16x16x32_bf16 v[56:59], a[128:131], a[112:115], v[56:59]
    buffer_load_dwordx4 v28, s[8:11], s38 offen offset:1024 sc1 lds
    v_mfma_f32_16x16x32_bf16 v[56:59], a[92:95], a[76:79], v[56:59]
    ds_read_b128 a[40:43], v5 offset:1024
    v_mfma_f32_16x16x32_bf16 v[60:63], a[96:99], a[76:79], v[60:63]
    ds_read_b128 a[44:47], v6 offset:1024
    v_mfma_f32_16x16x32_bf16 v[60:63], a[132:135], a[112:115], v[60:63]
    ds_read_b128 a[48:51], v7 offset:1024
    v_mfma_f32_16x16x32_bf16 v[64:67], a[136:139], a[112:115], v[64:67]
    v_mfma_f32_16x16x32_bf16 v[64:67], a[100:103], a[76:79], v[64:67]
    ds_read_b128 a[56:59], v8 offset:11264
    v_mfma_f32_16x16x32_bf16 v[68:71], a[104:107], a[76:79], v[68:71]
    ds_read_b128 a[60:63], v8 offset:12288
    v_mfma_f32_16x16x32_bf16 v[68:71], a[140:143], a[112:115], v[68:71]
    ds_read_b128 a[64:67], v8 offset:13312
    v_mfma_f32_16x16x32_bf16 v[48:51], a[140:143], a[108:111], v[48:51]
    v_mfma_f32_16x16x32_bf16 v[48:51], a[104:107], a[72:75], v[48:51]
    ds_read_b128 a[68:71], v8 offset:14336
    v_mfma_f32_16x16x32_bf16 v[44:47], a[100:103], a[72:75], v[44:47]
    buffer_load_dwordx4 v28, s[8:11], s38 offen offset:2048 sc1 lds
    v_add_u32 v4, s48, v4
    v_add_u32 v5, s48, v5
    v_mfma_f32_16x16x32_bf16 v[44:47], a[136:139], a[108:111], v[44:47]
    v_add_u32 v6, s48, v6
    v_mfma_f32_16x16x32_bf16 v[40:43], a[132:135], a[108:111], v[40:43]
    buffer_load_dwordx4 v28, s[8:11], s38 offen offset:3072 sc1 lds
    v_add_u32 v7, s48, v7
    v_mfma_f32_16x16x32_bf16 v[40:43], a[96:99], a[72:75], v[40:43]
    s_add_u32 m0, m0, 4096
    v_add_u32 v8, s48, v8
    v_add_u32 v9, s48, v9
    v_mfma_f32_16x16x32_bf16 v[36:39], a[92:95], a[72:75], v[36:39]
    buffer_load_dwordx4 v29, s[8:11], s38 offen sc1 lds
    v_add_u32 v10, s48, v10
    v_mfma_f32_16x16x32_bf16 v[36:39], a[128:131], a[108:111], v[36:39]
    v_add_u32 v11, s48, v11
    v_mfma_f32_16x16x32_bf16 v[32:35], a[124:127], a[108:111], v[32:35]
    v_add_u32 v12, s48, v12
    v_mfma_f32_16x16x32_bf16 v[32:35], a[88:91], a[72:75], v[32:35]
    s_waitcnt lgkmcnt(0) vmcnt(19)
    s_barrier
    v_mfma_f32_16x16x32_bf16 v[92:95], a[16:19], a[12:15], v[92:95]
    ds_read_b128 a[88:91], v8 offset:0
    s_add_u32 s36, s43, 0
    s_xor_b32 s36, s36, s58
    s_mov_b32 s39, 73728
    v_mfma_f32_16x16x32_bf16 v[92:95], a[52:55], a[48:51], v[92:95]
    ds_read_b128 a[72:75], v4 offset:0
    s_mul_i32 s38, s36, 40960
    s_add_u32 m0, s39, s42
    v_mfma_f32_16x16x32_bf16 v[96:99], a[56:59], a[48:51], v[96:99]
    buffer_load_dwordx4 v28, s[8:11], s38 offen offset:0 sc1 lds
    v_mfma_f32_16x16x32_bf16 v[96:99], a[20:23], a[12:15], v[96:99]
    ds_read_b128 a[76:79], v5 offset:0
    v_mfma_f32_16x16x32_bf16 v[100:103], a[24:27], a[12:15], v[100:103]
    ds_read_b128 a[80:83], v6 offset:0
    v_mfma_f32_16x16x32_bf16 v[100:103], a[60:63], a[48:51], v[100:103]
    ds_read_b128 a[84:87], v7 offset:0
    v_mfma_f32_16x16x32_bf16 v[104:107], a[64:67], a[48:51], v[104:107]
    v_mfma_f32_16x16x32_bf16 v[104:107], a[28:31], a[12:15], v[104:107]
    ds_read_b128 a[92:95], v8 offset:1024
    v_mfma_f32_16x16x32_bf16 v[108:111], a[32:35], a[12:15], v[108:111]
    ds_read_b128 a[96:99], v8 offset:2048
    v_mfma_f32_16x16x32_bf16 v[108:111], a[68:71], a[48:51], v[108:111]
    ds_read_b128 a[100:103], v8 offset:3072
    v_mfma_f32_16x16x32_bf16 v[88:91], a[68:71], a[44:47], v[88:91]
    v_mfma_f32_16x16x32_bf16 v[88:91], a[32:35], a[8:11], v[88:91]
    ds_read_b128 a[104:107], v8 offset:4096
    v_mfma_f32_16x16x32_bf16 v[84:87], a[28:31], a[8:11], v[84:87]
    v_mfma_f32_16x16x32_bf16 v[84:87], a[64:67], a[44:47], v[84:87]
    buffer_load_dwordx4 v28, s[8:11], s38 offen offset:1024 sc1 lds
    v_mfma_f32_16x16x32_bf16 v[80:83], a[60:63], a[44:47], v[80:83]
    v_mfma_f32_16x16x32_bf16 v[80:83], a[24:27], a[8:11], v[80:83]
    v_mfma_f32_16x16x32_bf16 v[76:79], a[20:23], a[8:11], v[76:79]
    v_mfma_f32_16x16x32_bf16 v[76:79], a[56:59], a[44:47], v[76:79]
    buffer_load_dwordx4 v28, s[8:11], s38 offen offset:2048 sc1 lds
    v_mfma_f32_16x16x32_bf16 v[72:75], a[52:55], a[44:47], v[72:75]
    v_mfma_f32_16x16x32_bf16 v[72:75], a[16:19], a[8:11], v[72:75]
    v_mfma_f32_16x16x32_bf16 v[52:55], a[16:19], a[4:7], v[52:55]
    ds_read_b128 a[124:127], v8 offset:10240
    global_load_dword v15, v2, s[52:53] sc1
    v_mfma_f32_16x16x32_bf16 v[52:55], a[52:55], a[40:43], v[52:55]
    ds_read2_b64 a[108:111], v9 offset0:128 offset1:192
    v_mfma_f32_16x16x32_bf16 v[56:59], a[56:59], a[40:43], v[56:59]
    v_mfma_f32_16x16x32_bf16 v[56:59], a[20:23], a[4:7], v[56:59]
    ds_read2_b64 a[112:115], v10 offset0:128 offset1:192
    v_mfma_f32_16x16x32_bf16 v[60:63], a[24:27], a[4:7], v[60:63]
    ds_read2_b64 a[116:119], v11 offset0:128 offset1:192
    v_mfma_f32_16x16x32_bf16 v[60:63], a[60:63], a[40:43], v[60:63]
    ds_read2_b64 a[120:123], v12 offset0:128 offset1:192
    v_mfma_f32_16x16x32_bf16 v[64:67], a[64:67], a[40:43], v[64:67]
    buffer_load_dwordx4 v28, s[8:11], s38 offen offset:3072 sc1 lds
    v_mfma_f32_16x16x32_bf16 v[64:67], a[28:31], a[4:7], v[64:67]
    ds_read_b128 a[128:131], v8 offset:11264
    v_mfma_f32_16x16x32_bf16 v[68:71], a[32:35], a[4:7], v[68:71]
    ds_read_b128 a[132:135], v8 offset:12288
    v_mfma_f32_16x16x32_bf16 v[68:71], a[68:71], a[40:43], v[68:71]
    ds_read_b128 a[136:139], v8 offset:13312
    v_mfma_f32_16x16x32_bf16 v[48:51], a[68:71], a[36:39], v[48:51]
    v_mfma_f32_16x16x32_bf16 v[48:51], a[32:35], a[0:3], v[48:51]
    ds_read_b128 a[140:143], v8 offset:14336
    v_mfma_f32_16x16x32_bf16 v[44:47], a[28:31], a[0:3], v[44:47]
    v_add_u32 v4, s49, v4
    v_add_u32 v5, s49, v5
    v_mfma_f32_16x16x32_bf16 v[44:47], a[64:67], a[36:39], v[44:47]
    s_add_u32 m0, m0, 4096
    v_add_u32 v6, s49, v6
    v_mfma_f32_16x16x32_bf16 v[40:43], a[60:63], a[36:39], v[40:43]
    buffer_load_dwordx4 v29, s[8:11], s38 offen sc1 lds
    v_add_u32 v7, s49, v7
    v_mfma_f32_16x16x32_bf16 v[40:43], a[24:27], a[0:3], v[40:43]
    v_add_u32 v8, s49, v8
    v_add_u32 v9, s49, v9
    v_mfma_f32_16x16x32_bf16 v[36:39], a[20:23], a[0:3], v[36:39]
    v_add_u32 v10, s49, v10
    v_mfma_f32_16x16x32_bf16 v[36:39], a[56:59], a[36:39], v[36:39]
    v_add_u32 v11, s49, v11
    v_mfma_f32_16x16x32_bf16 v[32:35], a[52:55], a[36:39], v[32:35]
    v_add_u32 v12, s49, v12
    v_mfma_f32_16x16x32_bf16 v[32:35], a[16:19], a[0:3], v[32:35]
    s_waitcnt vmcnt(2)
    v_cmp_ne_u32 vcc, 0, v15
    s_cmp_eq_u64 vcc, exec
    s_cbranch_scc1 K2_PO_OK
    s_mov_b32 s33, 65536
    s_mov_b64 exec, -1
K2_PO:
    global_load_dword v15, v2, s[52:53] sc1
    s_waitcnt vmcnt(0)
    v_cmp_ne_u32 vcc, 0, v15
    s_cmp_eq_u64 vcc, exec
    s_cbranch_scc1 K2_PO_OK
    s_sleep 1
    s_sub_u32 s33, s33, 1
    s_cmp_lg_u32 s33, 0
    s_cbranch_scc1 K2_PO
K2_PO_OK:
    s_mov_b64 exec, -1
    s_waitcnt lgkmcnt(0)
    s_barrier
    v_mfma_f32_16x16x32_bf16 v[92:95], a[88:91], a[84:87], v[92:95]
    ds_read_b128 a[16:19], v8 offset:0
    s_add_u32 s36, s43, 0
    s_xor_b32 s36, s36, s58
    s_mov_b32 s39, 73728
    v_mfma_f32_16x16x32_bf16 v[92:95], a[124:127], a[120:123], v[92:95]
    ds_read_b128 a[0:3], v4 offset:0
    s_lshl_b32 s37, s36, 10
    s_add_u32 m0, s39, s41
    v_mfma_f32_16x16x32_bf16 v[96:99], a[128:131], a[120:123], v[96:99]
    buffer_load_dwordx4 v26, s[12:15], s37 offen offset:0 sc1 lds
    v_mfma_f32_16x16x32_bf16 v[96:99], a[92:95], a[84:87], v[96:99]
    ds_read_b128 a[4:7], v5 offset:0
    v_mfma_f32_16x16x32_bf16 v[100:103], a[96:99], a[84:87], v[100:103]
    ds_read_b128 a[8:11], v6 offset:0
    v_mfma_f32_16x16x32_bf16 v[100:103], a[132:135], a[120:123], v[100:103]
    ds_read_b128 a[12:15], v7 offset:0
    v_mfma_f32_16x16x32_bf16 v[104:107], a[136:139], a[120:123], v[104:107]
    buffer_load_dwordx4 v26, s[12:15], s37 offen offset:1024 sc1 lds
    v_mfma_f32_16x16x32_bf16 v[104:107], a[100:103], a[84:87], v[104:107]
    ds_read_b128 a[20:23], v8 offset:1024
    v_mfma_f32_16x16x32_bf16 v[108:111], a[104:107], a[84:87], v[108:111]
    ds_read_b128 a[24:27], v8 offset:2048
    v_mfma_f32_16x16x32_bf16 v[108:111], a[140:143], a[120:123], v[108:111]
    ds_read_b128 a[28:31], v8 offset:3072
    v_mfma_f32_16x16x32_bf16 v[88:91], a[140:143], a[116:119], v[88:91]
    v_mfma_f32_16x16x32_bf16 v[88:91], a[104:107], a[80:83], v[88:91]
    ds_read_b128 a[32:35], v8 offset:4096
    v_mfma_f32_16x16x32_bf16 v[84:87], a[100:103], a[80:83], v[84:87]
    buffer_load_dwordx4 v27, s[12:15], s37 offen offset:2048 sc1 lds
    s_add_u32 s36, s43, 2
    v_mfma_f32_16x16x32_bf16 v[84:87], a[136:139], a[116:119], v[84:87]
    buffer_load_dwordx4 v27, s[12:15], s37 offen offset:3072 sc1 lds
    s_xor_b32 s36, s36, s58
    s_mov_b32 s39, 110592
    v_mfma_f32_16x16x32_bf16 v[80:83], a[132:135], a[116:119], v[80:83]
    s_lshl_b32 s37, s36, 10
    s_add_u32 m0, s39, s41
    v_mfma_f32_16x16x32_bf16 v[80:83], a[96:99], a[80:83], v[80:83]
    buffer_load_dwordx4 v26, s[12:15], s37 offen offset:0 sc1 lds
    v_mfma_f32_16x16x32_bf16 v[76:79], a[92:95], a[80:83], v[76:79]
    v_mfma_f32_16x16x32_bf16 v[76:79], a[128:131], a[116:119], v[76:79]
    buffer_load_dwordx4 v26, s[12:15], s37 offen offset:1024 sc1 lds
    v_mfma_f32_16x16x32_bf16 v[72:75], a[124:127], a[116:119], v[72:75]
    buffer_load_dwordx4 v27, s[12:15], s37 offen offset:2048 sc1 lds
    v_mfma_f32_16x16x32_bf16 v[72:75], a[88:91], a[80:83], v[72:75]
    v_mfma_f32_16x16x32_bf16 v[52:55], a[88:91], a[76:79], v[52:55]
    ds_read_b128 a[52:55], v8 offset:10240
    v_mfma_f32_16x16x32_bf16 v[52:55], a[124:127], a[112:115], v[52:55]
    ds_read_b128 a[36:39], v4 offset:1024
    v_mfma_f32_16x16x32_bf16 v[56:59], a[128:131], a[112:115], v[56:59]
    buffer_load_dwordx4 v27, s[12:15], s37 offen offset:3072 sc1 lds
    v_mfma_f32_16x16x32_bf16 v[56:59], a[92:95], a[76:79], v[56:59]
    ds_read_b128 a[40:43], v5 offset:1024
    v_mfma_f32_16x16x32_bf16 v[60:63], a[96:99], a[76:79], v[60:63]
    ds_read_b128 a[44:47], v6 offset:1024
    v_mfma_f32_16x16x32_bf16 v[60:63], a[132:135], a[112:115], v[60:63]
    ds_read_b128 a[48:51], v7 offset:1024
    s_mul_i32 s38, s36, 40960
    s_add_u32 m0, s39, s42
    v_mfma_f32_16x16x32_bf16 v[64:67], a[136:139], a[112:115], v[64:67]
    buffer_load_dwordx4 v28, s[8:11], s38 offen offset:0 sc1 lds
    v_mfma_f32_16x16x32_bf16 v[64:67], a[100:103], a[76:79], v[64:67]
    ds_read_b128 a[56:59], v8 offset:11264
    v_mfma_f32_16x16x32_bf16 v[68:71], a[104:107], a[76:79], v[68:71]
    ds_read_b128 a[60:63], v8 offset:12288
    v_mfma_f32_16x16x32_bf16 v[68:71], a[140:143], a[112:115], v[68:71]
    ds_read_b128 a[64:67], v8 offset:13312
    v_mfma_f32_16x16x32_bf16 v[48:51], a[140:143], a[108:111], v[48:51]
    v_mfma_f32_16x16x32_bf16 v[48:51], a[104:107], a[72:75], v[48:51]
    ds_read_b128 a[68:71], v8 offset:14336
    v_mfma_f32_16x16x32_bf16 v[44:47], a[100:103], a[72:75], v[44:47]
    buffer_load_dwordx4 v28, s[8:11], s38 offen offset:1024 sc1 lds
    v_add_u32 v4, s48, v4
    v_add_u32 v5, s48, v5
    v_mfma_f32_16x16x32_bf16 v[44:47], a[136:139], a[108:111], v[44:47]
    v_add_u32 v6, s48, v6
    v_mfma_f32_16x16x32_bf16 v[40:43], a[132:135], a[108:111], v[40:43]
    buffer_load_dwordx4 v28, s[8:11], s38 offen offset:2048 sc1 lds
    v_add_u32 v7, s48, v7
    v_mfma_f32_16x16x32_bf16 v[40:43], a[96:99], a[72:75], v[40:43]
    buffer_load_dwordx4 v28, s[8:11], s38 offen offset:3072 sc1 lds
    v_add_u32 v8, s48, v8
    v_add_u32 v9, s48, v9
    v_mfma_f32_16x16x32_bf16 v[36:39], a[92:95], a[72:75], v[36:39]
    s_add_u32 m0, m0, 4096
    v_add_u32 v10, s48, v10
    v_mfma_f32_16x16x32_bf16 v[36:39], a[128:131], a[108:111], v[36:39]
    buffer_load_dwordx4 v29, s[8:11], s38 offen sc1 lds
    v_add_u32 v11, s48, v11
    v_mfma_f32_16x16x32_bf16 v[32:35], a[124:127], a[108:111], v[32:35]
    v_add_u32 v12, s48, v12
    v_mfma_f32_16x16x32_bf16 v[32:35], a[88:91], a[72:75], v[32:35]
    s_waitcnt lgkmcnt(0)
    s_barrier
    v_mfma_f32_16x16x32_bf16 v[92:95], a[16:19], a[12:15], v[92:95]
    ds_read_b128 a[88:91], v8 offset:0
    s_add_u32 s36, s43, 4
    s_xor_b32 s36, s36, s58
    s_mov_b32 s39, 0
    v_mfma_f32_16x16x32_bf16 v[92:95], a[52:55], a[48:51], v[92:95]
    ds_read2_b64 a[72:75], v9 offset0:0 offset1:64
    s_lshl_b32 s37, s36, 10
    s_add_u32 m0, s39, s41
    v_mfma_f32_16x16x32_bf16 v[96:99], a[56:59], a[48:51], v[96:99]
    buffer_load_dwordx4 v26, s[12:15], s37 offen offset:0 sc1 lds
    v_mfma_f32_16x16x32_bf16 v[96:99], a[20:23], a[12:15], v[96:99]
    ds_read2_b64 a[76:79], v10 offset0:0 offset1:64
    v_mfma_f32_16x16x32_bf16 v[100:103], a[24:27], a[12:15], v[100:103]
    ds_read2_b64 a[80:83], v11 offset0:0 offset1:64
    v_mfma_f32_16x16x32_bf16 v[100:103], a[60:63], a[48:51], v[100:103]
    ds_read2_b64 a[84:87], v12 offset0:0 offset1:64
    v_mfma_f32_16x16x32_bf16 v[104:107], a[64:67], a[48:51], v[104:107]
    v_mfma_f32_16x16x32_bf16 v[104:107], a[28:31], a[12:15], v[104:107]
    ds_read_b128 a[92:95], v8 offset:1024
    v_mfma_f32_16x16x32_bf16 v[108:111], a[32:35], a[12:15], v[108:111]
    ds_read_b128 a[96:99], v8 offset:2048
    v_mfma_f32_16x16x32_bf16 v[108:111], a[68:71], a[48:51], v[108:111]
    ds_read_b128 a[100:103], v8 offset:3072
    v_mfma_f32_16x16x32_bf16 v[88:91], a[68:71], a[44:47], v[88:91]
    buffer_load_dwordx4 v26, s[12:15], s37 offen offset:1024 sc1 lds
    v_mfma_f32_16x16x32_bf16 v[88:91], a[32:35], a[8:11], v[88:91]
    ds_read_b128 a[104:107], v8 offset:4096
    v_mfma_f32_16x16x32_bf16 v[84:87], a[28:31], a[8:11], v[84:87]
    v_mfma_f32_16x16x32_bf16 v[84:87], a[64:67], a[44:47], v[84:87]
    buffer_load_dwordx4 v27, s[12:15], s37 offen offset:2048 sc1 lds
    v_mfma_f32_16x16x32_bf16 v[80:83], a[60:63], a[44:47], v[80:83]
    v_mfma_f32_16x16x32_bf16 v[80:83], a[24:27], a[8:11], v[80:83]
    v_mfma_f32_16x16x32_bf16 v[76:79], a[20:23], a[8:11], v[76:79]
    buffer_load_dwordx4 v27, s[12:15], s37 offen offset:3072 sc1 lds
    v_mfma_f32_16x16x32_bf16 v[76:79], a[56:59], a[44:47], v[76:79]
    s_mul_i32 s38, s36, 40960
    s_add_u32 m0, s39, s42
    v_mfma_f32_16x16x32_bf16 v[72:75], a[52:55], a[44:47], v[72:75]
    buffer_load_dwordx4 v28, s[8:11], s38 offen offset:0 sc1 lds
    v_mfma_f32_16x16x32_bf16 v[72:75], a[16:19], a[8:11], v[72:75]
    v_mfma_f32_16x16x32_bf16 v[52:55], a[16:19], a[4:7], v[52:55]
    ds_read_b128 a[124:127], v8 offset:10240
    v_mfma_f32_16x16x32_bf16 v[52:55], a[52:55], a[40:43], v[52:55]
    ds_read_b128 a[108:111], v4 offset:1024
    v_mfma_f32_16x16x32_bf16 v[56:59], a[56:59], a[40:43], v[56:59]
    buffer_load_dwordx4 v28, s[8:11], s38 offen offset:1024 sc1 lds
    v_mfma_f32_16x16x32_bf16 v[56:59], a[20:23], a[4:7], v[56:59]
    ds_read_b128 a[112:115], v5 offset:1024
    v_mfma_f32_16x16x32_bf16 v[60:63], a[24:27], a[4:7], v[60:63]
    ds_read_b128 a[116:119], v6 offset:1024
    v_mfma_f32_16x16x32_bf16 v[60:63], a[60:63], a[40:43], v[60:63]
    ds_read_b128 a[120:123], v7 offset:1024
    v_mfma_f32_16x16x32_bf16 v[64:67], a[64:67], a[40:43], v[64:67]
    v_mfma_f32_16x16x32_bf16 v[64:67], a[28:31], a[4:7], v[64:67]
    ds_read_b128 a[128:131], v8 offset:11264
    v_mfma_f32_16x16x32_bf16 v[68:71], a[32:35], a[4:7], v[68:71]
    ds_read_b128 a[132:135], v8 offset:12288
    v_mfma_f32_16x16x32_bf16 v[68:71], a[68:71], a[40:43], v[68:71]
    ds_read_b128 a[136:139], v8 offset:13312
    v_mfma_f32_16x16x32_bf16 v[48:51], a[68:71], a[36:39], v[48:51]
    v_mfma_f32_16x16x32_bf16 v[48:51], a[32:35], a[0:3], v[48:51]
    ds_read_b128 a[140:143], v8 offset:14336
    v_mfma_f32_16x16x32_bf16 v[44:47], a[28:31], a[0:3], v[44:47]
    buffer_load_dwordx4 v28, s[8:11], s38 offen offset:2048 sc1 lds
    v_add_u32 v4, s48, v4
    v_mfma_f32_16x16x32_bf16 v[44:47], a[64:67], a[36:39], v[44:47]
    v_add_u32 v5, s48, v5
    v_mfma_f32_16x16x32_bf16 v[40:43], a[60:63], a[36:39], v[40:43]
    buffer_load_dwordx4 v28, s[8:11], s38 offen offset:3072 sc1 lds
    v_add_u32 v6, s48, v6
    v_mfma_f32_16x16x32_bf16 v[40:43], a[24:27], a[0:3], v[40:43]
    s_add_u32 m0, m0, 4096
    v_mfma_f32_16x16x32_bf16 v[36:39], a[20:23], a[0:3], v[36:39]
    buffer_load_dwordx4 v29, s[8:11], s38 offen sc1 lds
    v_add_u32 v7, s48, v7
    v_mfma_f32_16x16x32_bf16 v[36:39], a[56:59], a[36:39], v[36:39]
    v_add_u32 v8, s48, v8
    v_mfma_f32_16x16x32_bf16 v[32:35], a[52:55], a[36:39], v[32:35]
    v_mfma_f32_16x16x32_bf16 v[32:35], a[16:19], a[0:3], v[32:35]
    s_waitcnt lgkmcnt(0) vmcnt(18)
    s_barrier
    v_mfma_f32_16x16x32_bf16 v[92:95], a[88:91], a[84:87], v[92:95]
    ds_read_b128 a[16:19], v8 offset:0
    s_add_u32 s36, s43, 6
    s_xor_b32 s36, s36, s58
    s_mov_b32 s39, 36864
    v_mfma_f32_16x16x32_bf16 v[92:95], a[124:127], a[120:123], v[92:95]
    ds_read_b128 a[0:3], v4 offset:0
    s_lshl_b32 s37, s36, 10
    s_add_u32 m0, s39, s41
    v_mfma_f32_16x16x32_bf16 v[96:99], a[128:131], a[120:123], v[96:99]
    buffer_load_dwordx4 v26, s[12:15], s37 offen offset:0 sc1 lds
    v_mfma_f32_16x16x32_bf16 v[96:99], a[92:95], a[84:87], v[96:99]
    ds_read_b128 a[4:7], v5 offset:0
    v_mfma_f32_16x16x32_bf16 v[100:103], a[96:99], a[84:87], v[100:103]
    ds_read_b128 a[8:11], v6 offset:0
    v_mfma_f32_16x16x32_bf16 v[100:103], a[132:135], a[120:123], v[100:103]
    ds_read_b128 a[12:15], v7 offset:0
    v_mfma_f32_16x16x32_bf16 v[104:107], a[136:139], a[120:123], v[104:107]
    v_mfma_f32_16x16x32_bf16 v[104:107], a[100:103], a[84:87], v[104:107]
    ds_read_b128 a[20:23], v8 offset:1024
    v_mfma_f32_16x16x32_bf16 v[108:111], a[104:107], a[84:87], v[108:111]
    ds_read_b128 a[24:27], v8 offset:2048
    v_mfma_f32_16x16x32_bf16 v[108:111], a[140:143], a[120:123], v[108:111]
    ds_read_b128 a[28:31], v8 offset:3072
    v_mfma_f32_16x16x32_bf16 v[88:91], a[140:143], a[116:119], v[88:91]
    buffer_load_dwordx4 v26, s[12:15], s37 offen offset:1024 sc1 lds
    v_mfma_f32_16x16x32_bf16 v[88:91], a[104:107], a[80:83], v[88:91]
    ds_read_b128 a[32:35], v8 offset:4096
    v_mfma_f32_16x16x32_bf16 v[84:87], a[100:103], a[80:83], v[84:87]
    v_mfma_f32_16x16x32_bf16 v[84:87], a[136:139], a[116:119], v[84:87]
    buffer_load_dwordx4 v27, s[12:15], s37 offen offset:2048 sc1 lds
    v_mfma_f32_16x16x32_bf16 v[80:83], a[132:135], a[116:119], v[80:83]
    v_mfma_f32_16x16x32_bf16 v[80:83], a[96:99], a[80:83], v[80:83]
    v_mfma_f32_16x16x32_bf16 v[76:79], a[92:95], a[80:83], v[76:79]
    buffer_load_dwordx4 v27, s[12:15], s37 offen offset:3072 sc1 lds
    v_mfma_f32_16x16x32_bf16 v[76:79], a[128:131], a[116:119], v[76:79]
    s_mul_i32 s38, s36, 40960
    s_add_u32 m0, s39, s42
    v_mfma_f32_16x16x32_bf16 v[72:75], a[124:127], a[116:119], v[72:75]
    buffer_load_dwordx4 v28, s[8:11], s38 offen offset:0 sc1 lds
    v_mfma_f32_16x16x32_bf16 v[72:75], a[88:91], a[80:83], v[72:75]
    v_mfma_f32_16x16x32_bf16 v[52:55], a[88:91], a[76:79], v[52:55]
    ds_read_b128 a[52:55], v8 offset:10240
    v_mfma_f32_16x16x32_bf16 v[52:55], a[124:127], a[112:115], v[52:55]
    ds_read_b128 a[36:39], v4 offset:1024
    v_mfma_f32_16x16x32_bf16 v[56:59], a[128:131], a[112:115], v[56:59]
    buffer_load_dwordx4 v28, s[8:11], s38 offen offset:1024 sc1 lds
    v_mfma_f32_16x16x32_bf16 v[56:59], a[92:95], a[76:79], v[56:59]
    ds_read_b128 a[40:43], v5 offset:1024
    v_mfma_f32_16x16x32_bf16 v[60:63], a[96:99], a[76:79], v[60:63]
    ds_read_b128 a[44:47], v6 offset:1024
    v_mfma_f32_16x16x32_bf16 v[60:63], a[132:135], a[112:115], v[60:63]
    ds_read_b128 a[48:51], v7 offset:1024
    v_mfma_f32_16x16x32_bf16 v[64:67], a[136:139], a[112:115], v[64:67]
    v_mfma_f32_16x16x32_bf16 v[64:67], a[100:103], a[76:79], v[64:67]
    ds_read_b128 a[56:59], v8 offset:11264
    v_mfma_f32_16x16x32_bf16 v[68:71], a[104:107], a[76:79], v[68:71]
    ds_read_b128 a[60:63], v8 offset:12288
    v_mfma_f32_16x16x32_bf16 v[68:71], a[140:143], a[112:115], v[68:71]
    ds_read_b128 a[64:67], v8 offset:13312
    v_mfma_f32_16x16x32_bf16 v[48:51], a[140:143], a[108:111], v[48:51]
    v_mfma_f32_16x16x32_bf16 v[48:51], a[104:107], a[72:75], v[48:51]
    ds_read_b128 a[68:71], v8 offset:14336
    v_mfma_f32_16x16x32_bf16 v[44:47], a[100:103], a[72:75], v[44:47]
    buffer_load_dwordx4 v28, s[8:11], s38 offen offset:2048 sc1 lds
    v_add_u32 v4, s48, v4
    v_mfma_f32_16x16x32_bf16 v[44:47], a[136:139], a[108:111], v[44:47]
    v_add_u32 v5, s48, v5
    v_mfma_f32_16x16x32_bf16 v[40:43], a[132:135], a[108:111], v[40:43]
    buffer_load_dwordx4 v28, s[8:11], s38 offen offset:3072 sc1 lds
    v_add_u32 v6, s48, v6
    v_mfma_f32_16x16x32_bf16 v[40:43], a[96:99], a[72:75], v[40:43]
    s_add_u32 m0, m0, 4096
    v_mfma_f32_16x16x32_bf16 v[36:39], a[92:95], a[72:75], v[36:39]
    buffer_load_dwordx4 v29, s[8:11], s38 offen sc1 lds
    v_add_u32 v7, s48, v7
    v_mfma_f32_16x16x32_bf16 v[36:39], a[128:131], a[108:111], v[36:39]
    v_add_u32 v8, s48, v8
    v_mfma_f32_16x16x32_bf16 v[32:35], a[124:127], a[108:111], v[32:35]
    v_mfma_f32_16x16x32_bf16 v[32:35], a[88:91], a[72:75], v[32:35]
    s_waitcnt lgkmcnt(0) vmcnt(18)
    s_barrier
    v_mfma_f32_16x16x32_bf16 v[172:175], a[16:19], a[12:15], 0
    ds_read_b128 a[88:91], v8 offset:0
    s_add_u32 s36, s43, 8
    s_xor_b32 s36, s36, s58
    s_mov_b32 s39, 73728
    v_cvt_pk_bf16_f32 v212, v92, v93
    v_mfma_f32_16x16x32_bf16 v[172:175], a[52:55], a[48:51], v[172:175]
    ds_read_b128 a[72:75], v4 offset:0
    s_lshl_b32 s37, s36, 10
    s_add_u32 m0, s39, s41
    v_cvt_pk_bf16_f32 v213, v94, v95
    v_mfma_f32_16x16x32_bf16 v[176:179], a[56:59], a[48:51], 0
    buffer_load_dwordx4 v26, s[12:15], s37 offen offset:0 sc1 lds
    v_cvt_pk_bf16_f32 v214, v96, v97
    v_mfma_f32_16x16x32_bf16 v[176:179], a[20:23], a[12:15], v[176:179]
    ds_read_b128 a[76:79], v5 offset:0
    v_cvt_pk_bf16_f32 v215, v98, v99
    v_mfma_f32_16x16x32_bf16 v[180:183], a[24:27], a[12:15], 0
    ds_read_b128 a[80:83], v6 offset:0
    v_cvt_pk_bf16_f32 v216, v100, v101
    v_mfma_f32_16x16x32_bf16 v[180:183], a[60:63], a[48:51], v[180:183]
    ds_read_b128 a[84:87], v7 offset:0
    v_cvt_pk_bf16_f32 v217, v102, v103
    v_mfma_f32_16x16x32_bf16 v[184:187], a[64:67], a[48:51], 0
    buffer_load_dwordx4 v26, s[12:15], s37 offen offset:1024 sc1 lds
    v_cvt_pk_bf16_f32 v218, v104, v105
    v_mfma_f32_16x16x32_bf16 v[184:187], a[28:31], a[12:15], v[184:187]
    ds_read_b128 a[92:95], v8 offset:1024
    v_cvt_pk_bf16_f32 v219, v106, v107
    v_mfma_f32_16x16x32_bf16 v[188:191], a[32:35], a[12:15], 0
    ds_read_b128 a[96:99], v8 offset:2048
    v_cvt_pk_bf16_f32 v220, v108, v109
    v_mfma_f32_16x16x32_bf16 v[188:191], a[68:71], a[48:51], v[188:191]
    ds_read_b128 a[100:103], v8 offset:3072
    v_cvt_pk_bf16_f32 v221, v110, v111
    v_mfma_f32_16x16x32_bf16 v[168:171], a[68:71], a[44:47], 0
    v_cvt_pk_bf16_f32 v202, v72, v73
    v_mfma_f32_16x16x32_bf16 v[168:171], a[32:35], a[8:11], v[168:171]
    ds_read_b128 a[104:107], v8 offset:4096
    v_cvt_pk_bf16_f32 v203, v74, v75
    v_mfma_f32_16x16x32_bf16 v[164:167], a[28:31], a[8:11], 0
    buffer_load_dwordx4 v27, s[12:15], s37 offen offset:2048 sc1 lds
    v_cvt_pk_bf16_f32 v204, v76, v77
    v_mfma_f32_16x16x32_bf16 v[164:167], a[64:67], a[44:47], v[164:167]
    v_cvt_pk_bf16_f32 v205, v78, v79
    v_mfma_f32_16x16x32_bf16 v[160:163], a[60:63], a[44:47], 0
    buffer_load_dwordx4 v27, s[12:15], s37 offen offset:3072 sc1 lds
    v_cvt_pk_bf16_f32 v206, v80, v81
    v_mfma_f32_16x16x32_bf16 v[160:163], a[24:27], a[8:11], v[160:163]
    s_mul_i32 s38, s36, 40960
    s_add_u32 m0, s39, s42
    v_cvt_pk_bf16_f32 v207, v82, v83
    v_mfma_f32_16x16x32_bf16 v[156:159], a[20:23], a[8:11], 0
    buffer_load_dwordx4 v28, s[8:11], s38 offen offset:0 sc1 lds
    v_cvt_pk_bf16_f32 v208, v84, v85
    v_mfma_f32_16x16x32_bf16 v[156:159], a[56:59], a[44:47], v[156:159]
    buffer_load_dwordx4 v28, s[8:11], s38 offen offset:1024 sc1 lds
    v_cvt_pk_bf16_f32 v209, v86, v87
    v_mfma_f32_16x16x32_bf16 v[152:155], a[52:55], a[44:47], 0
    v_cvt_pk_bf16_f32 v210, v88, v89
    v_mfma_f32_16x16x32_bf16 v[152:155], a[16:19], a[8:11], v[152:155]
    buffer_load_dwordx4 v28, s[8:11], s38 offen offset:2048 sc1 lds
    v_cvt_pk_bf16_f32 v211, v90, v91
    v_mfma_f32_16x16x32_bf16 v[132:135], a[16:19], a[4:7], 0
    ds_read_b128 a[124:127], v8 offset:10240
    v_cvt_pk_bf16_f32 v192, v52, v53
    v_mfma_f32_16x16x32_bf16 v[132:135], a[52:55], a[40:43], v[132:135]
    ds_read_b128 a[108:111], v4 offset:1024
    v_cvt_pk_bf16_f32 v193, v54, v55
    v_mfma_f32_16x16x32_bf16 v[136:139], a[56:59], a[40:43], 0
    v_cvt_pk_bf16_f32 v194, v56, v57
    v_mfma_f32_16x16x32_bf16 v[136:139], a[20:23], a[4:7], v[136:139]
    ds_read_b128 a[112:115], v5 offset:1024
    v_cvt_pk_bf16_f32 v195, v58, v59
    v_mfma_f32_16x16x32_bf16 v[140:143], a[24:27], a[4:7], 0
    ds_read_b128 a[116:119], v6 offset:1024
    v_cvt_pk_bf16_f32 v196, v60, v61
    v_mfma_f32_16x16x32_bf16 v[140:143], a[60:63], a[40:43], v[140:143]
    ds_read_b128 a[120:123], v7 offset:1024
    v_cvt_pk_bf16_f32 v197, v62, v63
    v_mfma_f32_16x16x32_bf16 v[144:147], a[64:67], a[40:43], 0
    buffer_load_dwordx4 v28, s[8:11], s38 offen offset:3072 sc1 lds
    v_cvt_pk_bf16_f32 v198, v64, v65
    v_mfma_f32_16x16x32_bf16 v[144:147], a[28:31], a[4:7], v[144:147]
    ds_read_b128 a[128:131], v8 offset:11264
    v_cvt_pk_bf16_f32 v199, v66, v67
    v_mfma_f32_16x16x32_bf16 v[148:151], a[32:35], a[4:7], 0
    ds_read_b128 a[132:135], v8 offset:12288
    v_cvt_pk_bf16_f32 v200, v68, v69
    v_mfma_f32_16x16x32_bf16 v[148:151], a[68:71], a[40:43], v[148:151]
    ds_read_b128 a[136:139], v8 offset:13312
    v_cvt_pk_bf16_f32 v201, v70, v71
    v_mfma_f32_16x16x32_bf16 v[128:131], a[68:71], a[36:39], 0
    v_mfma_f32_16x16x32_bf16 v[128:131], a[32:35], a[0:3], v[128:131]
    ds_read_b128 a[140:143], v8 offset:14336
    s_add_u32 m0, m0, 4096
    v_mfma_f32_16x16x32_bf16 v[124:127], a[28:31], a[0:3], 0
    buffer_load_dwordx4 v29, s[8:11], s38 offen sc1 lds
    s_add_u32 s34, s47, 12800
    v_add_u32 v4, s49, v4
    v_mfma_f32_16x16x32_bf16 v[124:127], a[64:67], a[36:39], v[124:127]
    buffer_store_dwordx4 v[212:215], v16, s[4:7], s34 offen sc1
    v_add_u32 v5, s49, v5
    v_mfma_f32_16x16x32_bf16 v[120:123], a[60:63], a[36:39], 0
    v_add_u32 v6, s49, v6
    v_mfma_f32_16x16x32_bf16 v[120:123], a[24:27], a[0:3], v[120:123]
    buffer_store_dwordx4 v[216:219], v16, s[4:7], s34 offen offset:1024 sc1
    v_mfma_f32_16x16x32_bf16 v[116:119], a[20:23], a[0:3], 0
    v_add_u32 v7, s49, v7
    v_mfma_f32_16x16x32_bf16 v[116:119], a[56:59], a[36:39], v[116:119]
    buffer_store_dwordx2 v[220:221], v17, s[4:7], s34 offen offset:2048 sc1
    v_add_u32 v8, s49, v8
    v_mfma_f32_16x16x32_bf16 v[112:115], a[52:55], a[36:39], 0
    v_mfma_f32_16x16x32_bf16 v[112:115], a[16:19], a[0:3], v[112:115]
    s_waitcnt lgkmcnt(0) vmcnt(21)
    s_barrier
    v_mfma_f32_16x16x32_bf16 v[172:175], a[88:91], a[84:87], v[172:175]
    ds_read_b128 a[16:19], v8 offset:0
    s_add_u32 s36, s43, 10
    s_xor_b32 s36, s36, s58
    s_mov_b32 s39, 110592
    v_mfma_f32_16x16x32_bf16 v[172:175], a[124:127], a[120:123], v[172:175]
    ds_read_b128 a[0:3], v4 offset:0
    s_lshl_b32 s37, s36, 10
    s_add_u32 m0, s39, s41
    v_mfma_f32_16x16x32_bf16 v[176:179], a[128:131], a[120:123], v[176:179]
    buffer_load_dwordx4 v26, s[12:15], s37 offen offset:0 sc1 lds
    v_mfma_f32_16x16x32_bf16 v[176:179], a[92:95], a[84:87], v[176:179]
    ds_read_b128 a[4:7], v5 offset:0
    v_mfma_f32_16x16x32_bf16 v[180:183], a[96:99], a[84:87], v[180:183]
    ds_read_b128 a[8:11], v6 offset:0
    v_mfma_f32_16x16x32_bf16 v[180:183], a[132:135], a[120:123], v[180:183]
    ds_read_b128 a[12:15], v7 offset:0
    v_mfma_f32_16x16x32_bf16 v[184:187], a[136:139], a[120:123], v[184:187]
    buffer_load_dwordx4 v26, s[12:15], s37 offen offset:1024 sc1 lds
    v_mfma_f32_16x16x32_bf16 v[184:187], a[100:103], a[84:87], v[184:187]
    ds_read_b128 a[20:23], v8 offset:1024
    v_mfma_f32_16x16x32_bf16 v[188:191], a[104:107], a[84:87], v[188:191]
    ds_read_b128 a[24:27], v8 offset:2048
    v_mfma_f32_16x16x32_bf16 v[188:191], a[140:143], a[120:123], v[188:191]
    ds_read_b128 a[28:31], v8 offset:3072
    v_mfma_f32_16x16x32_bf16 v[168:171], a[140:143], a[116:119], v[168:171]
    v_mfma_f32_16x16x32_bf16 v[168:171], a[104:107], a[80:83], v[168:171]
    ds_read_b128 a[32:35], v8 offset:4096
    s_add_u32 s34, s46, 10240
    v_mfma_f32_16x16x32_bf16 v[164:167], a[100:103], a[80:83], v[164:167]
    buffer_store_dwordx4 v[202:205], v16, s[4:7], s34 offen sc1
    v_mfma_f32_16x16x32_bf16 v[164:167], a[136:139], a[116:119], v[164:167]
    v_mfma_f32_16x16x32_bf16 v[160:163], a[132:135], a[116:119], v[160:163]
    buffer_load_dwordx4 v27, s[12:15], s37 offen offset:2048 sc1 lds
    v_mfma_f32_16x16x32_bf16 v[160:163], a[96:99], a[80:83], v[160:163]
    v_mfma_f32_16x16x32_bf16 v[156:159], a[92:95], a[80:83], v[156:159]
    buffer_load_dwordx4 v27, s[12:15], s37 offen offset:3072 sc1 lds
    s_mul_i32 s38, s36, 40960
    s_add_u32 m0, s39, s42
    v_mfma_f32_16x16x32_bf16 v[156:159], a[128:131], a[116:119], v[156:159]
    buffer_load_dwordx4 v28, s[8:11], s38 offen offset:0 sc1 lds
    v_mfma_f32_16x16x32_bf16 v[152:155], a[124:127], a[116:119], v[152:155]
    v_mfma_f32_16x16x32_bf16 v[152:155], a[88:91], a[80:83], v[152:155]
    buffer_store_dwordx4 v[206:209], v16, s[4:7], s34 offen offset:1024 sc1
    v_mfma_f32_16x16x32_bf16 v[132:135], a[88:91], a[76:79], v[132:135]
    ds_read_b128 a[52:55], v8 offset:10240
    v_mfma_f32_16x16x32_bf16 v[132:135], a[124:127], a[112:115], v[132:135]
    ds_read_b128 a[36:39], v4 offset:1024
    v_mfma_f32_16x16x32_bf16 v[136:139], a[128:131], a[112:115], v[136:139]
    v_mfma_f32_16x16x32_bf16 v[136:139], a[92:95], a[76:79], v[136:139]
    ds_read_b128 a[40:43], v5 offset:1024
    v_mfma_f32_16x16x32_bf16 v[140:143], a[96:99], a[76:79], v[140:143]
    ds_read_b128 a[44:47], v6 offset:1024
    v_mfma_f32_16x16x32_bf16 v[140:143], a[132:135], a[112:115], v[140:143]
    ds_read_b128 a[48:51], v7 offset:1024
    v_mfma_f32_16x16x32_bf16 v[144:147], a[136:139], a[112:115], v[144:147]
    buffer_load_dwordx4 v28, s[8:11], s38 offen offset:1024 sc1 lds
    v_mfma_f32_16x16x32_bf16 v[144:147], a[100:103], a[76:79], v[144:147]
    ds_read_b128 a[56:59], v8 offset:11264
    v_mfma_f32_16x16x32_bf16 v[148:151], a[104:107], a[76:79], v[148:151]
    ds_read_b128 a[60:63], v8 offset:12288
    v_mfma_f32_16x16x32_bf16 v[148:151], a[140:143], a[112:115], v[148:151]
    ds_read_b128 a[64:67], v8 offset:13312
    v_mfma_f32_16x16x32_bf16 v[128:131], a[140:143], a[108:111], v[128:131]
    v_mfma_f32_16x16x32_bf16 v[128:131], a[104:107], a[72:75], v[128:131]
    ds_read_b128 a[68:71], v8 offset:14336
    v_mfma_f32_16x16x32_bf16 v[124:127], a[100:103], a[72:75], v[124:127]
    buffer_load_dwordx4 v28, s[8:11], s38 offen offset:2048 sc1 lds
    v_add_u32 v4, s48, v4
    v_mfma_f32_16x16x32_bf16 v[124:127], a[136:139], a[108:111], v[124:127]
    buffer_load_dwordx4 v28, s[8:11], s38 offen offset:3072 sc1 lds
    v_add_u32 v5, s48, v5
    v_mfma_f32_16x16x32_bf16 v[120:123], a[132:135], a[108:111], v[120:123]
    v_add_u32 v6, s48, v6
    v_mfma_f32_16x16x32_bf16 v[120:123], a[96:99], a[72:75], v[120:123]
    buffer_store_dwordx2 v[210:211], v17, s[4:7], s34 offen offset:2048 sc1
    v_mfma_f32_16x16x32_bf16 v[116:119], a[92:95], a[72:75], v[116:119]
    s_add_u32 m0, m0, 4096
    v_add_u32 v7, s48, v7
    v_mfma_f32_16x16x32_bf16 v[116:119], a[128:131], a[108:111], v[116:119]
    buffer_load_dwordx4 v29, s[8:11], s38 offen sc1 lds
    v_add_u32 v8, s48, v8
    v_mfma_f32_16x16x32_bf16 v[112:115], a[124:127], a[108:111], v[112:115]
    v_mfma_f32_16x16x32_bf16 v[112:115], a[88:91], a[72:75], v[112:115]
    s_waitcnt lgkmcnt(0) vmcnt(24)
    s_barrier
    v_mfma_f32_16x16x32_bf16 v[172:175], a[16:19], a[12:15], v[172:175]
    ds_read_b128 a[88:91], v8 offset:0
    s_add_u32 s36, s43, 12
    s_xor_b32 s36, s36, s58
    s_mov_b32 s39, 0
    v_mfma_f32_16x16x32_bf16 v[172:175], a[52:55], a[48:51], v[172:175]
    ds_read_b128 a[72:75], v4 offset:0
    s_lshl_b32 s37, s36, 10
    s_add_u32 m0, s39, s41
    v_mfma_f32_16x16x32_bf16 v[176:179], a[56:59], a[48:51], v[176:179]
    buffer_load_dwordx4 v26, s[12:15], s37 offen offset:0 sc1 lds
    v_mfma_f32_16x16x32_bf16 v[176:179], a[20:23], a[12:15], v[176:179]
    ds_read_b128 a[76:79], v5 offset:0
    v_mfma_f32_16x16x32_bf16 v[180:183], a[24:27], a[12:15], v[180:183]
    ds_read_b128 a[80:83], v6 offset:0
    v_mfma_f32_16x16x32_bf16 v[180:183], a[60:63], a[48:51], v[180:183]
    ds_read_b128 a[84:87], v7 offset:0
    v_mfma_f32_16x16x32_bf16 v[184:187], a[64:67], a[48:51], v[184:187]
    buffer_load_dwordx4 v26, s[12:15], s37 offen offset:1024 sc1 lds
    v_mfma_f32_16x16x32_bf16 v[184:187], a[28:31], a[12:15], v[184:187]
    ds_read_b128 a[92:95], v8 offset:1024
    v_mfma_f32_16x16x32_bf16 v[188:191], a[32:35], a[12:15], v[188:191]
    ds_read_b128 a[96:99], v8 offset:2048
    v_mfma_f32_16x16x32_bf16 v[188:191], a[68:71], a[48:51], v[188:191]
    ds_read_b128 a[100:103], v8 offset:3072
    v_mfma_f32_16x16x32_bf16 v[168:171], a[68:71], a[44:47], v[168:171]
    v_mfma_f32_16x16x32_bf16 v[168:171], a[32:35], a[8:11], v[168:171]
    ds_read_b128 a[104:107], v8 offset:4096
    s_add_u32 s34, s45, 7680
    v_mfma_f32_16x16x32_bf16 v[164:167], a[28:31], a[8:11], v[164:167]
    buffer_store_dwordx4 v[192:195], v16, s[4:7], s34 offen sc1
    v_mfma_f32_16x16x32_bf16 v[164:167], a[64:67], a[44:47], v[164:167]
    v_mfma_f32_16x16x32_bf16 v[160:163], a[60:63], a[44:47], v[160:163]
    buffer_load_dwordx4 v27, s[12:15], s37 offen offset:2048 sc1 lds
    v_mfma_f32_16x16x32_bf16 v[160:163], a[24:27], a[8:11], v[160:163]
    v_mfma_f32_16x16x32_bf16 v[156:159], a[20:23], a[8:11], v[156:159]
    buffer_load_dwordx4 v27, s[12:15], s37 offen offset:3072 sc1 lds
    s_mul_i32 s38, s36, 40960
    s_add_u32 m0, s39, s42
    v_mfma_f32_16x16x32_bf16 v[156:159], a[56:59], a[44:47], v[156:159]
    buffer_load_dwordx4 v28, s[8:11], s38 offen offset:0 sc1 lds
    v_mfma_f32_16x16x32_bf16 v[152:155], a[52:55], a[44:47], v[152:155]
    v_mfma_f32_16x16x32_bf16 v[152:155], a[16:19], a[8:11], v[152:155]
    buffer_store_dwordx4 v[196:199], v16, s[4:7], s34 offen offset:1024 sc1
    v_mfma_f32_16x16x32_bf16 v[132:135], a[16:19], a[4:7], v[132:135]
    ds_read_b128 a[124:127], v8 offset:10240
    v_mfma_f32_16x16x32_bf16 v[132:135], a[52:55], a[40:43], v[132:135]
    ds_read_b128 a[108:111], v4 offset:1024
    v_mfma_f32_16x16x32_bf16 v[136:139], a[56:59], a[40:43], v[136:139]
    v_mfma_f32_16x16x32_bf16 v[136:139], a[20:23], a[4:7], v[136:139]
    ds_read_b128 a[112:115], v5 offset:1024
    v_mfma_f32_16x16x32_bf16 v[140:143], a[24:27], a[4:7], v[140:143]
    ds_read_b128 a[116:119], v6 offset:1024
    v_mfma_f32_16x16x32_bf16 v[140:143], a[60:63], a[40:43], v[140:143]
    ds_read_b128 a[120:123], v7 offset:1024
    v_mfma_f32_16x16x32_bf16 v[144:147], a[64:67], a[40:43], v[144:147]
    buffer_load_dwordx4 v28, s[8:11], s38 offen offset:1024 sc1 lds
    v_mfma_f32_16x16x32_bf16 v[144:147], a[28:31], a[4:7], v[144:147]
    ds_read_b128 a[128:131], v8 offset:11264
    v_mfma_f32_16x16x32_bf16 v[148:151], a[32:35], a[4:7], v[148:151]
    ds_read_b128 a[132:135], v8 offset:12288
    v_mfma_f32_16x16x32_bf16 v[148:151], a[68:71], a[40:43], v[148:151]
    ds_read_b128 a[136:139], v8 offset:13312
    v_mfma_f32_16x16x32_bf16 v[128:131], a[68:71], a[36:39], v[128:131]
    v_mfma_f32_16x16x32_bf16 v[128:131], a[32:35], a[0:3], v[128:131]
    ds_read_b128 a[140:143], v8 offset:14336
    v_mfma_f32_16x16x32_bf16 v[124:127], a[28:31], a[0:3], v[124:127]
    buffer_load_dwordx4 v28, s[8:11], s38 offen offset:2048 sc1 lds
    v_add_u32 v4, s48, v4
    v_mfma_f32_16x16x32_bf16 v[124:127], a[64:67], a[36:39], v[124:127]
    buffer_load_dwordx4 v28, s[8:11], s38 offen offset:3072 sc1 lds
    v_add_u32 v5, s48, v5
    v_mfma_f32_16x16x32_bf16 v[120:123], a[60:63], a[36:39], v[120:123]
    v_add_u32 v6, s48, v6
    v_mfma_f32_16x16x32_bf16 v[120:123], a[24:27], a[0:3], v[120:123]
    buffer_store_dwordx2 v[200:201], v17, s[4:7], s34 offen offset:2048 sc1
    v_mfma_f32_16x16x32_bf16 v[116:119], a[20:23], a[0:3], v[116:119]
    s_add_u32 m0, m0, 4096
    v_add_u32 v7, s48, v7
    v_mfma_f32_16x16x32_bf16 v[116:119], a[56:59], a[36:39], v[116:119]
    buffer_load_dwordx4 v29, s[8:11], s38 offen sc1 lds
    v_add_u32 v8, s48, v8
    v_mfma_f32_16x16x32_bf16 v[112:115], a[52:55], a[36:39], v[112:115]
    v_mfma_f32_16x16x32_bf16 v[112:115], a[16:19], a[0:3], v[112:115]
    s_waitcnt lgkmcnt(0) vmcnt(27)
    s_barrier
    v_mfma_f32_16x16x32_bf16 v[172:175], a[88:91], a[84:87], v[172:175]
    ds_read_b128 a[16:19], v8 offset:0
    s_add_u32 s36, s43, 14
    s_xor_b32 s36, s36, s58
    s_mov_b32 s39, 36864
    v_mfma_f32_16x16x32_bf16 v[172:175], a[124:127], a[120:123], v[172:175]
    ds_read_b128 a[0:3], v4 offset:0
    s_lshl_b32 s37, s36, 10
    s_add_u32 m0, s39, s41
    v_mfma_f32_16x16x32_bf16 v[176:179], a[128:131], a[120:123], v[176:179]
    buffer_load_dwordx4 v26, s[12:15], s37 offen offset:0 sc1 lds
    v_mfma_f32_16x16x32_bf16 v[176:179], a[92:95], a[84:87], v[176:179]
    ds_read_b128 a[4:7], v5 offset:0
    v_mfma_f32_16x16x32_bf16 v[180:183], a[96:99], a[84:87], v[180:183]
    ds_read_b128 a[8:11], v6 offset:0
    v_mfma_f32_16x16x32_bf16 v[180:183], a[132:135], a[120:123], v[180:183]
    ds_read_b128 a[12:15], v7 offset:0
    v_mfma_f32_16x16x32_bf16 v[184:187], a[136:139], a[120:123], v[184:187]
    v_mfma_f32_16x16x32_bf16 v[184:187], a[100:103], a[84:87], v[184:187]
    ds_read_b128 a[20:23], v8 offset:1024
    v_mfma_f32_16x16x32_bf16 v[188:191], a[104:107], a[84:87], v[188:191]
    ds_read_b128 a[24:27], v8 offset:2048
    v_mfma_f32_16x16x32_bf16 v[188:191], a[140:143], a[120:123], v[188:191]
    ds_read_b128 a[28:31], v8 offset:3072
    v_mfma_f32_16x16x32_bf16 v[168:171], a[140:143], a[116:119], v[168:171]
    buffer_load_dwordx4 v26, s[12:15], s37 offen offset:1024 sc1 lds
    v_mfma_f32_16x16x32_bf16 v[168:171], a[104:107], a[80:83], v[168:171]
    ds_read_b128 a[32:35], v8 offset:4096
    v_mfma_f32_16x16x32_bf16 v[164:167], a[100:103], a[80:83], v[164:167]
    v_mfma_f32_16x16x32_bf16 v[164:167], a[136:139], a[116:119], v[164:167]
    buffer_load_dwordx4 v27, s[12:15], s37 offen offset:2048 sc1 lds
    v_mfma_f32_16x16x32_bf16 v[160:163], a[132:135], a[116:119], v[160:163]
    v_mfma_f32_16x16x32_bf16 v[160:163], a[96:99], a[80:83], v[160:163]
    v_mfma_f32_16x16x32_bf16 v[156:159], a[92:95], a[80:83], v[156:159]
    buffer_load_dwordx4 v27, s[12:15], s37 offen offset:3072 sc1 lds
    v_mfma_f32_16x16x32_bf16 v[156:159], a[128:131], a[116:119], v[156:159]
    s_mul_i32 s38, s36, 40960
    s_add_u32 m0, s39, s42
    v_mfma_f32_16x16x32_bf16 v[152:155], a[124:127], a[116:119], v[152:155]
    buffer_load_dwordx4 v28, s[8:11], s38 offen offset:0 sc1 lds
    v_mfma_f32_16x16x32_bf16 v[152:155], a[88:91], a[80:83], v[152:155]
    v_mfma_f32_16x16x32_bf16 v[132:135], a[88:91], a[76:79], v[132:135]
    ds_read_b128 a[52:55], v8 offset:10240
    v_mfma_f32_16x16x32_bf16 v[132:135], a[124:127], a[112:115], v[132:135]
    ds_read_b128 a[36:39], v4 offset:1024
    v_mfma_f32_16x16x32_bf16 v[136:139], a[128:131], a[112:115], v[136:139]
    buffer_load_dwordx4 v28, s[8:11], s38 offen offset:1024 sc1 lds
    v_mfma_f32_16x16x32_bf16 v[136:139], a[92:95], a[76:79], v[136:139]
    ds_read_b128 a[40:43], v5 offset:1024
    v_mfma_f32_16x16x32_bf16 v[140:143], a[96:99], a[76:79], v[140:143]
    ds_read_b128 a[44:47], v6 offset:1024
    v_mfma_f32_16x16x32_bf16 v[140:143], a[132:135], a[112:115], v[140:143]
    ds_read_b128 a[48:51], v7 offset:1024
    v_mfma_f32_16x16x32_bf16 v[144:147], a[136:139], a[112:115], v[144:147]
    v_mfma_f32_16x16x32_bf16 v[144:147], a[100:103], a[76:79], v[144:147]
    ds_read_b128 a[56:59], v8 offset:11264
    v_mfma_f32_16x16x32_bf16 v[148:151], a[104:107], a[76:79], v[148:151]
    ds_read_b128 a[60:63], v8 offset:12288
    v_mfma_f32_16x16x32_bf16 v[148:151], a[140:143], a[112:115], v[148:151]
    ds_read_b128 a[64:67], v8 offset:13312
    v_mfma_f32_16x16x32_bf16 v[128:131], a[140:143], a[108:111], v[128:131]
    v_mfma_f32_16x16x32_bf16 v[128:131], a[104:107], a[72:75], v[128:131]
    ds_read_b128 a[68:71], v8 offset:14336
    v_mfma_f32_16x16x32_bf16 v[124:127], a[100:103], a[72:75], v[124:127]
    buffer_load_dwordx4 v28, s[8:11], s38 offen offset:2048 sc1 lds
    v_add_u32 v4, s48, v4
    v_mfma_f32_16x16x32_bf16 v[124:127], a[136:139], a[108:111], v[124:127]
    v_add_u32 v5, s48, v5
    v_mfma_f32_16x16x32_bf16 v[120:123], a[132:135], a[108:111], v[120:123]
    buffer_load_dwordx4 v28, s[8:11], s38 offen offset:3072 sc1 lds
    v_add_u32 v6, s48, v6
    v_mfma_f32_16x16x32_bf16 v[120:123], a[96:99], a[72:75], v[120:123]
    s_add_u32 m0, m0, 4096
    v_mfma_f32_16x16x32_bf16 v[116:119], a[92:95], a[72:75], v[116:119]
    buffer_load_dwordx4 v29, s[8:11], s38 offen sc1 lds
    v_add_u32 v7, s48, v7
    v_mfma_f32_16x16x32_bf16 v[116:119], a[128:131], a[108:111], v[116:119]
    v_add_u32 v8, s48, v8
    v_mfma_f32_16x16x32_bf16 v[112:115], a[124:127], a[108:111], v[112:115]
    v_mfma_f32_16x16x32_bf16 v[112:115], a[88:91], a[72:75], v[112:115]
    s_waitcnt lgkmcnt(0) vmcnt(21)
    s_barrier
    v_mfma_f32_16x16x32_bf16 v[172:175], a[16:19], a[12:15], v[172:175]
    ds_read_b128 a[88:91], v8 offset:0
    s_add_u32 s36, s43, 16
    s_xor_b32 s36, s36, s58
    s_mov_b32 s39, 73728
    global_load_dword v15, v13, s[52:53] sc1
    v_mfma_f32_16x16x32_bf16 v[172:175], a[52:55], a[48:51], v[172:175]
    ds_read_b128 a[72:75], v4 offset:0
    s_lshl_b32 s37, s36, 10
    s_add_u32 m0, s39, s41
    v_mfma_f32_16x16x32_bf16 v[176:179], a[56:59], a[48:51], v[176:179]
    buffer_load_dwordx4 v26, s[12:15], s37 offen offset:0 sc1 lds
    v_mfma_f32_16x16x32_bf16 v[176:179], a[20:23], a[12:15], v[176:179]
    ds_read_b128 a[76:79], v5 offset:0
    v_mfma_f32_16x16x32_bf16 v[180:183], a[24:27], a[12:15], v[180:183]
    ds_read_b128 a[80:83], v6 offset:0
    v_mfma_f32_16x16x32_bf16 v[180:183], a[60:63], a[48:51], v[180:183]
    ds_read_b128 a[84:87], v7 offset:0
    v_mfma_f32_16x16x32_bf16 v[184:187], a[64:67], a[48:51], v[184:187]
    v_mfma_f32_16x16x32_bf16 v[184:187], a[28:31], a[12:15], v[184:187]
    ds_read_b128 a[92:95], v8 offset:1024
    v_mfma_f32_16x16x32_bf16 v[188:191], a[32:35], a[12:15], v[188:191]
    ds_read_b128 a[96:99], v8 offset:2048
    v_mfma_f32_16x16x32_bf16 v[188:191], a[68:71], a[48:51], v[188:191]
    ds_read_b128 a[100:103], v8 offset:3072
    v_mfma_f32_16x16x32_bf16 v[168:171], a[68:71], a[44:47], v[168:171]
    buffer_load_dwordx4 v26, s[12:15], s37 offen offset:1024 sc1 lds
    v_mfma_f32_16x16x32_bf16 v[168:171], a[32:35], a[8:11], v[168:171]
    ds_read_b128 a[104:107], v8 offset:4096
    v_mfma_f32_16x16x32_bf16 v[164:167], a[28:31], a[8:11], v[164:167]
    v_mfma_f32_16x16x32_bf16 v[164:167], a[64:67], a[44:47], v[164:167]
    buffer_load_dwordx4 v27, s[12:15], s37 offen offset:2048 sc1 lds
    v_mfma_f32_16x16x32_bf16 v[160:163], a[60:63], a[44:47], v[160:163]
    v_mfma_f32_16x16x32_bf16 v[160:163], a[24:27], a[8:11], v[160:163]
    v_mfma_f32_16x16x32_bf16 v[156:159], a[20:23], a[8:11], v[156:159]
    buffer_load_dwordx4 v27, s[12:15], s37 offen offset:3072 sc1 lds
    v_mfma_f32_16x16x32_bf16 v[156:159], a[56:59], a[44:47], v[156:159]
    s_mul_i32 s38, s36, 40960
    s_add_u32 m0, s39, s42
    v_mfma_f32_16x16x32_bf16 v[152:155], a[52:55], a[44:47], v[152:155]
    buffer_load_dwordx4 v28, s[8:11], s38 offen offset:0 sc1 lds
    v_mfma_f32_16x16x32_bf16 v[152:155], a[16:19], a[8:11], v[152:155]
    v_mfma_f32_16x16x32_bf16 v[132:135], a[16:19], a[4:7], v[132:135]
    ds_read_b128 a[124:127], v8 offset:10240
    v_mfma_f32_16x16x32_bf16 v[132:135], a[52:55], a[40:43], v[132:135]
    ds_read_b128 a[108:111], v4 offset:1024
    v_mfma_f32_16x16x32_bf16 v[136:139], a[56:59], a[40:43], v[136:139]
    buffer_load_dwordx4 v28, s[8:11], s38 offen offset:1024 sc1 lds
    v_mfma_f32_16x16x32_bf16 v[136:139], a[20:23], a[4:7], v[136:139]
    ds_read_b128 a[112:115], v5 offset:1024
    v_mfma_f32_16x16x32_bf16 v[140:143], a[24:27], a[4:7], v[140:143]
    ds_read_b128 a[116:119], v6 offset:1024
    v_mfma_f32_16x16x32_bf16 v[140:143], a[60:63], a[40:43], v[140:143]
    ds_read_b128 a[120:123], v7 offset:1024
    v_mfma_f32_16x16x32_bf16 v[144:147], a[64:67], a[40:43], v[144:147]
    v_mfma_f32_16x16x32_bf16 v[144:147], a[28:31], a[4:7], v[144:147]
    ds_read_b128 a[128:131], v8 offset:11264
    v_mfma_f32_16x16x32_bf16 v[148:151], a[32:35], a[4:7], v[148:151]
    ds_read_b128 a[132:135], v8 offset:12288
    v_mfma_f32_16x16x32_bf16 v[148:151], a[68:71], a[40:43], v[148:151]
    ds_read_b128 a[136:139], v8 offset:13312
    v_mfma_f32_16x16x32_bf16 v[128:131], a[68:71], a[36:39], v[128:131]
    v_mfma_f32_16x16x32_bf16 v[128:131], a[32:35], a[0:3], v[128:131]
    ds_read_b128 a[140:143], v8 offset:14336
    v_mfma_f32_16x16x32_bf16 v[124:127], a[28:31], a[0:3], v[124:127]
    buffer_load_dwordx4 v28, s[8:11], s38 offen offset:2048 sc1 lds
    v_add_u32 v4, s49, v4
    v_mfma_f32_16x16x32_bf16 v[124:127], a[64:67], a[36:39], v[124:127]
    v_add_u32 v5, s49, v5
    v_mfma_f32_16x16x32_bf16 v[120:123], a[60:63], a[36:39], v[120:123]
    buffer_load_dwordx4 v28, s[8:11], s38 offen offset:3072 sc1 lds
    v_add_u32 v6, s49, v6
    v_mfma_f32_16x16x32_bf16 v[120:123], a[24:27], a[0:3], v[120:123]
    s_add_u32 m0, m0, 4096
    v_mfma_f32_16x16x32_bf16 v[116:119], a[20:23], a[0:3], v[116:119]
    buffer_load_dwordx4 v29, s[8:11], s38 offen sc1 lds
    v_add_u32 v7, s49, v7
    v_mfma_f32_16x16x32_bf16 v[116:119], a[56:59], a[36:39], v[116:119]
    v_add_u32 v8, s49, v8
    v_mfma_f32_16x16x32_bf16 v[112:115], a[52:55], a[36:39], v[112:115]
    v_mfma_f32_16x16x32_bf16 v[112:115], a[16:19], a[0:3], v[112:115]
    s_waitcnt lgkmcnt(0) vmcnt(19)
    s_barrier
    v_mfma_f32_16x16x32_bf16 v[172:175], a[88:91], a[84:87], v[172:175]
    ds_read_b128 a[16:19], v8 offset:0
    s_add_u32 s36, s43, 18
    s_xor_b32 s36, s36, s58
    s_mov_b32 s39, 110592
    v_mov_b32 v14, 1
    s_mov_b64 exec, 2
    global_store_dword v1, v14, s[52:53] sc1
    s_mov_b64 exec, -1
    v_mfma_f32_16x16x32_bf16 v[172:175], a[124:127], a[120:123], v[172:175]
    ds_read_b128 a[0:3], v4 offset:0
    s_lshl_b32 s37, s36, 10
    s_add_u32 m0, s39, s41
    v_mfma_f32_16x16x32_bf16 v[176:179], a[128:131], a[120:123], v[176:179]
    buffer_load_dwordx4 v26, s[12:15], s37 offen offset:0 sc1 lds
    v_mfma_f32_16x16x32_bf16 v[176:179], a[92:95], a[84:87], v[176:179]
    ds_read_b128 a[4:7], v5 offset:0
    v_mfma_f32_16x16x32_bf16 v[180:183], a[96:99], a[84:87], v[180:183]
    ds_read_b128 a[8:11], v6 offset:0
    v_mfma_f32_16x16x32_bf16 v[180:183], a[132:135], a[120:123], v[180:183]
    ds_read_b128 a[12:15], v7 offset:0
    v_mfma_f32_16x16x32_bf16 v[184:187], a[136:139], a[120:123], v[184:187]
    v_mfma_f32_16x16x32_bf16 v[184:187], a[100:103], a[84:87], v[184:187]
    ds_read_b128 a[20:23], v8 offset:1024
    v_mfma_f32_16x16x32_bf16 v[188:191], a[104:107], a[84:87], v[188:191]
    ds_read_b128 a[24:27], v8 offset:2048
    v_mfma_f32_16x16x32_bf16 v[188:191], a[140:143], a[120:123], v[188:191]
    ds_read_b128 a[28:31], v8 offset:3072
    v_mfma_f32_16x16x32_bf16 v[168:171], a[140:143], a[116:119], v[168:171]
    buffer_load_dwordx4 v26, s[12:15], s37 offen offset:1024 sc1 lds
    v_mfma_f32_16x16x32_bf16 v[168:171], a[104:107], a[80:83], v[168:171]
    ds_read_b128 a[32:35], v8 offset:4096
    v_mfma_f32_16x16x32_bf16 v[164:167], a[100:103], a[80:83], v[164:167]
    v_mfma_f32_16x16x32_bf16 v[164:167], a[136:139], a[116:119], v[164:167]
    buffer_load_dwordx4 v27, s[12:15], s37 offen offset:2048 sc1 lds
    v_mfma_f32_16x16x32_bf16 v[160:163], a[132:135], a[116:119], v[160:163]
    v_mfma_f32_16x16x32_bf16 v[160:163], a[96:99], a[80:83], v[160:163]
    v_mfma_f32_16x16x32_bf16 v[156:159], a[92:95], a[80:83], v[156:159]
    buffer_load_dwordx4 v27, s[12:15], s37 offen offset:3072 sc1 lds
    v_mfma_f32_16x16x32_bf16 v[156:159], a[128:131], a[116:119], v[156:159]
    s_mul_i32 s38, s36, 40960
    s_add_u32 m0, s39, s42
    v_mfma_f32_16x16x32_bf16 v[152:155], a[124:127], a[116:119], v[152:155]
    buffer_load_dwordx4 v28, s[8:11], s38 offen offset:0 sc1 lds
    v_mfma_f32_16x16x32_bf16 v[152:155], a[88:91], a[80:83], v[152:155]
    v_mfma_f32_16x16x32_bf16 v[132:135], a[88:91], a[76:79], v[132:135]
    ds_read_b128 a[52:55], v8 offset:10240
    v_mfma_f32_16x16x32_bf16 v[132:135], a[124:127], a[112:115], v[132:135]
    ds_read_b128 a[36:39], v4 offset:1024
    v_mfma_f32_16x16x32_bf16 v[136:139], a[128:131], a[112:115], v[136:139]
    buffer_load_dwordx4 v28, s[8:11], s38 offen offset:1024 sc1 lds
    v_mfma_f32_16x16x32_bf16 v[136:139], a[92:95], a[76:79], v[136:139]
    ds_read_b128 a[40:43], v5 offset:1024
    v_mfma_f32_16x16x32_bf16 v[140:143], a[96:99], a[76:79], v[140:143]
    ds_read_b128 a[44:47], v6 offset:1024
    v_mfma_f32_16x16x32_bf16 v[140:143], a[132:135], a[112:115], v[140:143]
    ds_read_b128 a[48:51], v7 offset:1024
    v_mfma_f32_16x16x32_bf16 v[144:147], a[136:139], a[112:115], v[144:147]
    v_mfma_f32_16x16x32_bf16 v[144:147], a[100:103], a[76:79], v[144:147]
    ds_read_b128 a[56:59], v8 offset:11264
    v_mfma_f32_16x16x32_bf16 v[148:151], a[104:107], a[76:79], v[148:151]
    ds_read_b128 a[60:63], v8 offset:12288
    v_mfma_f32_16x16x32_bf16 v[148:151], a[140:143], a[112:115], v[148:151]
    ds_read_b128 a[64:67], v8 offset:13312
    v_mfma_f32_16x16x32_bf16 v[128:131], a[140:143], a[108:111], v[128:131]
    v_mfma_f32_16x16x32_bf16 v[128:131], a[104:107], a[72:75], v[128:131]
    ds_read_b128 a[68:71], v8 offset:14336
    v_mfma_f32_16x16x32_bf16 v[124:127], a[100:103], a[72:75], v[124:127]
    buffer_load_dwordx4 v28, s[8:11], s38 offen offset:2048 sc1 lds
    v_add_u32 v4, s48, v4
    v_mfma_f32_16x16x32_bf16 v[124:127], a[136:139], a[108:111], v[124:127]
    v_add_u32 v5, s48, v5
    v_mfma_f32_16x16x32_bf16 v[120:123], a[132:135], a[108:111], v[120:123]
    buffer_load_dwordx4 v28, s[8:11], s38 offen offset:3072 sc1 lds
    v_add_u32 v6, s48, v6
    v_mfma_f32_16x16x32_bf16 v[120:123], a[96:99], a[72:75], v[120:123]
    s_add_u32 m0, m0, 4096
    v_mfma_f32_16x16x32_bf16 v[116:119], a[92:95], a[72:75], v[116:119]
    buffer_load_dwordx4 v29, s[8:11], s38 offen sc1 lds
    v_add_u32 v7, s48, v7
    v_mfma_f32_16x16x32_bf16 v[116:119], a[128:131], a[108:111], v[116:119]
    v_add_u32 v8, s48, v8
    v_mfma_f32_16x16x32_bf16 v[112:115], a[124:127], a[108:111], v[112:115]
    v_mfma_f32_16x16x32_bf16 v[112:115], a[88:91], a[72:75], v[112:115]
    s_waitcnt vmcnt(19)
    v_cmp_ne_u32 vcc, 0, v15
    s_sub_u32 s59, s54, 7
    s_max_i32 s59, s59, 0
    s_cmp_eq_u64 vcc, exec
    s_cselect_b32 s59, 0, s59
    s_sub_u32 s54, s54, s59
    s_add_u32 s36, s43, 20
    s_mov_b32 s51, s36
    s_xor_b32 s36, s36, s58
    s_mov_b32 s39, 0
    s_mov_b32 s35, 36864
K2_LOOP:
    s_waitcnt vmcnt(18) lgkmcnt(0)
    s_barrier
    v_mfma_f32_16x16x32_bf16 v[172:175], a[16:19], a[12:15], v[172:175]
    ds_read_b128 a[88:91], v8 offset:0
    s_lshl_b32 s37, s36, 10
    v_mfma_f32_16x16x32_bf16 v[172:175], a[52:55], a[48:51], v[172:175]
    ds_read_b128 a[72:75], v4 offset:0
    s_add_u32 m0, s39, s41
    v_mfma_f32_16x16x32_bf16 v[176:179], a[56:59], a[48:51], v[176:179]
    buffer_load_dwordx4 v26, s[12:15], s37 offen offset:0 sc1 lds
    v_mfma_f32_16x16x32_bf16 v[176:179], a[20:23], a[12:15], v[176:179]
    ds_read_b128 a[76:79], v5 offset:0
    v_mfma_f32_16x16x32_bf16 v[180:183], a[24:27], a[12:15], v[180:183]
    ds_read_b128 a[80:83], v6 offset:0
    v_mfma_f32_16x16x32_bf16 v[180:183], a[60:63], a[48:51], v[180:183]
    ds_read_b128 a[84:87], v7 offset:0
    v_mfma_f32_16x16x32_bf16 v[184:187], a[64:67], a[48:51], v[184:187]
    buffer_load_dwordx4 v26, s[12:15], s37 offen offset:1024 sc1 lds
    v_mfma_f32_16x16x32_bf16 v[184:187], a[28:31], a[12:15], v[184:187]
    ds_read_b128 a[92:95], v8 offset:1024
    v_mfma_f32_16x16x32_bf16 v[188:191], a[32:35], a[12:15], v[188:191]
    ds_read_b128 a[96:99], v8 offset:2048
    v_mfma_f32_16x16x32_bf16 v[188:191], a[68:71], a[48:51], v[188:191]
    ds_read_b128 a[100:103], v8 offset:3072
    v_mfma_f32_16x16x32_bf16 v[168:171], a[68:71], a[44:47], v[168:171]
    buffer_load_dwordx4 v27, s[12:15], s37 offen offset:2048 sc1 lds
    v_mfma_f32_16x16x32_bf16 v[168:171], a[32:35], a[8:11], v[168:171]
    ds_read_b128 a[104:107], v8 offset:4096
    v_mfma_f32_16x16x32_bf16 v[164:167], a[28:31], a[8:11], v[164:167]
    s_add_u32 s35, s35, 36864
    v_mfma_f32_16x16x32_bf16 v[164:167], a[64:67], a[44:47], v[164:167]
    s_cmp_eq_u32 s35, 147456
    s_cselect_b32 s50, s49, s48
    v_mfma_f32_16x16x32_bf16 v[160:163], a[60:63], a[44:47], v[160:163]
    buffer_load_dwordx4 v27, s[12:15], s37 offen offset:3072 sc1 lds
    s_mul_i32 s38, s36, 40960
    v_mfma_f32_16x16x32_bf16 v[160:163], a[24:27], a[8:11], v[160:163]
    s_add_u32 m0, s39, s42
    v_mfma_f32_16x16x32_bf16 v[156:159], a[20:23], a[8:11], v[156:159]
    s_add_u32 s51, s51, 2
    s_add_u32 s39, s39, 36864
    v_mfma_f32_16x16x32_bf16 v[156:159], a[56:59], a[44:47], v[156:159]
    s_cmp_eq_u32 s39, 147456
    s_cselect_b32 s39, 0, s39
    v_mfma_f32_16x16x32_bf16 v[152:155], a[52:55], a[44:47], v[152:155]
    buffer_load_dwordx4 v28, s[8:11], s38 offen offset:0 sc1 lds
    v_mfma_f32_16x16x32_bf16 v[152:155], a[16:19], a[8:11], v[152:155]
    s_cmp_eq_u32 s35, 147456
    s_cselect_b32 s35, 0, s35
    v_mfma_f32_16x16x32_bf16 v[132:135], a[16:19], a[4:7], v[132:135]
    ds_read_b128 a[124:127], v8 offset:10240
    v_mfma_f32_16x16x32_bf16 v[132:135], a[52:55], a[40:43], v[132:135]
    ds_read_b128 a[108:111], v4 offset:1024
    v_mfma_f32_16x16x32_bf16 v[136:139], a[56:59], a[40:43], v[136:139]
    buffer_load_dwordx4 v28, s[8:11], s38 offen offset:1024 sc1 lds
    v_mfma_f32_16x16x32_bf16 v[136:139], a[20:23], a[4:7], v[136:139]
    ds_read_b128 a[112:115], v5 offset:1024
    v_mfma_f32_16x16x32_bf16 v[140:143], a[24:27], a[4:7], v[140:143]
    ds_read_b128 a[116:119], v6 offset:1024
    s_xor_b32 s36, s51, s58
    v_mfma_f32_16x16x32_bf16 v[140:143], a[60:63], a[40:43], v[140:143]
    ds_read_b128 a[120:123], v7 offset:1024
    v_mfma_f32_16x16x32_bf16 v[144:147], a[64:67], a[40:43], v[144:147]
    buffer_load_dwordx4 v28, s[8:11], s38 offen offset:2048 sc1 lds
    v_mfma_f32_16x16x32_bf16 v[144:147], a[28:31], a[4:7], v[144:147]
    ds_read_b128 a[128:131], v8 offset:11264
    v_mfma_f32_16x16x32_bf16 v[148:151], a[32:35], a[4:7], v[148:151]
    ds_read_b128 a[132:135], v8 offset:12288
    v_mfma_f32_16x16x32_bf16 v[148:151], a[68:71], a[40:43], v[148:151]
    ds_read_b128 a[136:139], v8 offset:13312
    v_mfma_f32_16x16x32_bf16 v[128:131], a[68:71], a[36:39], v[128:131]
    buffer_load_dwordx4 v28, s[8:11], s38 offen offset:3072 sc1 lds
    s_add_u32 m0, m0, 4096
    v_mfma_f32_16x16x32_bf16 v[128:131], a[32:35], a[0:3], v[128:131]
    ds_read_b128 a[140:143], v8 offset:14336
    v_mfma_f32_16x16x32_bf16 v[124:127], a[28:31], a[0:3], v[124:127]
    v_add_u32 v4, s50, v4
    v_mfma_f32_16x16x32_bf16 v[124:127], a[64:67], a[36:39], v[124:127]
    v_add_u32 v5, s50, v5
    v_mfma_f32_16x16x32_bf16 v[120:123], a[60:63], a[36:39], v[120:123]
    buffer_load_dwordx4 v29, s[8:11], s38 offen sc1 lds
    v_mfma_f32_16x16x32_bf16 v[120:123], a[24:27], a[0:3], v[120:123]
    v_add_u32 v6, s50, v6
    v_mfma_f32_16x16x32_bf16 v[116:119], a[20:23], a[0:3], v[116:119]
    v_add_u32 v7, s50, v7
    v_mfma_f32_16x16x32_bf16 v[116:119], a[56:59], a[36:39], v[116:119]
    v_add_u32 v8, s50, v8
    v_mfma_f32_16x16x32_bf16 v[112:115], a[52:55], a[36:39], v[112:115]
    v_mfma_f32_16x16x32_bf16 v[112:115], a[16:19], a[0:3], v[112:115]
    s_waitcnt vmcnt(18) lgkmcnt(0)
    s_barrier
    v_mfma_f32_16x16x32_bf16 v[172:175], a[88:91], a[84:87], v[172:175]
    ds_read_b128 a[16:19], v8 offset:0
    s_lshl_b32 s37, s36, 10
    v_mfma_f32_16x16x32_bf16 v[172:175], a[124:127], a[120:123], v[172:175]
    ds_read_b128 a[0:3], v4 offset:0
    s_add_u32 m0, s39, s41
    v_mfma_f32_16x16x32_bf16 v[176:179], a[128:131], a[120:123], v[176:179]
    buffer_load_dwordx4 v26, s[12:15], s37 offen offset:0 sc1 lds
    v_mfma_f32_16x16x32_bf16 v[176:179], a[92:95], a[84:87], v[176:179]
    ds_read_b128 a[4:7], v5 offset:0
    v_mfma_f32_16x16x32_bf16 v[180:183], a[96:99], a[84:87], v[180:183]
    ds_read_b128 a[8:11], v6 offset:0
    v_mfma_f32_16x16x32_bf16 v[180:183], a[132:135], a[120:123], v[180:183]
    ds_read_b128 a[12:15], v7 offset:0
    v_mfma_f32_16x16x32_bf16 v[184:187], a[136:139], a[120:123], v[184:187]
    buffer_load_dwordx4 v26, s[12:15], s37 offen offset:1024 sc1 lds
    v_mfma_f32_16x16x32_bf16 v[184:187], a[100:103], a[84:87], v[184:187]
    ds_read_b128 a[20:23], v8 offset:1024
    v_mfma_f32_16x16x32_bf16 v[188:191], a[104:107], a[84:87], v[188:191]
    ds_read_b128 a[24:27], v8 offset:2048
    v_mfma_f32_16x16x32_bf16 v[188:191], a[140:143], a[120:123], v[188:191]
    ds_read_b128 a[28:31], v8 offset:3072
    v_mfma_f32_16x16x32_bf16 v[168:171], a[140:143], a[116:119], v[168:171]
    buffer_load_dwordx4 v27, s[12:15], s37 offen offset:2048 sc1 lds
    v_mfma_f32_16x16x32_bf16 v[168:171], a[104:107], a[80:83], v[168:171]
    ds_read_b128 a[32:35], v8 offset:4096
    v_mfma_f32_16x16x32_bf16 v[164:167], a[100:103], a[80:83], v[164:167]
    s_add_u32 s35, s35, 36864
    s_sub_u32 s54, s54, 1
    v_mfma_f32_16x16x32_bf16 v[164:167], a[136:139], a[116:119], v[164:167]
    s_cmp_eq_u32 s35, 147456
    s_cselect_b32 s50, s49, s48
    v_mfma_f32_16x16x32_bf16 v[160:163], a[132:135], a[116:119], v[160:163]
    buffer_load_dwordx4 v27, s[12:15], s37 offen offset:3072 sc1 lds
    s_mul_i32 s38, s36, 40960
    v_mfma_f32_16x16x32_bf16 v[160:163], a[96:99], a[80:83], v[160:163]
    s_add_u32 m0, s39, s42
    v_mfma_f32_16x16x32_bf16 v[156:159], a[92:95], a[80:83], v[156:159]
    s_add_u32 s51, s51, 2
    s_add_u32 s39, s39, 36864
    v_mfma_f32_16x16x32_bf16 v[156:159], a[128:131], a[116:119], v[156:159]
    s_cmp_eq_u32 s39, 147456
    s_cselect_b32 s39, 0, s39
    v_mfma_f32_16x16x32_bf16 v[152:155], a[124:127], a[116:119], v[152:155]
    buffer_load_dwordx4 v28, s[8:11], s38 offen offset:0 sc1 lds
    s_cmp_eq_u32 s51, s23
    s_cselect_b32 s58, s22, s58
    v_mfma_f32_16x16x32_bf16 v[152:155], a[88:91], a[80:83], v[152:155]
    s_cmp_eq_u32 s35, 147456
    s_cselect_b32 s35, 0, s35
    v_mfma_f32_16x16x32_bf16 v[132:135], a[88:91], a[76:79], v[132:135]
    ds_read_b128 a[52:55], v8 offset:10240
    v_mfma_f32_16x16x32_bf16 v[132:135], a[124:127], a[112:115], v[132:135]
    ds_read_b128 a[36:39], v4 offset:1024
    v_mfma_f32_16x16x32_bf16 v[136:139], a[128:131], a[112:115], v[136:139]
    buffer_load_dwordx4 v28, s[8:11], s38 offen offset:1024 sc1 lds
    s_cmp_eq_u32 s51, s56
    s_cselect_b32 s51, s57, s51
    v_mfma_f32_16x16x32_bf16 v[136:139], a[92:95], a[76:79], v[136:139]
    ds_read_b128 a[40:43], v5 offset:1024
    v_mfma_f32_16x16x32_bf16 v[140:143], a[96:99], a[76:79], v[140:143]
    ds_read_b128 a[44:47], v6 offset:1024
    s_xor_b32 s36, s51, s58
    v_mfma_f32_16x16x32_bf16 v[140:143], a[132:135], a[112:115], v[140:143]
    ds_read_b128 a[48:51], v7 offset:1024
    v_mfma_f32_16x16x32_bf16 v[144:147], a[136:139], a[112:115], v[144:147]
    buffer_load_dwordx4 v28, s[8:11], s38 offen offset:2048 sc1 lds
    v_mfma_f32_16x16x32_bf16 v[144:147], a[100:103], a[76:79], v[144:147]
    ds_read_b128 a[56:59], v8 offset:11264
    v_mfma_f32_16x16x32_bf16 v[148:151], a[104:107], a[76:79], v[148:151]
    ds_read_b128 a[60:63], v8 offset:12288
    v_mfma_f32_16x16x32_bf16 v[148:151], a[140:143], a[112:115], v[148:151]
    ds_read_b128 a[64:67], v8 offset:13312
    v_mfma_f32_16x16x32_bf16 v[128:131], a[140:143], a[108:111], v[128:131]
    buffer_load_dwordx4 v28, s[8:11], s38 offen offset:3072 sc1 lds
    s_add_u32 m0, m0, 4096
    v_mfma_f32_16x16x32_bf16 v[128:131], a[104:107], a[72:75], v[128:131]
    ds_read_b128 a[68:71], v8 offset:14336
    v_mfma_f32_16x16x32_bf16 v[124:127], a[100:103], a[72:75], v[124:127]
    v_add_u32 v4, s50, v4
    v_mfma_f32_16x16x32_bf16 v[124:127], a[136:139], a[108:111], v[124:127]
    v_add_u32 v5, s50, v5
    v_mfma_f32_16x16x32_bf16 v[120:123], a[132:135], a[108:111], v[120:123]
    buffer_load_dwordx4 v29, s[8:11], s38 offen sc1 lds
    v_mfma_f32_16x16x32_bf16 v[120:123], a[96:99], a[72:75], v[120:123]
    v_add_u32 v6, s50, v6
    v_mfma_f32_16x16x32_bf16 v[116:119], a[92:95], a[72:75], v[116:119]
    v_add_u32 v7, s50, v7
    v_mfma_f32_16x16x32_bf16 v[116:119], a[128:131], a[108:111], v[116:119]
    v_add_u32 v8, s50, v8
    v_mfma_f32_16x16x32_bf16 v[112:115], a[124:127], a[108:111], v[112:115]
    s_cmp_lg_u32 s54, 0
    v_mfma_f32_16x16x32_bf16 v[112:115], a[88:91], a[72:75], v[112:115]
    s_cbranch_scc1 K2_LOOP
    s_cmp_eq_u32 s59, 0
    s_cbranch_scc1 K2_LOOP_END
    s_mov_b32 s33, 65536
    s_mov_b64 exec, -1
K2_PD:
    global_load_dword v15, v13, s[52:53] sc1
    s_waitcnt vmcnt(0)
    v_cmp_ne_u32 vcc, 0, v15
    s_cmp_eq_u64 vcc, exec
    s_cbranch_scc1 K2_PD_OK
    s_sleep 1
    s_sub_u32 s33, s33, 1
    s_cmp_lg_u32 s33, 0
    s_cbranch_scc1 K2_PD
K2_PD_OK:
    s_mov_b64 exec, -1
    s_mov_b32 s54, s59
    s_mov_b32 s59, 0
    s_branch K2_LOOP
K2_LOOP_END:
    s_waitcnt lgkmcnt(0) vmcnt(18)
    s_barrier
    v_mfma_f32_16x16x32_bf16 v[172:175], a[16:19], a[12:15], v[172:175]
    ds_read_b128 a[88:91], v8 offset:0
    s_lshr_b32 s33, s2, 3
    v_mfma_f32_16x16x32_bf16 v[172:175], a[52:55], a[48:51], v[172:175]
    ds_read_b128 a[72:75], v4 offset:0
    s_and_b32 s34, s2, 1
    v_mfma_f32_16x16x32_bf16 v[176:179], a[56:59], a[48:51], v[176:179]
    s_lshl_b32 s34, s34, 5
    v_mfma_f32_16x16x32_bf16 v[176:179], a[20:23], a[12:15], v[176:179]
    ds_read_b128 a[76:79], v5 offset:0
    s_add_u32 s33, s33, s34
    v_mfma_f32_16x16x32_bf16 v[180:183], a[24:27], a[12:15], v[180:183]
    ds_read_b128 a[80:83], v6 offset:0
    s_lshl_b32 s33, s33, 2
    v_mfma_f32_16x16x32_bf16 v[180:183], a[60:63], a[48:51], v[180:183]
    ds_read_b128 a[84:87], v7 offset:0
    s_add_u32 s33, s33, s28
    v_mfma_f32_16x16x32_bf16 v[184:187], a[64:67], a[48:51], v[184:187]
    s_lshl_b32 s33, s33, 4
    v_mfma_f32_16x16x32_bf16 v[184:187], a[28:31], a[12:15], v[184:187]
    ds_read_b128 a[92:95], v8 offset:1024
    s_add_u32 s33, s33, 117444608
    v_mfma_f32_16x16x32_bf16 v[188:191], a[32:35], a[12:15], v[188:191]
    ds_read_b128 a[96:99], v8 offset:2048
    v_and_b32 v2, 3, v0
    v_mfma_f32_16x16x32_bf16 v[188:191], a[68:71], a[48:51], v[188:191]
    ds_read_b128 a[100:103], v8 offset:3072
    v_lshl_add_u32 v2, v2, 2, s33
    v_mfma_f32_16x16x32_bf16 v[168:171], a[68:71], a[44:47], v[168:171]
    global_load_dword v15, v2, s[52:53] sc1
    s_mov_b32 s20, s60
    v_mfma_f32_16x16x32_bf16 v[168:171], a[32:35], a[8:11], v[168:171]
    ds_read_b128 a[104:107], v8 offset:4096
    s_mov_b32 s21, s61
    v_mfma_f32_16x16x32_bf16 v[164:167], a[28:31], a[8:11], v[164:167]
    s_mov_b32 s22, 2621440
    v_mfma_f32_16x16x32_bf16 v[164:167], a[64:67], a[44:47], v[164:167]
    s_mov_b32 s23, 0x00020000
    v_mfma_f32_16x16x32_bf16 v[160:163], a[60:63], a[44:47], v[160:163]
    s_mov_b32 s16, s62
    v_mfma_f32_16x16x32_bf16 v[160:163], a[24:27], a[8:11], v[160:163]
    s_mov_b32 s17, s63
    v_mfma_f32_16x16x32_bf16 v[156:159], a[20:23], a[8:11], v[156:159]
    s_mov_b32 s18, 2621440
    v_mfma_f32_16x16x32_bf16 v[156:159], a[56:59], a[44:47], v[156:159]
    s_mov_b32 s19, 0x00020000
    v_mfma_f32_16x16x32_bf16 v[152:155], a[52:55], a[44:47], v[152:155]
    v_mfma_f32_16x16x32_bf16 v[152:155], a[16:19], a[8:11], v[152:155]
    v_mfma_f32_16x16x32_bf16 v[132:135], a[16:19], a[4:7], v[132:135]
    ds_read_b128 a[124:127], v8 offset:10240
    v_mfma_f32_16x16x32_bf16 v[132:135], a[52:55], a[40:43], v[132:135]
    ds_read_b128 a[108:111], v4 offset:1024
    v_mfma_f32_16x16x32_bf16 v[136:139], a[56:59], a[40:43], v[136:139]
    buffer_load_dwordx2 v[222:223], v3, s[20:23], 0 offen offset:0
    v_mfma_f32_16x16x32_bf16 v[136:139], a[20:23], a[4:7], v[136:139]
    ds_read_b128 a[112:115], v5 offset:1024
    v_mfma_f32_16x16x32_bf16 v[140:143], a[24:27], a[4:7], v[140:143]
    ds_read_b128 a[116:119], v6 offset:1024
    v_mfma_f32_16x16x32_bf16 v[140:143], a[60:63], a[40:43], v[140:143]
    ds_read_b128 a[120:123], v7 offset:1024
    buffer_load_dwordx2 v[224:225], v3, s[20:23], 0 offen offset:32
    v_mfma_f32_16x16x32_bf16 v[144:147], a[64:67], a[40:43], v[144:147]
    v_mfma_f32_16x16x32_bf16 v[144:147], a[28:31], a[4:7], v[144:147]
    ds_read_b128 a[128:131], v8 offset:11264
    v_mfma_f32_16x16x32_bf16 v[148:151], a[32:35], a[4:7], v[148:151]
    ds_read_b128 a[132:135], v8 offset:12288
    buffer_load_dwordx2 v[226:227], v3, s[20:23], 0 offen offset:64
    v_mfma_f32_16x16x32_bf16 v[148:151], a[68:71], a[40:43], v[148:151]
    ds_read_b128 a[136:139], v8 offset:13312
    v_mfma_f32_16x16x32_bf16 v[128:131], a[68:71], a[36:39], v[128:131]
    s_add_u32 s35, s35, 36864
    s_cmp_eq_u32 s35, 147456
    s_cselect_b32 s50, s49, s48
    s_cselect_b32 s35, 0, s35
    v_mfma_f32_16x16x32_bf16 v[128:131], a[32:35], a[0:3], v[128:131]
    ds_read_b128 a[140:143], v8 offset:14336
    buffer_load_dwordx2 v[228:229], v3, s[20:23], 0 offen offset:96
    v_mfma_f32_16x16x32_bf16 v[124:127], a[28:31], a[0:3], v[124:127]
    v_add_u32 v4, s50, v4
    v_mfma_f32_16x16x32_bf16 v[124:127], a[64:67], a[36:39], v[124:127]
    v_add_u32 v5, s50, v5
    v_mfma_f32_16x16x32_bf16 v[120:123], a[60:63], a[36:39], v[120:123]
    buffer_load_dwordx2 v[230:231], v3, s[20:23], 0 offen offset:128
    v_mfma_f32_16x16x32_bf16 v[120:123], a[24:27], a[0:3], v[120:123]
    v_add_u32 v6, s50, v6
    v_mfma_f32_16x16x32_bf16 v[116:119], a[20:23], a[0:3], v[116:119]
    v_add_u32 v7, s50, v7
    v_mfma_f32_16x16x32_bf16 v[116:119], a[56:59], a[36:39], v[116:119]
    v_add_u32 v8, s50, v8
    v_mfma_f32_16x16x32_bf16 v[112:115], a[52:55], a[36:39], v[112:115]
    v_mfma_f32_16x16x32_bf16 v[112:115], a[16:19], a[0:3], v[112:115]
    s_waitcnt vmcnt(5)
    v_cmp_ne_u32 vcc, 0, v15
    s_cmp_eq_u64 vcc, exec
    s_cbranch_scc1 K2_PF_OK
    s_mov_b32 s33, 65536
    s_mov_b64 exec, -1
K2_PF:
    global_load_dword v15, v2, s[52:53] sc1
    s_waitcnt vmcnt(0)
    v_cmp_ne_u32 vcc, 0, v15
    s_cmp_eq_u64 vcc, exec
    s_cbranch_scc1 K2_PF_OK
    s_sleep 1
    s_sub_u32 s33, s33, 1
    s_cmp_lg_u32 s33, 0
    s_cbranch_scc1 K2_PF
K2_PF_OK:
    s_mov_b64 exec, -1
    s_waitcnt lgkmcnt(0)
    s_barrier
    v_mfma_f32_16x16x32_bf16 v[172:175], a[88:91], a[84:87], v[172:175]
    ds_read_b128 a[16:19], v8 offset:0
    v_mfma_f32_16x16x32_bf16 v[172:175], a[124:127], a[120:123], v[172:175]
    ds_read_b128 a[0:3], v4 offset:0
    s_add_u32 s34, s44, 7680
    v_mfma_f32_16x16x32_bf16 v[176:179], a[128:131], a[120:123], v[176:179]
    buffer_load_dwordx4 v[52:55], v16, s[4:7], s34 offen sc1
    v_mfma_f32_16x16x32_bf16 v[176:179], a[92:95], a[84:87], v[176:179]
    ds_read_b128 a[4:7], v5 offset:0
    v_mfma_f32_16x16x32_bf16 v[180:183], a[96:99], a[84:87], v[180:183]
    ds_read_b128 a[8:11], v6 offset:0
    v_mfma_f32_16x16x32_bf16 v[180:183], a[132:135], a[120:123], v[180:183]
    ds_read_b128 a[12:15], v7 offset:0
    v_mfma_f32_16x16x32_bf16 v[184:187], a[136:139], a[120:123], v[184:187]
    v_mfma_f32_16x16x32_bf16 v[184:187], a[100:103], a[84:87], v[184:187]
    ds_read_b128 a[20:23], v8 offset:1024
    v_mfma_f32_16x16x32_bf16 v[188:191], a[104:107], a[84:87], v[188:191]
    ds_read_b128 a[24:27], v8 offset:2048
    v_mfma_f32_16x16x32_bf16 v[188:191], a[140:143], a[120:123], v[188:191]
    ds_read_b128 a[28:31], v8 offset:3072
    v_mfma_f32_16x16x32_bf16 v[168:171], a[140:143], a[116:119], v[168:171]
    buffer_load_dwordx4 v[56:59], v16, s[4:7], s34 offen offset:1024 sc1
    v_mfma_f32_16x16x32_bf16 v[168:171], a[104:107], a[80:83], v[168:171]
    ds_read_b128 a[32:35], v8 offset:4096
    v_mfma_f32_16x16x32_bf16 v[164:167], a[100:103], a[80:83], v[164:167]
    v_mfma_f32_16x16x32_bf16 v[164:167], a[136:139], a[116:119], v[164:167]
    buffer_load_dwordx2 v[60:61], v17, s[4:7], s34 offen offset:2048 sc1
    v_mfma_f32_16x16x32_bf16 v[160:163], a[132:135], a[116:119], v[160:163]
    v_mfma_f32_16x16x32_bf16 v[160:163], a[96:99], a[80:83], v[160:163]
    s_add_u32 s34, s44, 10240
    v_mfma_f32_16x16x32_bf16 v[156:159], a[92:95], a[80:83], v[156:159]
    buffer_load_dwordx4 v[62:65], v16, s[4:7], s34 offen sc1
    v_mfma_f32_16x16x32_bf16 v[156:159], a[128:131], a[116:119], v[156:159]
    v_mfma_f32_16x16x32_bf16 v[152:155], a[124:127], a[116:119], v[152:155]
    buffer_load_dwordx4 v[66:69], v16, s[4:7], s34 offen offset:1024 sc1
    v_mfma_f32_16x16x32_bf16 v[152:155], a[88:91], a[80:83], v[152:155]
    v_mfma_f32_16x16x32_bf16 v[132:135], a[88:91], a[76:79], v[132:135]
    ds_read_b128 a[52:55], v8 offset:10240
    v_mfma_f32_16x16x32_bf16 v[132:135], a[124:127], a[112:115], v[132:135]
    ds_read_b128 a[36:39], v4 offset:1024
    v_mfma_f32_16x16x32_bf16 v[136:139], a[128:131], a[112:115], v[136:139]
    buffer_load_dwordx2 v[70:71], v17, s[4:7], s34 offen offset:2048 sc1
    v_mfma_f32_16x16x32_bf16 v[136:139], a[92:95], a[76:79], v[136:139]
    ds_read_b128 a[40:43], v5 offset:1024
    v_mfma_f32_16x16x32_bf16 v[140:143], a[96:99], a[76:79], v[140:143]
    ds_read_b128 a[44:47], v6 offset:1024
    v_mfma_f32_16x16x32_bf16 v[140:143], a[132:135], a[112:115], v[140:143]
    ds_read_b128 a[48:51], v7 offset:1024
    v_mfma_f32_16x16x32_bf16 v[144:147], a[136:139], a[112:115], v[144:147]
    v_mfma_f32_16x16x32_bf16 v[144:147], a[100:103], a[76:79], v[144:147]
    ds_read_b128 a[56:59], v8 offset:11264
    v_mfma_f32_16x16x32_bf16 v[148:151], a[104:107], a[76:79], v[148:151]
    ds_read_b128 a[60:63], v8 offset:12288
    v_mfma_f32_16x16x32_bf16 v[148:151], a[140:143], a[112:115], v[148:151]
    ds_read_b128 a[64:67], v8 offset:13312
    v_mfma_f32_16x16x32_bf16 v[128:131], a[140:143], a[108:111], v[128:131]
    s_add_u32 s35, s35, 36864
    s_cmp_eq_u32 s35, 147456
    s_cselect_b32 s50, s49, s48
    s_cselect_b32 s35, 0, s35
    v_mfma_f32_16x16x32_bf16 v[128:131], a[104:107], a[72:75], v[128:131]
    ds_read_b128 a[68:71], v8 offset:14336
    s_add_u32 s34, s44, 12800
    v_mfma_f32_16x16x32_bf16 v[124:127], a[100:103], a[72:75], v[124:127]
    buffer_load_dwordx4 v[72:75], v16, s[4:7], s34 offen sc1
    v_add_u32 v4, s50, v4
    v_mfma_f32_16x16x32_bf16 v[124:127], a[136:139], a[108:111], v[124:127]
    v_add_u32 v5, s50, v5
    v_mfma_f32_16x16x32_bf16 v[120:123], a[132:135], a[108:111], v[120:123]
    buffer_load_dwordx4 v[76:79], v16, s[4:7], s34 offen offset:1024 sc1
    v_mfma_f32_16x16x32_bf16 v[120:123], a[96:99], a[72:75], v[120:123]
    v_add_u32 v6, s50, v6
    v_mfma_f32_16x16x32_bf16 v[116:119], a[92:95], a[72:75], v[116:119]
    buffer_load_dwordx2 v[80:81], v17, s[4:7], s34 offen offset:2048 sc1
    v_add_u32 v7, s50, v7
    v_mfma_f32_16x16x32_bf16 v[116:119], a[128:131], a[108:111], v[116:119]
    v_add_u32 v8, s50, v8
    v_mfma_f32_16x16x32_bf16 v[112:115], a[124:127], a[108:111], v[112:115]
    v_mfma_f32_16x16x32_bf16 v[112:115], a[88:91], a[72:75], v[112:115]
    s_waitcnt lgkmcnt(0)
    s_barrier
    v_mfma_f32_16x16x32_bf16 v[172:175], a[16:19], a[12:15], v[172:175]
    ds_read_b128 a[88:91], v8 offset:0
    v_mfma_f32_16x16x32_bf16 v[172:175], a[52:55], a[48:51], v[172:175]
    ds_read_b128 a[72:75], v4 offset:0
    v_mfma_f32_16x16x32_bf16 v[176:179], a[56:59], a[48:51], v[176:179]
    v_mfma_f32_16x16x32_bf16 v[176:179], a[20:23], a[12:15], v[176:179]
    ds_read_b128 a[76:79], v5 offset:0
    v_mfma_f32_16x16x32_bf16 v[180:183], a[24:27], a[12:15], v[180:183]
    ds_read_b128 a[80:83], v6 offset:0
    v_mfma_f32_16x16x32_bf16 v[180:183], a[60:63], a[48:51], v[180:183]
    ds_read_b128 a[84:87], v7 offset:0
    v_mfma_f32_16x16x32_bf16 v[184:187], a[64:67], a[48:51], v[184:187]
    v_mfma_f32_16x16x32_bf16 v[184:187], a[28:31], a[12:15], v[184:187]
    ds_read_b128 a[92:95], v8 offset:1024
    v_mfma_f32_16x16x32_bf16 v[188:191], a[32:35], a[12:15], v[188:191]
    ds_read_b128 a[96:99], v8 offset:2048
    v_mfma_f32_16x16x32_bf16 v[188:191], a[68:71], a[48:51], v[188:191]
    ds_read_b128 a[100:103], v8 offset:3072
    v_mfma_f32_16x16x32_bf16 v[168:171], a[68:71], a[44:47], v[168:171]
    v_mfma_f32_16x16x32_bf16 v[168:171], a[32:35], a[8:11], v[168:171]
    ds_read_b128 a[104:107], v8 offset:4096
    v_mfma_f32_16x16x32_bf16 v[164:167], a[28:31], a[8:11], v[164:167]
    v_mfma_f32_16x16x32_bf16 v[164:167], a[64:67], a[44:47], v[164:167]
    v_mfma_f32_16x16x32_bf16 v[160:163], a[60:63], a[44:47], v[160:163]
    v_mfma_f32_16x16x32_bf16 v[160:163], a[24:27], a[8:11], v[160:163]
    v_mfma_f32_16x16x32_bf16 v[156:159], a[20:23], a[8:11], v[156:159]
    v_mfma_f32_16x16x32_bf16 v[156:159], a[56:59], a[44:47], v[156:159]
    v_mfma_f32_16x16x32_bf16 v[152:155], a[52:55], a[44:47], v[152:155]
    v_mfma_f32_16x16x32_bf16 v[152:155], a[16:19], a[8:11], v[152:155]
    v_mfma_f32_16x16x32_bf16 v[132:135], a[16:19], a[4:7], v[132:135]
    ds_read_b128 a[124:127], v8 offset:10240
    v_mfma_f32_16x16x32_bf16 v[132:135], a[52:55], a[40:43], v[132:135]
    ds_read_b128 a[108:111], v4 offset:1024
    v_mfma_f32_16x16x32_bf16 v[136:139], a[56:59], a[40:43], v[136:139]
    v_mfma_f32_16x16x32_bf16 v[136:139], a[20:23], a[4:7], v[136:139]
    ds_read_b128 a[112:115], v5 offset:1024
    v_mfma_f32_16x16x32_bf16 v[140:143], a[24:27], a[4:7], v[140:143]
    ds_read_b128 a[116:119], v6 offset:1024
    v_mfma_f32_16x16x32_bf16 v[140:143], a[60:63], a[40:43], v[140:143]
    ds_read_b128 a[120:123], v7 offset:1024
    v_mfma_f32_16x16x32_bf16 v[144:147], a[64:67], a[40:43], v[144:147]
    v_mfma_f32_16x16x32_bf16 v[144:147], a[28:31], a[4:7], v[144:147]
    ds_read_b128 a[128:131], v8 offset:11264
    v_mfma_f32_16x16x32_bf16 v[148:151], a[32:35], a[4:7], v[148:151]
    ds_read_b128 a[132:135], v8 offset:12288
    v_mfma_f32_16x16x32_bf16 v[148:151], a[68:71], a[40:43], v[148:151]
    ds_read_b128 a[136:139], v8 offset:13312
    v_mfma_f32_16x16x32_bf16 v[128:131], a[68:71], a[36:39], v[128:131]
    v_mfma_f32_16x16x32_bf16 v[128:131], a[32:35], a[0:3], v[128:131]
    ds_read_b128 a[140:143], v8 offset:14336
    v_mfma_f32_16x16x32_bf16 v[124:127], a[28:31], a[0:3], v[124:127]
    v_mfma_f32_16x16x32_bf16 v[124:127], a[64:67], a[36:39], v[124:127]
    v_mfma_f32_16x16x32_bf16 v[120:123], a[60:63], a[36:39], v[120:123]
    v_mfma_f32_16x16x32_bf16 v[120:123], a[24:27], a[0:3], v[120:123]
    v_mfma_f32_16x16x32_bf16 v[116:119], a[20:23], a[0:3], v[116:119]
    v_mfma_f32_16x16x32_bf16 v[116:119], a[56:59], a[36:39], v[116:119]
    v_mfma_f32_16x16x32_bf16 v[112:115], a[52:55], a[36:39], v[112:115]
    v_mfma_f32_16x16x32_bf16 v[112:115], a[16:19], a[0:3], v[112:115]
    s_waitcnt lgkmcnt(0)
    v_mfma_f32_16x16x32_bf16 v[172:175], a[88:91], a[84:87], v[172:175]
    s_waitcnt vmcnt(6)
    v_mfma_f32_16x16x32_bf16 v[172:175], a[124:127], a[120:123], v[172:175]
    v_lshlrev_b32 v192, 16, v52
    v_and_b32 v193, 0xffff0000, v52
    v_mfma_f32_16x16x32_bf16 v[176:179], a[128:131], a[120:123], v[176:179]
    v_lshlrev_b32 v194, 16, v53
    v_and_b32 v195, 0xffff0000, v53
    v_mfma_f32_16x16x32_bf16 v[176:179], a[92:95], a[84:87], v[176:179]
    v_lshlrev_b32 v196, 16, v54
    v_and_b32 v197, 0xffff0000, v54
    v_mfma_f32_16x16x32_bf16 v[180:183], a[96:99], a[84:87], v[180:183]
    v_lshlrev_b32 v198, 16, v55
    v_and_b32 v199, 0xffff0000, v55
    v_mfma_f32_16x16x32_bf16 v[180:183], a[132:135], a[120:123], v[180:183]
    v_lshlrev_b32 v200, 16, v56
    v_and_b32 v201, 0xffff0000, v56
    v_mfma_f32_16x16x32_bf16 v[184:187], a[136:139], a[120:123], v[184:187]
    v_lshlrev_b32 v202, 16, v57
    v_and_b32 v203, 0xffff0000, v57
    v_mfma_f32_16x16x32_bf16 v[184:187], a[100:103], a[84:87], v[184:187]
    v_lshlrev_b32 v204, 16, v58
    v_and_b32 v205, 0xffff0000, v58
    v_mfma_f32_16x16x32_bf16 v[188:191], a[104:107], a[84:87], v[188:191]
    v_lshlrev_b32 v206, 16, v59
    v_and_b32 v207, 0xffff0000, v59
    v_mfma_f32_16x16x32_bf16 v[188:191], a[140:143], a[120:123], v[188:191]
    v_lshlrev_b32 v208, 16, v60
    v_and_b32 v209, 0xffff0000, v60
    v_mfma_f32_16x16x32_bf16 v[168:171], a[140:143], a[116:119], v[168:171]
    v_lshlrev_b32 v210, 16, v61
    v_and_b32 v211, 0xffff0000, v61
    v_mfma_f32_16x16x32_bf16 v[168:171], a[104:107], a[80:83], v[168:171]
    v_mfma_f32_16x16x32_bf16 v[164:167], a[100:103], a[80:83], v[164:167]
    v_mfma_f32_16x16x32_bf16 v[164:167], a[136:139], a[116:119], v[164:167]
    v_mfma_f32_16x16x32_bf16 v[160:163], a[132:135], a[116:119], v[160:163]
    v_cvt_pk_bf16_f32 v172, v172, v173
    v_cvt_pk_bf16_f32 v173, v174, v175
    v_mfma_f32_16x16x32_bf16 v[160:163], a[96:99], a[80:83], v[160:163]
    v_cvt_pk_bf16_f32 v174, v176, v177
    v_cvt_pk_bf16_f32 v175, v178, v179
    v_mfma_f32_16x16x32_bf16 v[156:159], a[92:95], a[80:83], v[156:159]
    v_cvt_pk_bf16_f32 v176, v180, v181
    v_cvt_pk_bf16_f32 v177, v182, v183
    v_mfma_f32_16x16x32_bf16 v[156:159], a[128:131], a[116:119], v[156:159]
    v_cvt_pk_bf16_f32 v178, v184, v185
    v_cvt_pk_bf16_f32 v179, v186, v187
    v_mfma_f32_16x16x32_bf16 v[152:155], a[124:127], a[116:119], v[152:155]
    v_cvt_pk_bf16_f32 v180, v188, v189
    v_cvt_pk_bf16_f32 v181, v190, v191
    v_mfma_f32_16x16x32_bf16 v[152:155], a[88:91], a[80:83], v[152:155]
    s_add_u32 s34, s47, 5120
    v_mfma_f32_16x16x32_bf16 v[132:135], a[88:91], a[76:79], v[132:135]
    buffer_store_dwordx4 v[172:175], v16, s[4:7], s34 offen sc1
    v_mfma_f32_16x16x32_bf16 v[132:135], a[124:127], a[112:115], v[132:135]
    buffer_store_dwordx4 v[176:179], v16, s[4:7], s34 offen offset:1024 sc1
    v_mfma_f32_16x16x32_bf16 v[136:139], a[128:131], a[112:115], v[136:139]
    buffer_store_dwordx2 v[180:181], v17, s[4:7], s34 offen offset:2048 sc1
    v_mfma_f32_16x16x32_bf16 v[136:139], a[92:95], a[76:79], v[136:139]
    v_mfma_f32_16x16x32_bf16 v[140:143], a[96:99], a[76:79], v[140:143]
    v_cvt_pk_bf16_f32 v152, v152, v153
    v_cvt_pk_bf16_f32 v153, v154, v155
    v_mfma_f32_16x16x32_bf16 v[140:143], a[132:135], a[112:115], v[140:143]
    v_cvt_pk_bf16_f32 v154, v156, v157
    v_cvt_pk_bf16_f32 v155, v158, v159
    v_mfma_f32_16x16x32_bf16 v[144:147], a[136:139], a[112:115], v[144:147]
    v_cvt_pk_bf16_f32 v156, v160, v161
    v_cvt_pk_bf16_f32 v157, v162, v163
    v_mfma_f32_16x16x32_bf16 v[144:147], a[100:103], a[76:79], v[144:147]
    v_cvt_pk_bf16_f32 v158, v164, v165
    v_cvt_pk_bf16_f32 v159, v166, v167
    v_mfma_f32_16x16x32_bf16 v[148:151], a[104:107], a[76:79], v[148:151]
    v_cvt_pk_bf16_f32 v160, v168, v169
    v_cvt_pk_bf16_f32 v161, v170, v171
    v_mfma_f32_16x16x32_bf16 v[148:151], a[140:143], a[112:115], v[148:151]
    s_add_u32 s34, s46, 2560
    v_mfma_f32_16x16x32_bf16 v[128:131], a[140:143], a[108:111], v[128:131]
    buffer_store_dwordx4 v[152:155], v16, s[4:7], s34 offen sc1
    v_mfma_f32_16x16x32_bf16 v[128:131], a[104:107], a[72:75], v[128:131]
    buffer_store_dwordx4 v[156:159], v16, s[4:7], s34 offen offset:1024 sc1
    v_mfma_f32_16x16x32_bf16 v[124:127], a[100:103], a[72:75], v[124:127]
    buffer_store_dwordx2 v[160:161], v17, s[4:7], s34 offen offset:2048 sc1
    v_mfma_f32_16x16x32_bf16 v[124:127], a[136:139], a[108:111], v[124:127]
    v_mfma_f32_16x16x32_bf16 v[120:123], a[132:135], a[108:111], v[120:123]
    v_cvt_pk_bf16_f32 v132, v132, v133
    v_cvt_pk_bf16_f32 v133, v134, v135
    v_mfma_f32_16x16x32_bf16 v[120:123], a[96:99], a[72:75], v[120:123]
    v_cvt_pk_bf16_f32 v134, v136, v137
    v_cvt_pk_bf16_f32 v135, v138, v139
    v_mfma_f32_16x16x32_bf16 v[116:119], a[92:95], a[72:75], v[116:119]
    v_cvt_pk_bf16_f32 v136, v140, v141
    v_cvt_pk_bf16_f32 v137, v142, v143
    v_mfma_f32_16x16x32_bf16 v[116:119], a[128:131], a[108:111], v[116:119]
    v_cvt_pk_bf16_f32 v138, v144, v145
    v_cvt_pk_bf16_f32 v139, v146, v147
    v_mfma_f32_16x16x32_bf16 v[112:115], a[124:127], a[108:111], v[112:115]
    v_cvt_pk_bf16_f32 v140, v148, v149
    v_cvt_pk_bf16_f32 v141, v150, v151
    v_mfma_f32_16x16x32_bf16 v[112:115], a[88:91], a[72:75], v[112:115]
    s_add_u32 s34, s45, 0
    buffer_store_dwordx4 v[132:135], v16, s[4:7], s34 offen sc1
    buffer_store_dwordx4 v[136:139], v16, s[4:7], s34 offen offset:1024 sc1
    buffer_store_dwordx2 v[140:141], v17, s[4:7], s34 offen offset:2048 sc1
    v_pk_add_f32 v[32:33], v[32:33], v[192:193]
    v_pk_add_f32 v[34:35], v[34:35], v[194:195]
    v_pk_add_f32 v[36:37], v[36:37], v[196:197]
    v_pk_add_f32 v[38:39], v[38:39], v[198:199]
    v_pk_add_f32 v[40:41], v[40:41], v[200:201]
    v_pk_add_f32 v[42:43], v[42:43], v[202:203]
    v_pk_add_f32 v[44:45], v[44:45], v[204:205]
    v_pk_add_f32 v[46:47], v[46:47], v[206:207]
    v_pk_add_f32 v[48:49], v[48:49], v[208:209]
    v_pk_add_f32 v[50:51], v[50:51], v[210:211]
    s_waitcnt vmcnt(12)
    v_lshlrev_b32 v192, 16, v62
    v_and_b32 v193, 0xffff0000, v62
    v_lshlrev_b32 v194, 16, v63
    v_and_b32 v195, 0xffff0000, v63
    v_lshlrev_b32 v196, 16, v64
    v_and_b32 v197, 0xffff0000, v64
    v_lshlrev_b32 v198, 16, v65
    v_and_b32 v199, 0xffff0000, v65
    v_lshlrev_b32 v200, 16, v66
    v_and_b32 v201, 0xffff0000, v66
    v_lshlrev_b32 v202, 16, v67
    v_and_b32 v203, 0xffff0000, v67
    v_lshlrev_b32 v204, 16, v68
    v_and_b32 v205, 0xffff0000, v68
    v_lshlrev_b32 v206, 16, v69
    v_and_b32 v207, 0xffff0000, v69
    v_lshlrev_b32 v208, 16, v70
    v_and_b32 v209, 0xffff0000, v70
    v_lshlrev_b32 v210, 16, v71
    v_and_b32 v211, 0xffff0000, v71
    v_pk_add_f32 v[32:33], v[32:33], v[192:193]
    v_pk_add_f32 v[34:35], v[34:35], v[194:195]
    v_pk_add_f32 v[36:37], v[36:37], v[196:197]
    v_pk_add_f32 v[38:39], v[38:39], v[198:199]
    v_pk_add_f32 v[40:41], v[40:41], v[200:201]
    v_pk_add_f32 v[42:43], v[42:43], v[202:203]
    v_pk_add_f32 v[44:45], v[44:45], v[204:205]
    v_pk_add_f32 v[46:47], v[46:47], v[206:207]
    v_pk_add_f32 v[48:49], v[48:49], v[208:209]
    v_pk_add_f32 v[50:51], v[50:51], v[210:211]
    s_waitcnt vmcnt(9)
    v_lshlrev_b32 v192, 16, v72
    v_and_b32 v193, 0xffff0000, v72
    v_lshlrev_b32 v194, 16, v73
    v_and_b32 v195, 0xffff0000, v73
    v_lshlrev_b32 v196, 16, v74
    v_and_b32 v197, 0xffff0000, v74
    v_lshlrev_b32 v198, 16, v75
    v_and_b32 v199, 0xffff0000, v75
    v_lshlrev_b32 v200, 16, v76
    v_and_b32 v201, 0xffff0000, v76
    v_lshlrev_b32 v202, 16, v77
    v_and_b32 v203, 0xffff0000, v77
    v_lshlrev_b32 v204, 16, v78
    v_and_b32 v205, 0xffff0000, v78
    v_lshlrev_b32 v206, 16, v79
    v_and_b32 v207, 0xffff0000, v79
    v_lshlrev_b32 v208, 16, v80
    v_and_b32 v209, 0xffff0000, v80
    v_lshlrev_b32 v210, 16, v81
    v_and_b32 v211, 0xffff0000, v81
    v_pk_add_f32 v[32:33], v[32:33], v[192:193]
    v_pk_add_f32 v[34:35], v[34:35], v[194:195]
    v_pk_add_f32 v[36:37], v[36:37], v[196:197]
    v_pk_add_f32 v[38:39], v[38:39], v[198:199]
    v_pk_add_f32 v[40:41], v[40:41], v[200:201]
    v_pk_add_f32 v[42:43], v[42:43], v[202:203]
    v_pk_add_f32 v[44:45], v[44:45], v[204:205]
    v_pk_add_f32 v[46:47], v[46:47], v[206:207]
    v_pk_add_f32 v[48:49], v[48:49], v[208:209]
    v_pk_add_f32 v[50:51], v[50:51], v[210:211]
    s_mov_b32 s33, 0xbfb8aa3b
    v_cvt_pk_bf16_f32 v192, v32, v33
    v_cvt_pk_bf16_f32 v193, v34, v35
    v_cvt_pk_bf16_f32 v194, v36, v37
    v_cvt_pk_bf16_f32 v195, v38, v39
    v_cvt_pk_bf16_f32 v196, v40, v41
    v_cvt_pk_bf16_f32 v197, v42, v43
    v_cvt_pk_bf16_f32 v198, v44, v45
    v_cvt_pk_bf16_f32 v199, v46, v47
    v_cvt_pk_bf16_f32 v200, v48, v49
    v_cvt_pk_bf16_f32 v201, v50, v51
    v_lshlrev_b32 v32, 16, v192
    v_and_b32 v33, 0xffff0000, v192
    v_lshlrev_b32 v34, 16, v193
    v_and_b32 v35, 0xffff0000, v193
    v_lshlrev_b32 v36, 16, v194
    v_and_b32 v37, 0xffff0000, v194
    v_lshlrev_b32 v38, 16, v195
    v_and_b32 v39, 0xffff0000, v195
    v_lshlrev_b32 v40, 16, v196
    v_and_b32 v41, 0xffff0000, v196
    v_lshlrev_b32 v42, 16, v197
    v_and_b32 v43, 0xffff0000, v197
    v_lshlrev_b32 v44, 16, v198
    v_and_b32 v45, 0xffff0000, v198
    v_lshlrev_b32 v46, 16, v199
    v_and_b32 v47, 0xffff0000, v199
    v_lshlrev_b32 v48, 16, v200
    v_and_b32 v49, 0xffff0000, v200
    v_lshlrev_b32 v50, 16, v201
    v_and_b32 v51, 0xffff0000, v201
    v_mul_f32 v192, s33, v32
    v_mul_f32 v193, s33, v33
    v_mul_f32 v194, s33, v34
    v_mul_f32 v195, s33, v35
    v_mul_f32 v196, s33, v36
    v_mul_f32 v197, s33, v37
    v_mul_f32 v198, s33, v38
    v_mul_f32 v199, s33, v39
    v_mul_f32 v200, s33, v40
    v_mul_f32 v201, s33, v41
    v_mul_f32 v202, s33, v42
    v_mul_f32 v203, s33, v43
    v_mul_f32 v204, s33, v44
    v_mul_f32 v205, s33, v45
    v_mul_f32 v206, s33, v46
    v_mul_f32 v207, s33, v47
    v_mul_f32 v208, s33, v48
    v_mul_f32 v209, s33, v49
    v_mul_f32 v210, s33, v50
    v_mul_f32 v211, s33, v51
    v_exp_f32 v192, v192
    v_exp_f32 v193, v193
    v_exp_f32 v194, v194
    v_exp_f32 v195, v195
    v_exp_f32 v196, v196
    v_exp_f32 v197, v197
    v_exp_f32 v198, v198
    v_exp_f32 v199, v199
    v_exp_f32 v200, v200
    v_exp_f32 v201, v201
    v_exp_f32 v202, v202
    v_exp_f32 v203, v203
    v_exp_f32 v204, v204
    v_exp_f32 v205, v205
    v_exp_f32 v206, v206
    v_exp_f32 v207, v207
    v_exp_f32 v208, v208
    v_exp_f32 v209, v209
    v_exp_f32 v210, v210
    v_exp_f32 v211, v211
    v_add_f32 v192, 1.0, v192
    v_add_f32 v193, 1.0, v193
    v_add_f32 v194, 1.0, v194
    v_add_f32 v195, 1.0, v195
    v_add_f32 v196, 1.0, v196
    v_add_f32 v197, 1.0, v197
    v_add_f32 v198, 1.0, v198
    v_add_f32 v199, 1.0, v199
    v_add_f32 v200, 1.0, v200
    v_add_f32 v201, 1.0, v201
    v_add_f32 v202, 1.0, v202
    v_add_f32 v203, 1.0, v203
    v_add_f32 v204, 1.0, v204
    v_add_f32 v205, 1.0, v205
    v_add_f32 v206, 1.0, v206
    v_add_f32 v207, 1.0, v207
    v_add_f32 v208, 1.0, v208
    v_add_f32 v209, 1.0, v209
    v_add_f32 v210, 1.0, v210
    v_add_f32 v211, 1.0, v211
    v_rcp_f32 v192, v192
    v_rcp_f32 v193, v193
    v_rcp_f32 v194, v194
    v_rcp_f32 v195, v195
    v_rcp_f32 v196, v196
    v_rcp_f32 v197, v197
    v_rcp_f32 v198, v198
    v_rcp_f32 v199, v199
    v_rcp_f32 v200, v200
    v_rcp_f32 v201, v201
    v_rcp_f32 v202, v202
    v_rcp_f32 v203, v203
    v_rcp_f32 v204, v204
    v_rcp_f32 v205, v205
    v_rcp_f32 v206, v206
    v_rcp_f32 v207, v207
    v_rcp_f32 v208, v208
    v_rcp_f32 v209, v209
    v_rcp_f32 v210, v210
    v_rcp_f32 v211, v211
    v_pk_mul_f32 v[32:33], v[32:33], v[192:193]
    v_pk_mul_f32 v[34:35], v[34:35], v[194:195]
    v_pk_mul_f32 v[36:37], v[36:37], v[196:197]
    v_pk_mul_f32 v[38:39], v[38:39], v[198:199]
    v_pk_mul_f32 v[40:41], v[40:41], v[200:201]
    v_pk_mul_f32 v[42:43], v[42:43], v[202:203]
    v_pk_mul_f32 v[44:45], v[44:45], v[204:205]
    v_pk_mul_f32 v[46:47], v[46:47], v[206:207]
    v_pk_mul_f32 v[48:49], v[48:49], v[208:209]
    v_pk_mul_f32 v[50:51], v[50:51], v[210:211]
    v_cvt_pk_bf16_f32 v192, v32, v33
    v_cvt_pk_bf16_f32 v193, v34, v35
    v_cvt_pk_bf16_f32 v194, v36, v37
    v_cvt_pk_bf16_f32 v195, v38, v39
    v_cvt_pk_bf16_f32 v196, v40, v41
    v_cvt_pk_bf16_f32 v197, v42, v43
    v_cvt_pk_bf16_f32 v198, v44, v45
    v_cvt_pk_bf16_f32 v199, v46, v47
    v_cvt_pk_bf16_f32 v200, v48, v49
    v_cvt_pk_bf16_f32 v201, v50, v51
    v_lshlrev_b32 v32, 16, v192
    v_and_b32 v33, 0xffff0000, v192
    v_lshlrev_b32 v232, 16, v222
    v_and_b32 v233, 0xffff0000, v222
    v_lshlrev_b32 v34, 16, v193
    v_and_b32 v35, 0xffff0000, v193
    v_lshlrev_b32 v234, 16, v223
    v_and_b32 v235, 0xffff0000, v223
    v_lshlrev_b32 v36, 16, v194
    v_and_b32 v37, 0xffff0000, v194
    v_lshlrev_b32 v236, 16, v224
    v_and_b32 v237, 0xffff0000, v224
    v_lshlrev_b32 v38, 16, v195
    v_and_b32 v39, 0xffff0000, v195
    v_lshlrev_b32 v238, 16, v225
    v_and_b32 v239, 0xffff0000, v225
    v_lshlrev_b32 v40, 16, v196
    v_and_b32 v41, 0xffff0000, v196
    v_lshlrev_b32 v240, 16, v226
    v_and_b32 v241, 0xffff0000, v226
    v_lshlrev_b32 v42, 16, v197
    v_and_b32 v43, 0xffff0000, v197
    v_lshlrev_b32 v242, 16, v227
    v_and_b32 v243, 0xffff0000, v227
    v_lshlrev_b32 v44, 16, v198
    v_and_b32 v45, 0xffff0000, v198
    v_lshlrev_b32 v244, 16, v228
    v_and_b32 v245, 0xffff0000, v228
    v_lshlrev_b32 v46, 16, v199
    v_and_b32 v47, 0xffff0000, v199
    v_lshlrev_b32 v246, 16, v229
    v_and_b32 v247, 0xffff0000, v229
    v_lshlrev_b32 v48, 16, v200
    v_and_b32 v49, 0xffff0000, v200
    v_lshlrev_b32 v248, 16, v230
    v_and_b32 v249, 0xffff0000, v230
    v_lshlrev_b32 v50, 16, v201
    v_and_b32 v51, 0xffff0000, v201
    v_lshlrev_b32 v250, 16, v231
    v_and_b32 v251, 0xffff0000, v231
    s_mov_b32 s35, 65536
    s_branch K2_PS_LOAD
K2_PS:
    v_max3_u32 v12, v82, v83, v84
    v_max3_u32 v13, v85, v86, v87
    v_max3_u32 v12, v12, v88, v89
    v_max3_u32 v13, v13, v90, v91
    v_max3_u32 v12, v12, v92, v93
    v_max3_u32 v13, v13, v94, v95
    v_max3_u32 v12, v12, v96, v97
    v_max3_u32 v13, v13, v98, v99
    v_max3_u32 v12, v12, v100, v101
    v_max3_u32 v13, v13, v102, v103
    v_max3_u32 v12, v12, v104, v105
    v_max3_u32 v13, v13, v106, v107
    v_max3_u32 v12, v12, v108, v109
    v_max3_u32 v13, v13, v110, v111
    v_max_u32 v12, v12, v13
    v_cmp_eq_u32 vcc, -1, v12
    s_cmp_eq_u64 vcc, 0
    s_cbranch_scc1 K2_PS_OK
    s_sub_u32 s35, s35, 1
    s_cmp_eq_u32 s35, 0
    s_cbranch_scc1 K2_PS_OK
K2_PS_LOAD:
    s_add_u32 s34, s44, 0
    buffer_load_dwordx4 v[82:85], v16, s[4:7], s34 offen sc1
    buffer_load_dwordx4 v[86:89], v16, s[4:7], s34 offen offset:1024 sc1
    buffer_load_dwordx2 v[90:91], v17, s[4:7], s34 offen offset:2048 sc1
    s_add_u32 s34, s44, 2560
    buffer_load_dwordx4 v[92:95], v16, s[4:7], s34 offen sc1
    buffer_load_dwordx4 v[96:99], v16, s[4:7], s34 offen offset:1024 sc1
    buffer_load_dwordx2 v[100:101], v17, s[4:7], s34 offen offset:2048 sc1
    s_add_u32 s34, s44, 5120
    buffer_load_dwordx4 v[102:105], v16, s[4:7], s34 offen sc1
    buffer_load_dwordx4 v[106:109], v16, s[4:7], s34 offen offset:1024 sc1
    buffer_load_dwordx2 v[110:111], v17, s[4:7], s34 offen offset:2048 sc1
    s_waitcnt vmcnt(0)
    s_branch K2_PS
K2_PS_OK:
    v_lshlrev_b32 v192, 16, v82
    v_and_b32 v193, 0xffff0000, v82
    v_lshlrev_b32 v194, 16, v83
    v_and_b32 v195, 0xffff0000, v83
    v_lshlrev_b32 v196, 16, v84
    v_and_b32 v197, 0xffff0000, v84
    v_lshlrev_b32 v198, 16, v85
    v_and_b32 v199, 0xffff0000, v85
    v_lshlrev_b32 v200, 16, v86
    v_and_b32 v201, 0xffff0000, v86
    v_lshlrev_b32 v202, 16, v87
    v_and_b32 v203, 0xffff0000, v87
    v_lshlrev_b32 v204, 16, v88
    v_and_b32 v205, 0xffff0000, v88
    v_lshlrev_b32 v206, 16, v89
    v_and_b32 v207, 0xffff0000, v89
    v_lshlrev_b32 v208, 16, v90
    v_and_b32 v209, 0xffff0000, v90
    v_lshlrev_b32 v210, 16, v91
    v_and_b32 v211, 0xffff0000, v91
    v_pk_add_f32 v[112:113], v[112:113], v[192:193]
    v_pk_add_f32 v[114:115], v[114:115], v[194:195]
    v_pk_add_f32 v[116:117], v[116:117], v[196:197]
    v_pk_add_f32 v[118:119], v[118:119], v[198:199]
    v_pk_add_f32 v[120:121], v[120:121], v[200:201]
    v_pk_add_f32 v[122:123], v[122:123], v[202:203]
    v_pk_add_f32 v[124:125], v[124:125], v[204:205]
    v_pk_add_f32 v[126:127], v[126:127], v[206:207]
    v_pk_add_f32 v[128:129], v[128:129], v[208:209]
    v_pk_add_f32 v[130:131], v[130:131], v[210:211]
    v_lshlrev_b32 v192, 16, v92
    v_and_b32 v193, 0xffff0000, v92
    v_lshlrev_b32 v194, 16, v93
    v_and_b32 v195, 0xffff0000, v93
    v_lshlrev_b32 v196, 16, v94
    v_and_b32 v197, 0xffff0000, v94
    v_lshlrev_b32 v198, 16, v95
    v_and_b32 v199, 0xffff0000, v95
    v_lshlrev_b32 v200, 16, v96
    v_and_b32 v201, 0xffff0000, v96
    v_lshlrev_b32 v202, 16, v97
    v_and_b32 v203, 0xffff0000, v97
    v_lshlrev_b32 v204, 16, v98
    v_and_b32 v205, 0xffff0000, v98
    v_lshlrev_b32 v206, 16, v99
    v_and_b32 v207, 0xffff0000, v99
    v_lshlrev_b32 v208, 16, v100
    v_and_b32 v209, 0xffff0000, v100
    v_lshlrev_b32 v210, 16, v101
    v_and_b32 v211, 0xffff0000, v101
    v_pk_add_f32 v[112:113], v[112:113], v[192:193]
    v_pk_add_f32 v[114:115], v[114:115], v[194:195]
    v_pk_add_f32 v[116:117], v[116:117], v[196:197]
    v_pk_add_f32 v[118:119], v[118:119], v[198:199]
    v_pk_add_f32 v[120:121], v[120:121], v[200:201]
    v_pk_add_f32 v[122:123], v[122:123], v[202:203]
    v_pk_add_f32 v[124:125], v[124:125], v[204:205]
    v_pk_add_f32 v[126:127], v[126:127], v[206:207]
    v_pk_add_f32 v[128:129], v[128:129], v[208:209]
    v_pk_add_f32 v[130:131], v[130:131], v[210:211]
    v_lshlrev_b32 v192, 16, v102
    v_and_b32 v193, 0xffff0000, v102
    v_lshlrev_b32 v194, 16, v103
    v_and_b32 v195, 0xffff0000, v103
    v_lshlrev_b32 v196, 16, v104
    v_and_b32 v197, 0xffff0000, v104
    v_lshlrev_b32 v198, 16, v105
    v_and_b32 v199, 0xffff0000, v105
    v_lshlrev_b32 v200, 16, v106
    v_and_b32 v201, 0xffff0000, v106
    v_lshlrev_b32 v202, 16, v107
    v_and_b32 v203, 0xffff0000, v107
    v_lshlrev_b32 v204, 16, v108
    v_and_b32 v205, 0xffff0000, v108
    v_lshlrev_b32 v206, 16, v109
    v_and_b32 v207, 0xffff0000, v109
    v_lshlrev_b32 v208, 16, v110
    v_and_b32 v209, 0xffff0000, v110
    v_lshlrev_b32 v210, 16, v111
    v_and_b32 v211, 0xffff0000, v111
    v_pk_add_f32 v[112:113], v[112:113], v[192:193]
    v_pk_add_f32 v[114:115], v[114:115], v[194:195]
    v_pk_add_f32 v[116:117], v[116:117], v[196:197]
    v_pk_add_f32 v[118:119], v[118:119], v[198:199]
    v_pk_add_f32 v[120:121], v[120:121], v[200:201]
    v_pk_add_f32 v[122:123], v[122:123], v[202:203]
    v_pk_add_f32 v[124:125], v[124:125], v[204:205]
    v_pk_add_f32 v[126:127], v[126:127], v[206:207]
    v_pk_add_f32 v[128:129], v[128:129], v[208:209]
    v_pk_add_f32 v[130:131], v[130:131], v[210:211]
    v_cvt_pk_bf16_f32 v192, v112, v113
    v_cvt_pk_bf16_f32 v193, v114, v115
    v_cvt_pk_bf16_f32 v194, v116, v117
    v_cvt_pk_bf16_f32 v195, v118, v119
    v_cvt_pk_bf16_f32 v196, v120, v121
    v_cvt_pk_bf16_f32 v197, v122, v123
    v_cvt_pk_bf16_f32 v198, v124, v125
    v_cvt_pk_bf16_f32 v199, v126, v127
    v_cvt_pk_bf16_f32 v200, v128, v129
    v_cvt_pk_bf16_f32 v201, v130, v131
    v_lshlrev_b32 v112, 16, v192
    v_and_b32 v113, 0xffff0000, v192
    v_lshlrev_b32 v114, 16, v193
    v_and_b32 v115, 0xffff0000, v193
    v_lshlrev_b32 v116, 16, v194
    v_and_b32 v117, 0xffff0000, v194
    v_lshlrev_b32 v118, 16, v195
    v_and_b32 v119, 0xffff0000, v195
    v_lshlrev_b32 v120, 16, v196
    v_and_b32 v121, 0xffff0000, v196
    v_lshlrev_b32 v122, 16, v197
    v_and_b32 v123, 0xffff0000, v197
    v_lshlrev_b32 v124, 16, v198
    v_and_b32 v125, 0xffff0000, v198
    v_lshlrev_b32 v126, 16, v199
    v_and_b32 v127, 0xffff0000, v199
    v_lshlrev_b32 v128, 16, v200
    v_and_b32 v129, 0xffff0000, v200
    v_lshlrev_b32 v130, 16, v201
    v_and_b32 v131, 0xffff0000, v201
    v_pk_mul_f32 v[112:113], v[112:113], v[32:33]
    v_pk_mul_f32 v[114:115], v[114:115], v[34:35]
    v_pk_mul_f32 v[116:117], v[116:117], v[36:37]
    v_pk_mul_f32 v[118:119], v[118:119], v[38:39]
    v_pk_mul_f32 v[120:121], v[120:121], v[40:41]
    v_pk_mul_f32 v[122:123], v[122:123], v[42:43]
    v_pk_mul_f32 v[124:125], v[124:125], v[44:45]
    v_pk_mul_f32 v[126:127], v[126:127], v[46:47]
    v_pk_mul_f32 v[128:129], v[128:129], v[48:49]
    v_pk_mul_f32 v[130:131], v[130:131], v[50:51]
    v_cvt_pk_bf16_f32 v192, v112, v113
    v_cvt_pk_bf16_f32 v193, v114, v115
    v_cvt_pk_bf16_f32 v194, v116, v117
    v_cvt_pk_bf16_f32 v195, v118, v119
    v_cvt_pk_bf16_f32 v196, v120, v121
    v_cvt_pk_bf16_f32 v197, v122, v123
    v_cvt_pk_bf16_f32 v198, v124, v125
    v_cvt_pk_bf16_f32 v199, v126, v127
    v_cvt_pk_bf16_f32 v200, v128, v129
    v_cvt_pk_bf16_f32 v201, v130, v131
    v_lshlrev_b32 v112, 16, v192
    v_and_b32 v113, 0xffff0000, v192
    v_lshlrev_b32 v114, 16, v193
    v_and_b32 v115, 0xffff0000, v193
    v_lshlrev_b32 v116, 16, v194
    v_and_b32 v117, 0xffff0000, v194
    v_lshlrev_b32 v118, 16, v195
    v_and_b32 v119, 0xffff0000, v195
    v_lshlrev_b32 v120, 16, v196
    v_and_b32 v121, 0xffff0000, v196
    v_lshlrev_b32 v122, 16, v197
    v_and_b32 v123, 0xffff0000, v197
    v_lshlrev_b32 v124, 16, v198
    v_and_b32 v125, 0xffff0000, v198
    v_lshlrev_b32 v126, 16, v199
    v_and_b32 v127, 0xffff0000, v199
    v_lshlrev_b32 v128, 16, v200
    v_and_b32 v129, 0xffff0000, v200
    v_lshlrev_b32 v130, 16, v201
    v_and_b32 v131, 0xffff0000, v201
    v_pk_add_f32 v[112:113], v[112:113], v[232:233]
    v_pk_add_f32 v[114:115], v[114:115], v[234:235]
    v_pk_add_f32 v[116:117], v[116:117], v[236:237]
    v_pk_add_f32 v[118:119], v[118:119], v[238:239]
    v_pk_add_f32 v[120:121], v[120:121], v[240:241]
    v_pk_add_f32 v[122:123], v[122:123], v[242:243]
    v_pk_add_f32 v[124:125], v[124:125], v[244:245]
    v_pk_add_f32 v[126:127], v[126:127], v[246:247]
    v_pk_add_f32 v[128:129], v[128:129], v[248:249]
    v_pk_add_f32 v[130:131], v[130:131], v[250:251]
    v_cvt_pk_bf16_f32 v222, v112, v113
    v_cvt_pk_bf16_f32 v223, v114, v115
    v_cvt_pk_bf16_f32 v224, v116, v117
    v_cvt_pk_bf16_f32 v225, v118, v119
    v_cvt_pk_bf16_f32 v226, v120, v121
    v_cvt_pk_bf16_f32 v227, v122, v123
    v_cvt_pk_bf16_f32 v228, v124, v125
    v_cvt_pk_bf16_f32 v229, v126, v127
    v_cvt_pk_bf16_f32 v230, v128, v129
    v_cvt_pk_bf16_f32 v231, v130, v131
    buffer_store_dwordx2 v[222:223], v3, s[16:19], 0 offen offset:0
    buffer_store_dwordx2 v[224:225], v3, s[16:19], 0 offen offset:32
    buffer_store_dwordx2 v[226:227], v3, s[16:19], 0 offen offset:64
    buffer_store_dwordx2 v[228:229], v3, s[16:19], 0 offen offset:96
    buffer_store_dwordx2 v[230:231], v3, s[16:19], 0 offen offset:128
K1_END:
    s_endpgm
.section .rodata,"a"
.p2align 6
.amdhsa_kernel recurrent_scan__mha_block_cached__swiglu_ffn__prompt_kernel
  .amdhsa_next_free_vgpr 512
  .amdhsa_next_free_sgpr 72
  .amdhsa_accum_offset 256
  .amdhsa_group_segment_fixed_size 0
  .amdhsa_kernarg_size 96
  .amdhsa_user_sgpr_count 2
  .amdhsa_user_sgpr_kernarg_segment_ptr 1
  .amdhsa_system_sgpr_workgroup_id_x 1
.end_amdhsa_kernel
```
